```python
import torch

def _softmax(x, axis=-1):
    return torch.softmax(x, dim=axis)
def _gelu(x):
    return torch.nn.functional.gelu(x, approximate="tanh")
def _silu(x):
    return torch.nn.functional.silu(x)
def _sigmoid(x):
    return torch.sigmoid(x)
def _layernorm(x, axis=-1, eps=1e-5):
    m = x.mean(dim=axis, keepdim=True)
    v = x.var(dim=axis, keepdim=True, unbiased=False)
    return (x - m) / torch.sqrt(v + eps)
def _scatter_add(tgt, idx, src, axis=0):
    return tgt.clone().index_add_(axis, idx, src)
def _segment_sum(src, seg, n):
    out = torch.zeros((n,) + src.shape[1:], dtype=src.dtype)
    return out.index_add_(0, seg, src)
def _pad(x, pw):
    flat = tuple(v for pair in reversed(pw) for v in pair)
    return torch.nn.functional.pad(x, flat)

kernel_name = 'concat_heads__gqa_block_cached__gqa_block_cached__near_ridge'

def setup_inputs():

    _w = (lambda a: (lambda t: t.to(torch.bfloat16) if t.is_floating_point() else t)(torch.as_tensor(a)))
    def _A_setup():
        B, Sq, D = 32, 48, 512
        Hq, Hkv, Sk, Dh = 32, 8, 512, 128
        assert Hq % Hkv == 0, (Hq, Hkv)
        return {
            "x": _w((lambda *s: torch.randn(*s, dtype=torch.bfloat16) * 0.8)(B, Sq, D)),
            "k_cache": _w((lambda *s: torch.randn(*s, dtype=torch.bfloat16) * 0.8)(B, Hkv, Sk, Dh)),
            "v_cache": _w((lambda *s: torch.randn(*s, dtype=torch.bfloat16) * 0.05)(B, Hkv, Sk, Dh)),
            "wq": _w((lambda *s: torch.randn(*s, dtype=torch.bfloat16) * 0.8)(D, Hq * Dh) * (D ** -0.5)),
            "wo": _w((lambda *s: torch.randn(*s, dtype=torch.bfloat16) * 0.05)(Hq * Dh, D) * ((Hq * Dh) ** -0.5)),
        }
    _A_in = _A_setup()

    def _B_setup():
        B, Sq, D = 32, 48, 512
        Hq, Hkv, Sk, Dh = 32, 8, 512, 128
        assert Hq % Hkv == 0, (Hq, Hkv)
        return {
            "x": _w((lambda *s: torch.randn(*s, dtype=torch.bfloat16) * 0.8)(B, Sq, D)),
            "k_cache": _w((lambda *s: torch.randn(*s, dtype=torch.bfloat16) * 0.8)(B, Hkv, Sk, Dh)),
            "v_cache": _w((lambda *s: torch.randn(*s, dtype=torch.bfloat16) * 0.05)(B, Hkv, Sk, Dh)),
            "wq": _w((lambda *s: torch.randn(*s, dtype=torch.bfloat16) * 0.8)(D, Hq * Dh) * (D ** -0.5)),
            "wo": _w((lambda *s: torch.randn(*s, dtype=torch.bfloat16) * 0.05)(Hq * Dh, D) * ((Hq * Dh) ** -0.5)),
        }
    _B_in = _B_setup()

    return {
        "A_x": _A_in["x"],
        "A_k_cache": _A_in["k_cache"],
        "A_v_cache": _A_in["v_cache"],
        "A_wq": _A_in["wq"],
        "A_wo": _A_in["wo"],
        "B_x": _B_in["x"],
        "B_k_cache": _B_in["k_cache"],
        "B_v_cache": _B_in["v_cache"],
        "B_wq": _B_in["wq"],
        "B_wo": _B_in["wo"],
    }

def reference(A_x, A_k_cache, A_v_cache, A_wq, A_wo, B_x, B_k_cache, B_v_cache, B_wq, B_wo):
    def _A_ref(x, k_cache, v_cache, wq, wo):
        B, Sq, D = x.shape
        Hq, Dh = 32, 128
        Hkv = k_cache.shape[1]
        rep = Hq // Hkv
        q = (lambda x, *d: x.permute(*d))((x @ wq).reshape(B, Sq, Hq, Dh), 0, 2, 1, 3)
        k = (lambda x, n, axis: torch.repeat_interleave(x, n, dim=axis))(k_cache, rep, axis=1)
        v = (lambda x, n, axis: torch.repeat_interleave(x, n, dim=axis))(v_cache, rep, axis=1)
        scores = torch.einsum("bhqd,bhkd->bhqk", q, k) * (Dh ** -0.5)
        p = _softmax(scores, axis=-1)
        o = torch.einsum("bhqk,bhkd->bhqd", p, v)
        return (lambda x, *d: x.permute(*d))(o, 0, 2, 1, 3).reshape(B, Sq, Hq * Dh) @ wo

    def _B_ref(x, k_cache, v_cache, wq, wo):
        B, Sq, D = x.shape
        Hq, Dh = 32, 128
        Hkv = k_cache.shape[1]
        rep = Hq // Hkv
        q = (lambda x, *d: x.permute(*d))((x @ wq).reshape(B, Sq, Hq, Dh), 0, 2, 1, 3)
        k = (lambda x, n, axis: torch.repeat_interleave(x, n, dim=axis))(k_cache, rep, axis=1)
        v = (lambda x, n, axis: torch.repeat_interleave(x, n, dim=axis))(v_cache, rep, axis=1)
        scores = torch.einsum("bhqd,bhkd->bhqk", q, k) * (Dh ** -0.5)
        p = _softmax(scores, axis=-1)
        o = torch.einsum("bhqk,bhkd->bhqd", p, v)
        return (lambda x, *d: x.permute(*d))(o, 0, 2, 1, 3).reshape(B, Sq, Hq * Dh) @ wo

    a = _A_ref(A_x, A_k_cache, A_v_cache, A_wq, A_wo)
    b = _B_ref(B_x, B_k_cache, B_v_cache, B_wq, B_wo)
    return torch.concatenate([a, b], axis=-1)
```

```asm
; @launch grid=(256,1,1) block=(256,1,1) lds=163840
.amdgcn_target "amdgcn-amd-amdhsa--gfx950"
.text
.globl concat_heads__gqa_block_cached__gqa_block_cached__near_ridge_kernel
.p2align 8
.type concat_heads__gqa_block_cached__gqa_block_cached__near_ridge_kernel,@function
concat_heads__gqa_block_cached__gqa_block_cached__near_ridge_kernel:
    s_cmp_ge_u32 s2, 256
    s_cbranch_scc1 L_end
    s_load_dwordx2 s[28:29], s[0:1], 80
    s_load_dwordx2 s[36:37], s[0:1], 88
    s_load_dwordx2 s[32:33], s[0:1], 96
    s_and_b32 s3, s2, 7
    s_lshr_b32 s4, s2, 3
    s_lshr_b32 s5, s3, 2
    s_mul_i32 s6, s5, 40
    s_add_u32 s0, s0, s6
    s_addc_u32 s1, s1, 0
    s_load_dwordx2 s[8:9], s[0:1], 0
    s_load_dwordx2 s[12:13], s[0:1], 24
    s_load_dwordx2 s[16:17], s[0:1], 8
    s_load_dwordx2 s[20:21], s[0:1], 16
    s_load_dwordx2 s[24:25], s[0:1], 32
    s_getpc_b64 s[74:75]
L_pc:
    v_lshlrev_b32 v1, 7, v0
    v_mov_b32 v3, s75
    v_add_co_u32 v2, vcc, s74, v1
    s_nop 1
    v_addc_co_u32 v3, vcc, 0, v3, vcc
    global_load_dword v31, v[2:3], off
    v_add_u32 v1, 0x8000, v1
    v_min_u32 v1, L_last-L_pc, v1
    v_mov_b32 v3, s75
    v_add_co_u32 v2, vcc, s74, v1
    s_nop 1
    v_addc_co_u32 v3, vcc, 0, v3, vcc
    global_load_dword v30, v[2:3], off
    v_lshrrev_b32 v1, 6, v0
    v_and_b32 v0, 63, v0
    v_readfirstlane_b32 s38, v1
    s_and_b32 s3, s3, 3
    s_lshl_b32 s3, s3, 1
    s_and_b32 s6, s4, 1
    s_or_b32 s3, s3, s6
    s_lshr_b32 s4, s4, 1
    s_and_b32 s6, s38, 1
    s_lshr_b32 s7, s38, 1
    s_mul_i32 s74, s6, 81920
    s_lshl_b32 s75, s7, 12
    s_add_u32 s52, s74, s75
    s_mul_i32 s75, s7, 3072
    s_add_u32 s53, s74, s75
    s_mov_b32 s10, 1572864
    s_mov_b32 s11, 0x20000
    s_mov_b32 s14, 0x400000
    s_mov_b32 s15, 0x20000
    s_mov_b32 s40, 31744
    s_mov_b32 s41, 63488
    s_mov_b32 s42, 95232
    s_mov_b32 s43, 15360
    s_mov_b32 s44, 30720
    v_lshrrev_b32 v1, 4, v0
    v_lshlrev_b32 v2, 2, v1
    v_and_b32 v3, 15, v0
    v_xor_b32 v2, v2, v3
    v_lshlrev_b32 v2, 4, v2
    v_lshl_add_u32 v2, v1, 13, v2
    s_lshl_b32 s74, s3, 2
    s_add_u32 s74, s74, s38
    s_lshl_b32 s74, s74, 8
    v_add_u32 v18, s74, v2
    s_lshl_b32 s74, s7, 2
    v_add_u32 v2, s74, v1
    v_and_b32 v3, 7, v0
    v_xor_b32 v28, v2, v3
    v_lshlrev_b32 v28, 4, v28
    v_lshrrev_b32 v27, 3, v0
    s_lshl_b32 s75, s4, 1
    s_add_u32 s75, s75, s6
    s_mul_i32 s74, s75, 6
    s_add_u32 s74, s74, s7
    s_lshl_b32 s74, s74, 13
    v_lshl_add_u32 v2, v27, 10, v28
    v_add_u32 v19, s74, v2
    s_lshl_b32 s74, s75, 3
    s_add_u32 s74, s74, s3
    s_lshl_b32 s74, s74, 6
    s_add_u32 s74, s74, s7
    s_lshl_b32 s74, s74, 11
    v_lshl_add_u32 v2, v27, 8, v28
    v_add_u32 v20, s74, v2
    v_and_b32 v1, 1, v1
    v_lshlrev_b32 v1, 2, v1
    v_xor_b32 v2, v1, v3
    v_lshlrev_b32 v2, 4, v2
    v_lshl_add_u32 v2, v27, 8, v2
    v_add_u32 v21, s74, v2
    s_mov_b32 s18, 0x2000400
    s_mov_b32 s19, 0x20000
    s_mov_b32 s22, 0x2000400
    s_mov_b32 s23, 0x20000
    s_mov_b32 s45, 1024
    s_mov_b32 s46, 128
    s_mov_b32 s47, 3072
    s_mov_b32 s48, 2176
    s_mov_b32 s26, 0x400000
    s_mov_b32 s27, 0x20000
    s_mov_b32 s30, 3145728
    s_mov_b32 s31, 0x20000
    s_mov_b32 s34, 0x10000000
    s_mov_b32 s35, 0x20000
    s_mov_b32 s49, 7168
    s_mov_b32 s50, 14336
    s_mov_b32 s51, 21504
    s_mul_i32 s54, s7, 81920
    s_lshl_b32 s74, s6, 12
    s_add_u32 s54, s54, s74
    s_mov_b32 s56, 0x3e0293ee
    s_mov_b32 s57, s56
    s_lshl_b32 s39, s5, 4
    s_add_u32 s39, s39, s4
    s_add_u32 s74, s3, 0
    s_and_b32 s74, s74, 7
    s_add_u32 s75, s74, s4
    s_and_b32 s75, s75, 7
    s_lshl_b32 s58, s75, 7
    s_lshl_b32 s75, s39, 3
    s_add_u32 s74, s74, s75
    s_mul_i32 s66, s74, 98304
    s_add_u32 s74, s3, 1
    s_and_b32 s74, s74, 7
    s_add_u32 s75, s74, s4
    s_and_b32 s75, s75, 7
    s_lshl_b32 s59, s75, 7
    s_lshl_b32 s75, s39, 3
    s_add_u32 s74, s74, s75
    s_mul_i32 s67, s74, 98304
    s_add_u32 s74, s3, 2
    s_and_b32 s74, s74, 7
    s_add_u32 s75, s74, s4
    s_and_b32 s75, s75, 7
    s_lshl_b32 s60, s75, 7
    s_lshl_b32 s75, s39, 3
    s_add_u32 s74, s74, s75
    s_mul_i32 s68, s74, 98304
    s_add_u32 s74, s3, 3
    s_and_b32 s74, s74, 7
    s_add_u32 s75, s74, s4
    s_and_b32 s75, s75, 7
    s_lshl_b32 s61, s75, 7
    s_lshl_b32 s75, s39, 3
    s_add_u32 s74, s74, s75
    s_mul_i32 s69, s74, 98304
    s_add_u32 s74, s3, 4
    s_and_b32 s74, s74, 7
    s_add_u32 s75, s74, s4
    s_and_b32 s75, s75, 7
    s_lshl_b32 s62, s75, 7
    s_lshl_b32 s75, s39, 3
    s_add_u32 s74, s74, s75
    s_mul_i32 s70, s74, 98304
    s_add_u32 s74, s3, 5
    s_and_b32 s74, s74, 7
    s_add_u32 s75, s74, s4
    s_and_b32 s75, s75, 7
    s_lshl_b32 s63, s75, 7
    s_lshl_b32 s75, s39, 3
    s_add_u32 s74, s74, s75
    s_mul_i32 s71, s74, 98304
    s_add_u32 s74, s3, 6
    s_and_b32 s74, s74, 7
    s_add_u32 s75, s74, s4
    s_and_b32 s75, s75, 7
    s_lshl_b32 s64, s75, 7
    s_lshl_b32 s75, s39, 3
    s_add_u32 s74, s74, s75
    s_mul_i32 s72, s74, 98304
    s_add_u32 s74, s3, 7
    s_and_b32 s74, s74, 7
    s_add_u32 s75, s74, s4
    s_and_b32 s75, s75, 7
    s_lshl_b32 s65, s75, 7
    s_lshl_b32 s75, s39, 3
    s_add_u32 s74, s74, s75
    s_mul_i32 s73, s74, 98304
    s_lshl_b32 s39, s39, 2
    v_bfe_u32 v1, v0, 2, 2
    v_mul_u32_u24 v2, 320, v1
    v_lshrrev_b32 v3, 5, v0
    v_lshl_add_u32 v2, v3, 11, v2
    v_bfe_u32 v27, v0, 4, 1
    v_lshl_add_u32 v2, v27, 5, v2
    v_and_b32 v28, 1, v0
    v_lshl_add_u32 v2, v28, 4, v2
    v_bfe_u32 v29, v0, 1, 1
    v_lshl_add_u32 v2, v29, 3, v2
    v_add_u32 v4, s52, v2
    v_xor_b32 v5, 64, v4
    v_xor_b32 v6, 128, v4
    v_xor_b32 v7, 192, v4
    v_lshl_add_u32 v2, v3, 2, v1
    v_lshlrev_b32 v2, 7, v2
    v_lshl_add_u32 v2, v27, 5, v2
    v_lshl_add_u32 v2, v29, 4, v2
    v_lshrrev_b32 v1, 1, v1
    v_lshl_add_u32 v2, v1, 6, v2
    v_lshl_add_u32 v2, v28, 3, v2
    s_mul_i32 s74, s6, 81920
    s_add_u32 s75, s74, 16384
    v_add_u32 v16, s75, v2
    v_xor_b32 v17, 64, v16
    v_bfe_u32 v1, v0, 1, 3
    v_xor_b32 v1, v1, v3
    v_lshlrev_b32 v1, 4, v1
    v_and_b32 v2, 7, v0
    v_lshl_add_u32 v1, v2, 7, v1
    v_bfe_u32 v2, v0, 3, 1
    v_lshl_add_u32 v28, v2, 12, v1
    v_lshl_add_u32 v28, v27, 11, v28
    v_add_u32 v12, s74, v28
    v_xor_b32 v13, 32, v12
    v_xor_b32 v14, 64, v12
    v_xor_b32 v15, 96, v12
    v_mul_u32_u24 v2, 3072, v2
    v_mul_u32_u24 v27, 81920, v27
    v_add3_u32 v1, v1, v2, v27
    v_add_u32 v8, 65536, v1
    v_xor_b32 v9, 32, v8
    v_xor_b32 v10, 64, v8
    v_xor_b32 v11, 96, v8
    v_lshlrev_b32 v1, 4, v0
    v_add_u32 v22, s52, v1
    v_and_b32 v1, 15, v0
    v_lshl_add_u32 v1, v1, 4, v27
    v_lshl_add_u32 v1, v3, 9, v1
    s_lshl_b32 s74, s7, 4
    s_add_u32 s74, s74, s6
    s_lshl_b32 s74, s74, 8
    v_add_u32 v23, s74, v1
    s_and_b32 s75, s3, 1
    s_lshl_b32 s74, s4, 1
    s_add_u32 s74, s74, s75
    s_lshl_b32 s74, s74, 2
    s_add_u32 s74, s74, s38
    s_lshl_b32 s74, s74, 5
    s_and_b32 s75, s3, 6
    s_add_u32 s74, s74, s75
    s_lshl_b32 s74, s74, 10
    v_and_b32 v3, 15, v0
    v_lshrrev_b32 v27, 4, v0
    v_lshlrev_b32 v2, 7, v3
    v_lshl_add_u32 v2, v27, 13, v2
    v_add_u32 v29, s74, v2
    s_waitcnt lgkmcnt(0)
    s_add_u32 m0, s53, 65536
    s_nop 0
    buffer_load_dwordx4 v19, s[8:11], 0 offen offset:0 lds
    buffer_load_dwordx4 v19, s[8:11], s43 offen offset:1024 lds
    buffer_load_dwordx4 v19, s[8:11], s44 offen offset:2048 lds
    s_add_u32 m0, s52, 32768
    v_add_u32 v19, 128, v19
    buffer_load_dwordx4 v18, s[12:15], 0 offen offset:0 lds
    buffer_load_dwordx4 v18, s[12:15], s40 offen offset:1024 lds
    buffer_load_dwordx4 v18, s[12:15], s41 offen offset:2048 lds
    buffer_load_dwordx4 v18, s[12:15], s42 offen offset:3072 lds
    v_add_u32 v18, 131072, v18
    buffer_load_dword v31, v29, s[12:15], 0 offen
    s_add_u32 m0, s52, 40960
    s_nop 0
    buffer_load_dwordx4 v18, s[12:15], 0 offen offset:0 lds
    buffer_load_dwordx4 v18, s[12:15], s40 offen offset:1024 lds
    buffer_load_dwordx4 v18, s[12:15], s41 offen offset:2048 lds
    buffer_load_dwordx4 v18, s[12:15], s42 offen offset:3072 lds
    v_add_u32 v18, 131072, v18
    s_sub_u32 s16, s16, 1024
    s_subb_u32 s17, s17, 0
    s_sub_u32 s20, s20, 1024
    s_subb_u32 s21, s21, 0
    s_waitcnt vmcnt(9)
    s_barrier
    s_waitcnt vmcnt(5)
    ds_read_b64_tr_b16 v[32:33], v4 offset:32768
    ds_read_b64_tr_b16 v[34:35], v4 offset:33792
    ds_read_b128 a[64:67], v8 offset:0
    ds_read_b128 a[68:71], v8 offset:1024
    ds_read_b128 a[72:75], v8 offset:2048
    ds_read_b64_tr_b16 v[36:37], v5 offset:32768
    ds_read_b64_tr_b16 v[38:39], v5 offset:33792
    ds_read_b64_tr_b16 v[40:41], v6 offset:32768
    ds_read_b64_tr_b16 v[42:43], v6 offset:33792
    ds_read_b64_tr_b16 v[44:45], v7 offset:32768
    ds_read_b64_tr_b16 v[46:47], v7 offset:33792
    s_add_u32 m0, s52, 49152
    s_waitcnt lgkmcnt(8)
    v_mfma_f32_32x32x16_bf16 v[64:79], v[32:35], a[64:67], 0
    buffer_load_dwordx4 v18, s[12:15], 0 offen offset:0 lds
    s_waitcnt lgkmcnt(7)
    v_mfma_f32_32x32x16_bf16 v[128:143], v[32:35], a[68:71], 0
    s_waitcnt vmcnt(1)
    ds_read_b64_tr_b16 a[32:33], v4 offset:40960
    ds_read_b64_tr_b16 a[34:35], v4 offset:41984
    buffer_load_dwordx4 v18, s[12:15], s40 offen offset:1024 lds
    s_waitcnt lgkmcnt(8)
    v_mfma_f32_32x32x16_bf16 v[192:207], v[32:35], a[72:75], 0
    ds_read_b64_tr_b16 a[36:37], v5 offset:40960
    buffer_load_dwordx4 v18, s[12:15], s41 offen offset:2048 lds
    s_waitcnt lgkmcnt(7)
    v_mfma_f32_32x32x16_bf16 v[80:95], v[36:39], a[64:67], 0
    ds_read_b64_tr_b16 a[38:39], v5 offset:41984
    buffer_load_dwordx4 v18, s[12:15], s42 offen offset:3072 lds
    v_add_u32 v18, 131072, v18
    v_mfma_f32_32x32x16_bf16 v[144:159], v[36:39], a[68:71], 0
    s_add_u32 m0, s53, 73728
    ds_read_b64_tr_b16 a[40:41], v6 offset:40960
    ds_read_b64_tr_b16 a[42:43], v6 offset:41984
    buffer_load_dwordx4 v19, s[8:11], 0 offen offset:0 lds
    v_mfma_f32_32x32x16_bf16 v[208:223], v[36:39], a[72:75], 0
    ds_read_b64_tr_b16 a[44:45], v7 offset:40960
    buffer_load_dwordx4 v19, s[8:11], s43 offen offset:1024 lds
    s_waitcnt lgkmcnt(9)
    v_mfma_f32_32x32x16_bf16 v[96:111], v[40:43], a[64:67], 0
    ds_read_b64_tr_b16 a[46:47], v7 offset:41984
    buffer_load_dwordx4 v19, s[8:11], s44 offen offset:2048 lds
    v_add_u32 v19, 128, v19
    v_mfma_f32_32x32x16_bf16 v[160:175], v[40:43], a[68:71], 0
    s_add_u32 m0, s52, 57344
    ds_read_b128 a[76:79], v9 offset:0
    buffer_load_dwordx4 v18, s[12:15], 0 offen offset:0 lds
    v_mfma_f32_32x32x16_bf16 v[224:239], v[40:43], a[72:75], 0
    ds_read_b128 a[80:83], v9 offset:1024
    buffer_load_dwordx4 v18, s[12:15], s40 offen offset:1024 lds
    s_waitcnt lgkmcnt(7)
    v_mfma_f32_32x32x16_bf16 v[112:127], v[44:47], a[64:67], 0
    ds_read_b128 a[84:87], v9 offset:2048
    buffer_load_dwordx4 v18, s[12:15], s41 offen offset:2048 lds
    v_mfma_f32_32x32x16_bf16 v[176:191], v[44:47], a[68:71], 0
    buffer_load_dwordx4 v18, s[12:15], s42 offen offset:3072 lds
    s_add_u32 m0, s52, 0
    v_add_u32 v18, 131072, v18
    v_mfma_f32_32x32x16_bf16 v[240:255], v[44:47], a[72:75], 0
    buffer_load_dwordx4 v20, s[16:19], s45 offen offset:0 nt lds
    s_waitcnt lgkmcnt(2)
    v_mfma_f32_32x32x16_bf16 v[64:79], a[32:35], a[76:79], v[64:79]
    s_waitcnt vmcnt(8)
    ds_read_b64_tr_b16 v[48:49], v4 offset:49152
    ds_read_b64_tr_b16 v[50:51], v4 offset:50176
    buffer_load_dwordx4 v20, s[16:19], s46 offen offset:1024 nt lds
    s_waitcnt lgkmcnt(3)
    v_mfma_f32_32x32x16_bf16 v[128:143], a[32:35], a[80:83], v[128:143]
    ds_read_b64_tr_b16 v[52:53], v5 offset:49152
    buffer_load_dwordx4 v20, s[16:19], s47 offen offset:2048 nt lds
    s_waitcnt lgkmcnt(3)
    v_mfma_f32_32x32x16_bf16 v[192:207], a[32:35], a[84:87], v[192:207]
    ds_read_b64_tr_b16 v[54:55], v5 offset:50176
    buffer_load_dwordx4 v20, s[16:19], s48 offen offset:3072 nt lds
    v_xor_b32 v20, 8192, v20
    v_mfma_f32_32x32x16_bf16 v[80:95], a[36:39], a[76:79], v[80:95]
    s_add_u32 m0, s52, 16384
    ds_read_b64_tr_b16 v[56:57], v6 offset:49152
    ds_read_b64_tr_b16 v[58:59], v6 offset:50176
    buffer_load_dwordx4 v21, s[20:23], s45 offen offset:0 nt lds
    v_mfma_f32_32x32x16_bf16 v[144:159], a[36:39], a[80:83], v[144:159]
    ds_read_b64_tr_b16 v[60:61], v7 offset:49152
    buffer_load_dwordx4 v21, s[20:23], s46 offen offset:1024 nt lds
    v_mfma_f32_32x32x16_bf16 v[208:223], a[36:39], a[84:87], v[208:223]
    ds_read_b64_tr_b16 v[62:63], v7 offset:50176
    buffer_load_dwordx4 v21, s[20:23], s47 offen offset:2048 nt lds
    v_mfma_f32_32x32x16_bf16 v[96:111], a[40:43], a[76:79], v[96:111]
    ds_read_b128 a[88:91], v10 offset:0
    buffer_load_dwordx4 v21, s[20:23], s48 offen offset:3072 nt lds
    v_xor_b32 v21, 8192, v21
    v_mfma_f32_32x32x16_bf16 v[160:175], a[40:43], a[80:83], v[160:175]
    s_add_u32 m0, s52, 32768
    ds_read_b128 a[92:95], v10 offset:1024
    buffer_load_dwordx4 v18, s[12:15], 0 offen offset:0 lds
    v_mfma_f32_32x32x16_bf16 v[224:239], a[40:43], a[84:87], v[224:239]
    ds_read_b128 a[64:67], v10 offset:2048
    v_mfma_f32_32x32x16_bf16 v[112:127], a[44:47], a[76:79], v[112:127]
    buffer_load_dwordx4 v18, s[12:15], s40 offen offset:1024 lds
    v_mfma_f32_32x32x16_bf16 v[176:191], a[44:47], a[80:83], v[176:191]
    v_mfma_f32_32x32x16_bf16 v[240:255], a[44:47], a[84:87], v[240:255]
    s_waitcnt vmcnt(10)
    ds_read_b64_tr_b16 v[32:33], v4 offset:57344
    ds_read_b64_tr_b16 v[34:35], v4 offset:58368
    buffer_load_dwordx4 v18, s[12:15], s41 offen offset:2048 lds
    s_waitcnt lgkmcnt(4)
    v_mfma_f32_32x32x16_bf16 v[64:79], v[48:51], a[88:91], v[64:79]
    ds_read_b64_tr_b16 v[36:37], v5 offset:57344
    s_waitcnt lgkmcnt(4)
    v_mfma_f32_32x32x16_bf16 v[128:143], v[48:51], a[92:95], v[128:143]
    ds_read_b64_tr_b16 v[38:39], v5 offset:58368
    buffer_load_dwordx4 v18, s[12:15], s42 offen offset:3072 lds
    s_waitcnt lgkmcnt(4)
    v_add_u32 v18, 131072, v18
    v_mfma_f32_32x32x16_bf16 v[192:207], v[48:51], a[64:67], v[192:207]
    ds_read_b64_tr_b16 v[40:41], v6 offset:57344
    ds_read_b64_tr_b16 v[42:43], v6 offset:58368
    v_mfma_f32_32x32x16_bf16 v[80:95], v[52:55], a[88:91], v[80:95]
    s_add_u32 m0, s52, 40960
    ds_read_b64_tr_b16 v[44:45], v7 offset:57344
    buffer_load_dwordx4 v18, s[12:15], 0 offen offset:0 lds
    v_mfma_f32_32x32x16_bf16 v[144:159], v[52:55], a[92:95], v[144:159]
    ds_read_b64_tr_b16 v[46:47], v7 offset:58368
    v_mfma_f32_32x32x16_bf16 v[208:223], v[52:55], a[64:67], v[208:223]
    ds_read_b128 a[68:71], v11 offset:0
    buffer_load_dwordx4 v18, s[12:15], s40 offen offset:1024 lds
    v_mfma_f32_32x32x16_bf16 v[96:111], v[56:59], a[88:91], v[96:111]
    ds_read_b128 a[72:75], v11 offset:1024
    v_mfma_f32_32x32x16_bf16 v[160:175], v[56:59], a[92:95], v[160:175]
    ds_read_b128 a[76:79], v11 offset:2048
    buffer_load_dwordx4 v18, s[12:15], s41 offen offset:2048 lds
    v_mfma_f32_32x32x16_bf16 v[224:239], v[56:59], a[64:67], v[224:239]
    v_mfma_f32_32x32x16_bf16 v[112:127], v[60:63], a[88:91], v[112:127]
    buffer_load_dwordx4 v18, s[12:15], s42 offen offset:3072 lds
    v_add_u32 v18, 131072, v18
    v_mfma_f32_32x32x16_bf16 v[176:191], v[60:63], a[92:95], v[176:191]
    s_waitcnt vmcnt(4)
    ds_read_b64_tr_b16 a[32:33], v4 offset:32768
    ds_read_b64_tr_b16 a[34:35], v4 offset:33792
    v_mfma_f32_32x32x16_bf16 v[240:255], v[60:63], a[64:67], v[240:255]
    s_add_u32 m0, s52, 49152
    ds_read_b64_tr_b16 a[36:37], v5 offset:32768
    buffer_load_dwordx4 v18, s[12:15], 0 offen offset:0 lds
    s_waitcnt lgkmcnt(5)
    v_mfma_f32_32x32x16_bf16 v[64:79], v[32:35], a[68:71], v[64:79]
    s_waitcnt lgkmcnt(3)
    s_barrier
    v_mfma_f32_32x32x16_bf16 v[128:143], v[32:35], a[72:75], v[128:143]
    ds_read_b64_tr_b16 a[38:39], v5 offset:33792
    ds_read_b64_tr_b16 a[40:41], v6 offset:32768
    buffer_load_dwordx4 v18, s[12:15], s40 offen offset:1024 lds
    v_mfma_f32_32x32x16_bf16 v[192:207], v[32:35], a[76:79], v[192:207]
    ds_read_b64_tr_b16 a[42:43], v6 offset:33792
    ds_read_b64_tr_b16 a[44:45], v7 offset:32768
    v_mfma_f32_32x32x16_bf16 v[80:95], v[36:39], a[68:71], v[80:95]
    ds_read_b64_tr_b16 a[46:47], v7 offset:33792
    buffer_load_dwordx4 v18, s[12:15], s41 offen offset:2048 lds
    v_mfma_f32_32x32x16_bf16 v[144:159], v[36:39], a[72:75], v[144:159]
    ds_read_b128 a[80:83], v8 offset:8192
    ds_read_b128 a[96:99], v12 offset:0
    v_mfma_f32_32x32x16_bf16 v[208:223], v[36:39], a[76:79], v[208:223]
    ds_read_b128 a[84:87], v8 offset:9216
    buffer_load_dwordx4 v18, s[12:15], s42 offen offset:3072 lds
    v_add_u32 v18, 131072, v18
    v_mfma_f32_32x32x16_bf16 v[96:111], v[40:43], a[68:71], v[96:111]
    ds_read_b128 a[88:91], v8 offset:10240
    ds_read_b128 a[100:103], v13 offset:0
    s_add_u32 m0, s52, 57344
    v_mfma_f32_32x32x16_bf16 v[160:175], v[40:43], a[72:75], v[160:175]
    buffer_load_dwordx4 v18, s[12:15], 0 offen offset:0 lds
    ds_read_b128 a[104:107], v14 offset:0
    v_mfma_f32_32x32x16_bf16 v[224:239], v[40:43], a[76:79], v[224:239]
    ds_read_b128 a[108:111], v15 offset:0
    ds_read_b128 a[112:115], v12 offset:1024
    v_mfma_f32_32x32x16_bf16 v[112:127], v[44:47], a[68:71], v[112:127]
    s_waitcnt vmcnt(5)
    ds_read_b64_tr_b16 v[48:49], v4 offset:40960
    ds_read_b64_tr_b16 v[50:51], v4 offset:41984
    buffer_load_dwordx4 v18, s[12:15], s40 offen offset:1024 lds
    v_mfma_f32_32x32x16_bf16 v[176:191], v[44:47], a[72:75], v[176:191]
    ds_read_b64_tr_b16 v[52:53], v5 offset:40960
    ds_read_b128 a[116:119], v13 offset:1024
    v_mfma_f32_32x32x16_bf16 v[240:255], v[44:47], a[76:79], v[240:255]
    ds_read_b64_tr_b16 v[54:55], v5 offset:41984
    buffer_load_dwordx4 v18, s[12:15], s41 offen offset:2048 lds
    s_waitcnt lgkmcnt(10)
    v_mfma_f32_32x32x16_bf16 v[64:79], a[32:35], a[80:83], v[64:79]
    ds_read_b64_tr_b16 v[56:57], v6 offset:40960
    ds_read_b64_tr_b16 v[58:59], v6 offset:41984
    v_mfma_f32_32x32x16_bf16 v[128:143], a[32:35], a[84:87], v[128:143]
    ds_read_b64_tr_b16 v[60:61], v7 offset:40960
    buffer_load_dwordx4 v18, s[12:15], s42 offen offset:3072 lds
    s_waitcnt lgkmcnt(10)
    v_add_u32 v18, 131072, v18
    v_mfma_f32_32x32x16_bf16 v[192:207], a[32:35], a[88:91], v[192:207]
    ds_read_b64_tr_b16 v[62:63], v7 offset:41984
    ds_read_b128 a[120:123], v14 offset:1024
    v_mfma_f32_32x32x16_bf16 v[80:95], a[36:39], a[80:83], v[80:95]
    s_add_u32 m0, s53, 65536
    ds_read_b128 a[92:95], v9 offset:8192
    buffer_load_dwordx4 v19, s[8:11], 0 offen offset:0 lds
    v_mfma_f32_32x32x16_bf16 v[144:159], a[36:39], a[84:87], v[144:159]
    ds_read_b128 a[64:67], v9 offset:9216
    ds_read_b128 a[124:127], v15 offset:1024
    v_mfma_f32_32x32x16_bf16 v[208:223], a[36:39], a[88:91], v[208:223]
    ds_read_b128 a[68:71], v9 offset:10240
    buffer_load_dwordx4 v19, s[8:11], s43 offen offset:1024 lds
    v_mfma_f32_32x32x16_bf16 v[96:111], a[40:43], a[80:83], v[96:111]
    ds_read_b64_tr_b16 a[128:129], v16 offset:0
    ds_read_b64_tr_b16 a[130:131], v16 offset:4096
    v_mfma_f32_32x32x16_bf16 v[160:175], a[40:43], a[84:87], v[160:175]
    buffer_load_dwordx4 v19, s[8:11], s44 offen offset:2048 lds
    ds_read_b64_tr_b16 a[132:133], v17 offset:0
    v_add_u32 v19, 128, v19
    v_mfma_f32_32x32x16_bf16 v[224:239], a[40:43], a[88:91], v[224:239]
    v_mfma_f32_32x32x16_bf16 v[112:127], a[44:47], a[80:83], v[112:127]
    s_add_u32 m0, s52, 32768
    s_waitcnt vmcnt(7)
    ds_read_b64_tr_b16 v[32:33], v4 offset:49152
    ds_read_b64_tr_b16 v[34:35], v4 offset:50176
    buffer_load_dwordx4 v18, s[12:15], 0 offen offset:0 lds
    v_mfma_f32_32x32x16_bf16 v[176:191], a[44:47], a[84:87], v[176:191]
    ds_read_b64_tr_b16 v[36:37], v5 offset:49152
    ds_read_b64_tr_b16 a[134:135], v17 offset:4096
    v_mfma_f32_32x32x16_bf16 v[240:255], a[44:47], a[88:91], v[240:255]
    ds_read_b64_tr_b16 v[38:39], v5 offset:50176
    buffer_load_dwordx4 v18, s[12:15], s40 offen offset:1024 lds
    s_waitcnt lgkmcnt(8)
    v_mfma_f32_32x32x16_bf16 v[64:79], v[48:51], a[92:95], v[64:79]
    ds_read_b64_tr_b16 v[40:41], v6 offset:49152
    ds_read_b64_tr_b16 v[42:43], v6 offset:50176
    v_mfma_f32_32x32x16_bf16 v[128:143], v[48:51], a[64:67], v[128:143]
    ds_read_b64_tr_b16 v[44:45], v7 offset:49152
    buffer_load_dwordx4 v18, s[12:15], s41 offen offset:2048 lds
    v_mfma_f32_32x32x16_bf16 v[192:207], v[48:51], a[68:71], v[192:207]
    ds_read_b64_tr_b16 v[46:47], v7 offset:50176
    ds_read_b64_tr_b16 a[136:137], v16 offset:1024
    v_mfma_f32_32x32x16_bf16 v[80:95], v[52:55], a[92:95], v[80:95]
    ds_read_b128 a[72:75], v10 offset:8192
    buffer_load_dwordx4 v18, s[12:15], s42 offen offset:3072 lds
    v_add_u32 v18, 131072, v18
    v_mfma_f32_32x32x16_bf16 v[144:159], v[52:55], a[64:67], v[144:159]
    ds_read_b128 a[76:79], v10 offset:9216
    ds_read_b64_tr_b16 a[138:139], v16 offset:5120
    v_mfma_f32_32x32x16_bf16 v[208:223], v[52:55], a[68:71], v[208:223]
    s_add_u32 m0, s52, 40960
    ds_read_b128 a[80:83], v10 offset:10240
    buffer_load_dwordx4 v18, s[12:15], 0 offen offset:0 lds
    v_mfma_f32_32x32x16_bf16 v[96:111], v[56:59], a[92:95], v[96:111]
    ds_read_b64_tr_b16 a[140:141], v17 offset:1024
    ds_read_b64_tr_b16 a[142:143], v17 offset:5120
    v_mfma_f32_32x32x16_bf16 v[160:175], v[56:59], a[64:67], v[160:175]
    buffer_load_dwordx4 v18, s[12:15], s40 offen offset:1024 lds
    ds_read_b64_tr_b16 a[144:145], v16 offset:2048
    v_mfma_f32_32x32x16_bf16 v[224:239], v[56:59], a[68:71], v[224:239]
    s_waitcnt vmcnt(9)
    ds_read_b64_tr_b16 a[32:33], v4 offset:57344
    ds_read_b64_tr_b16 a[34:35], v4 offset:58368
    v_mfma_f32_32x32x16_bf16 v[112:127], v[60:63], a[92:95], v[112:127]
    ds_read_b64_tr_b16 a[36:37], v5 offset:57344
    buffer_load_dwordx4 v18, s[12:15], s41 offen offset:2048 lds
    v_mfma_f32_32x32x16_bf16 v[176:191], v[60:63], a[64:67], v[176:191]
    ds_read_b64_tr_b16 a[38:39], v5 offset:58368
    ds_read_b64_tr_b16 a[146:147], v16 offset:6144
    v_mfma_f32_32x32x16_bf16 v[240:255], v[60:63], a[68:71], v[240:255]
    ds_read_b64_tr_b16 a[40:41], v6 offset:57344
    ds_read_b64_tr_b16 a[42:43], v6 offset:58368
    buffer_load_dwordx4 v18, s[12:15], s42 offen offset:3072 lds
    s_waitcnt lgkmcnt(10)
    v_add_u32 v18, 131072, v18
    v_mfma_f32_32x32x16_bf16 v[64:79], v[32:35], a[72:75], v[64:79]
    ds_read_b64_tr_b16 a[44:45], v7 offset:57344
    ds_read_b64_tr_b16 a[148:149], v17 offset:2048
    v_mfma_f32_32x32x16_bf16 v[128:143], v[32:35], a[76:79], v[128:143]
    s_add_u32 m0, s52, 49152
    ds_read_b64_tr_b16 a[46:47], v7 offset:58368
    buffer_load_dwordx4 v18, s[12:15], 0 offen offset:0 lds
    v_mfma_f32_32x32x16_bf16 v[192:207], v[32:35], a[80:83], v[192:207]
    ds_read_b128 a[84:87], v11 offset:8192
    ds_read_b64_tr_b16 a[150:151], v17 offset:6144
    v_mfma_f32_32x32x16_bf16 v[80:95], v[36:39], a[72:75], v[80:95]
    ds_read_b128 a[88:91], v11 offset:9216
    buffer_load_dwordx4 v18, s[12:15], s40 offen offset:1024 lds
    v_mfma_f32_32x32x16_bf16 v[144:159], v[36:39], a[76:79], v[144:159]
    ds_read_b128 a[92:95], v11 offset:10240
    ds_read_b64_tr_b16 a[152:153], v16 offset:3072
    v_mfma_f32_32x32x16_bf16 v[208:223], v[36:39], a[80:83], v[208:223]
    buffer_load_dwordx4 v18, s[12:15], s41 offen offset:2048 lds
    ds_read_b64_tr_b16 a[154:155], v16 offset:7168
    v_mfma_f32_32x32x16_bf16 v[96:111], v[40:43], a[72:75], v[96:111]
    ds_read_b64_tr_b16 a[156:157], v17 offset:3072
    v_mfma_f32_32x32x16_bf16 v[160:175], v[40:43], a[76:79], v[160:175]
    s_waitcnt vmcnt(7)
    ds_read_b64_tr_b16 v[48:49], v4 offset:32768
    ds_read_b64_tr_b16 v[50:51], v4 offset:33792
    buffer_load_dwordx4 v18, s[12:15], s42 offen offset:3072 lds
    v_add_u32 v18, 131072, v18
    v_mfma_f32_32x32x16_bf16 v[224:239], v[40:43], a[80:83], v[224:239]
    ds_read_b64_tr_b16 v[52:53], v5 offset:32768
    ds_read_b64_tr_b16 a[158:159], v17 offset:7168
    v_mfma_f32_32x32x16_bf16 v[112:127], v[44:47], a[72:75], v[112:127]
    s_add_u32 m0, s52, 57344
    ds_read_b64_tr_b16 v[54:55], v5 offset:33792
    s_waitcnt lgkmcnt(9)
    buffer_load_dwordx4 v18, s[12:15], 0 offen offset:0 lds
    v_mfma_f32_32x32x16_bf16 v[176:191], v[44:47], a[76:79], v[176:191]
    ds_read_b64_tr_b16 v[56:57], v6 offset:32768
    ds_read_b64_tr_b16 v[58:59], v6 offset:33792
    v_mfma_f32_32x32x16_bf16 v[240:255], v[44:47], a[80:83], v[240:255]
    ds_read_b64_tr_b16 v[60:61], v7 offset:32768
    buffer_load_dwordx4 v18, s[12:15], s40 offen offset:1024 lds
    v_mfma_f32_32x32x16_bf16 v[64:79], a[32:35], a[84:87], v[64:79]
    s_waitcnt lgkmcnt(4)
    s_barrier
    ds_read_b64_tr_b16 v[62:63], v7 offset:33792
    v_mfma_f32_32x32x16_bf16 v[128:143], a[32:35], a[88:91], v[128:143]
    buffer_load_dwordx4 v18, s[12:15], s41 offen offset:2048 lds
    v_mfma_f32_32x32x16_bf16 v[192:207], a[32:35], a[92:95], v[192:207]
    ds_read_b128 a[64:67], v8 offset:0
    v_mfma_f32_32x32x16_bf16 v[80:95], a[36:39], a[84:87], v[80:95]
    ds_read_b128 a[68:71], v8 offset:1024
    buffer_load_dwordx4 v18, s[12:15], s42 offen offset:3072 lds
    v_add_u32 v18, 131072, v18
    v_mfma_f32_32x32x16_bf16 v[144:159], a[36:39], a[88:91], v[144:159]
    ds_read_b128 a[72:75], v8 offset:2048
    s_add_u32 m0, s53, 73728
    v_mfma_f32_32x32x16_bf16 v[208:223], a[36:39], a[92:95], v[208:223]
    buffer_load_dwordx4 v19, s[8:11], 0 offen offset:0 lds
    v_mfma_f32_32x32x16_bf16 v[96:111], a[40:43], a[84:87], v[96:111]
    s_waitcnt vmcnt(9)
    ds_read_b64_tr_b16 v[32:33], v4 offset:40960
    ds_read_b64_tr_b16 v[34:35], v4 offset:41984
    v_mfma_f32_32x32x16_bf16 v[160:175], a[40:43], a[88:91], v[160:175]
    ds_read_b64_tr_b16 v[36:37], v5 offset:40960
    buffer_load_dwordx4 v19, s[8:11], s43 offen offset:1024 lds
    v_mfma_f32_32x32x16_bf16 v[224:239], a[40:43], a[92:95], v[224:239]
    ds_read_b64_tr_b16 v[38:39], v5 offset:41984
    v_mfma_f32_32x32x16_bf16 v[112:127], a[44:47], a[84:87], v[112:127]
    ds_read_b64_tr_b16 v[40:41], v6 offset:40960
    ds_read_b64_tr_b16 v[42:43], v6 offset:41984
    buffer_load_dwordx4 v19, s[8:11], s44 offen offset:2048 lds
    v_add_u32 v19, 128, v19
    v_mfma_f32_32x32x16_bf16 v[176:191], a[44:47], a[88:91], v[176:191]
    ds_read_b64_tr_b16 v[44:45], v7 offset:40960
    v_mfma_f32_32x32x16_bf16 v[240:255], a[44:47], a[92:95], v[240:255]
    s_add_u32 m0, s52, 32768
    ds_read_b64_tr_b16 v[46:47], v7 offset:41984
    s_waitcnt lgkmcnt(8)
    buffer_load_dwordx4 v18, s[12:15], 0 offen offset:0 lds
    v_mfma_f32_32x32x16_bf16 v[64:79], v[48:51], a[64:67], v[64:79]
    v_mfma_f32_32x32x16_bf16 v[128:143], v[48:51], a[68:71], v[128:143]
    buffer_load_dwordx4 v18, s[12:15], s40 offen offset:1024 lds
    v_mfma_f32_32x32x16_bf16 v[192:207], v[48:51], a[72:75], v[192:207]
    ds_read_b128 a[76:79], v9 offset:0
    v_mfma_f32_32x32x16_bf16 v[80:95], v[52:55], a[64:67], v[80:95]
    ds_read_b128 a[80:83], v9 offset:1024
    buffer_load_dwordx4 v18, s[12:15], s41 offen offset:2048 lds
    v_mfma_f32_32x32x16_bf16 v[144:159], v[52:55], a[68:71], v[144:159]
    ds_read_b128 a[84:87], v9 offset:2048
    v_mfma_f32_32x32x16_bf16 v[208:223], v[52:55], a[72:75], v[208:223]
    s_waitcnt vmcnt(10)
    ds_read_b64_tr_b16 a[32:33], v4 offset:49152
    ds_read_b64_tr_b16 a[34:35], v4 offset:50176
    buffer_load_dwordx4 v18, s[12:15], s42 offen offset:3072 lds
    v_add_u32 v18, 131072, v18
    v_mfma_f32_32x32x16_bf16 v[96:111], v[56:59], a[64:67], v[96:111]
    ds_read_b64_tr_b16 a[36:37], v5 offset:49152
    v_mfma_f32_32x32x16_bf16 v[160:175], v[56:59], a[68:71], v[160:175]
    s_add_u32 m0, s52, 40960
    ds_read_b64_tr_b16 a[38:39], v5 offset:50176
    s_waitcnt lgkmcnt(7)
    buffer_load_dwordx4 v18, s[12:15], 0 offen offset:0 lds
    v_mfma_f32_32x32x16_bf16 v[224:239], v[56:59], a[72:75], v[224:239]
    ds_read_b64_tr_b16 a[40:41], v6 offset:49152
    ds_read_b64_tr_b16 a[42:43], v6 offset:50176
    v_mfma_f32_32x32x16_bf16 v[112:127], v[60:63], a[64:67], v[112:127]
    ds_read_b64_tr_b16 a[44:45], v7 offset:49152
    buffer_load_dwordx4 v18, s[12:15], s40 offen offset:1024 lds
    v_mfma_f32_32x32x16_bf16 v[176:191], v[60:63], a[68:71], v[176:191]
    ds_read_b64_tr_b16 a[46:47], v7 offset:50176
    v_mfma_f32_32x32x16_bf16 v[240:255], v[60:63], a[72:75], v[240:255]
    buffer_load_dwordx4 v18, s[12:15], s41 offen offset:2048 lds
    s_waitcnt lgkmcnt(8)
    v_mfma_f32_32x32x16_bf16 v[64:79], v[32:35], a[76:79], v[64:79]
    v_mfma_f32_32x32x16_bf16 v[128:143], v[32:35], a[80:83], v[128:143]
    buffer_load_dwordx4 v18, s[12:15], s42 offen offset:3072 lds
    v_add_u32 v18, 131072, v18
    v_mfma_f32_32x32x16_bf16 v[192:207], v[32:35], a[84:87], v[192:207]
    ds_read_b128 a[88:91], v10 offset:0
    v_mfma_f32_32x32x16_bf16 v[80:95], v[36:39], a[76:79], v[80:95]
    s_add_u32 m0, s52, 49152
    ds_read_b128 a[92:95], v10 offset:1024
    s_waitcnt lgkmcnt(2)
    buffer_load_dwordx4 v18, s[12:15], 0 offen offset:0 lds
    v_mfma_f32_32x32x16_bf16 v[144:159], v[36:39], a[80:83], v[144:159]
    ds_read_b128 a[64:67], v10 offset:2048
    v_mfma_f32_32x32x16_bf16 v[208:223], v[36:39], a[84:87], v[208:223]
    s_waitcnt vmcnt(12)
    ds_read_b64_tr_b16 v[48:49], v4 offset:57344
    ds_read_b64_tr_b16 v[50:51], v4 offset:58368
    buffer_load_dwordx4 v18, s[12:15], s40 offen offset:1024 lds
    v_mfma_f32_32x32x16_bf16 v[96:111], v[40:43], a[76:79], v[96:111]
    ds_read_b64_tr_b16 v[52:53], v5 offset:57344
    v_mfma_f32_32x32x16_bf16 v[160:175], v[40:43], a[80:83], v[160:175]
    ds_read_b64_tr_b16 v[54:55], v5 offset:58368
    buffer_load_dwordx4 v18, s[12:15], s41 offen offset:2048 lds
    v_mfma_f32_32x32x16_bf16 v[224:239], v[40:43], a[84:87], v[224:239]
    ds_read_b64_tr_b16 v[56:57], v6 offset:57344
    ds_read_b64_tr_b16 v[58:59], v6 offset:58368
    v_mfma_f32_32x32x16_bf16 v[112:127], v[44:47], a[76:79], v[112:127]
    ds_read_b64_tr_b16 v[60:61], v7 offset:57344
    buffer_load_dwordx4 v18, s[12:15], s42 offen offset:3072 lds
    v_add_u32 v18, 131072, v18
    v_mfma_f32_32x32x16_bf16 v[176:191], v[44:47], a[80:83], v[176:191]
    ds_read_b64_tr_b16 v[62:63], v7 offset:58368
    v_mfma_f32_32x32x16_bf16 v[240:255], v[44:47], a[84:87], v[240:255]
    s_waitcnt lgkmcnt(8)
    v_mfma_f32_32x32x16_bf16 v[64:79], a[32:35], a[88:91], v[64:79]
    v_mfma_f32_32x32x16_bf16 v[128:143], a[32:35], a[92:95], v[128:143]
    v_mfma_f32_32x32x16_bf16 v[192:207], a[32:35], a[64:67], v[192:207]
    s_add_u32 m0, s52, 57344
    ds_read_b128 a[68:71], v11 offset:0
    s_waitcnt lgkmcnt(1)
    buffer_load_dwordx4 v18, s[12:15], 0 offen offset:0 lds
    v_mfma_f32_32x32x16_bf16 v[80:95], a[36:39], a[88:91], v[80:95]
    ds_read_b128 a[72:75], v11 offset:1024
    v_mfma_f32_32x32x16_bf16 v[144:159], a[36:39], a[92:95], v[144:159]
    s_waitcnt vmcnt(9)
    ds_read_b64_tr_b16 v[32:33], v4 offset:32768
    ds_read_b64_tr_b16 v[34:35], v4 offset:33792
    buffer_load_dwordx4 v18, s[12:15], s40 offen offset:1024 lds
    v_mfma_f32_32x32x16_bf16 v[208:223], a[36:39], a[64:67], v[208:223]
    ds_read_b64_tr_b16 v[36:37], v5 offset:32768
    v_mfma_f32_32x32x16_bf16 v[96:111], a[40:43], a[88:91], v[96:111]
    ds_read_b64_tr_b16 v[38:39], v5 offset:33792
    buffer_load_dwordx4 v18, s[12:15], s41 offen offset:2048 lds
    v_mfma_f32_32x32x16_bf16 v[160:175], a[40:43], a[92:95], v[160:175]
    ds_read_b64_tr_b16 v[40:41], v6 offset:32768
    ds_read_b64_tr_b16 v[42:43], v6 offset:33792
    v_mfma_f32_32x32x16_bf16 v[224:239], a[40:43], a[64:67], v[224:239]
    ds_read_b64_tr_b16 v[44:45], v7 offset:32768
    buffer_load_dwordx4 v18, s[12:15], s42 offen offset:3072 lds
    v_add_u32 v18, 131072, v18
    v_mfma_f32_32x32x16_bf16 v[112:127], a[44:47], a[88:91], v[112:127]
    ds_read_b64_tr_b16 v[46:47], v7 offset:33792
    v_mfma_f32_32x32x16_bf16 v[176:191], a[44:47], a[92:95], v[176:191]
    ds_read_b128 a[76:79], v11 offset:2048
    v_mfma_f32_32x32x16_bf16 v[240:255], a[44:47], a[64:67], v[240:255]
    s_waitcnt lgkmcnt(7)
    v_mfma_f32_32x32x16_bf16 v[64:79], v[48:51], a[68:71], v[64:79]
    s_waitcnt lgkmcnt(0)
    s_barrier
    s_add_u32 m0, s53, 65536
    v_mfma_f32_32x32x16_bf16 v[128:143], v[48:51], a[72:75], v[128:143]
    buffer_load_dwordx4 v19, s[8:11], 0 offen offset:0 lds
    v_mfma_f32_32x32x16_bf16 v[192:207], v[48:51], a[76:79], v[192:207]
    ds_read_b128 a[80:83], v8 offset:8192
    v_mfma_f32_32x32x16_bf16 v[80:95], v[52:55], a[68:71], v[80:95]
    s_waitcnt vmcnt(9)
    ds_read_b64_tr_b16 a[32:33], v4 offset:40960
    ds_read_b64_tr_b16 a[34:35], v4 offset:41984
    buffer_load_dwordx4 v19, s[8:11], s43 offen offset:1024 lds
    v_mfma_f32_32x32x16_bf16 v[144:159], v[52:55], a[72:75], v[144:159]
    ds_read_b64_tr_b16 a[36:37], v5 offset:40960
    v_mfma_f32_32x32x16_bf16 v[208:223], v[52:55], a[76:79], v[208:223]
    ds_read_b64_tr_b16 a[38:39], v5 offset:41984
    buffer_load_dwordx4 v19, s[8:11], s44 offen offset:2048 lds
    v_add_u32 v19, 128, v19
    v_mfma_f32_32x32x16_bf16 v[96:111], v[56:59], a[68:71], v[96:111]
    ds_read_b64_tr_b16 a[40:41], v6 offset:40960
    ds_read_b64_tr_b16 a[42:43], v6 offset:41984
    v_mfma_f32_32x32x16_bf16 v[160:175], v[56:59], a[72:75], v[160:175]
    s_add_u32 m0, s52, 8192
    ds_read_b64_tr_b16 a[44:45], v7 offset:40960
    buffer_load_dwordx4 v20, s[16:19], s45 offen offset:0 nt lds
    v_mfma_f32_32x32x16_bf16 v[224:239], v[56:59], a[76:79], v[224:239]
    ds_read_b64_tr_b16 a[46:47], v7 offset:41984
    v_mfma_f32_32x32x16_bf16 v[112:127], v[60:63], a[68:71], v[112:127]
    ds_read_b128 a[84:87], v8 offset:9216
    buffer_load_dwordx4 v20, s[16:19], s46 offen offset:1024 nt lds
    v_mfma_f32_32x32x16_bf16 v[176:191], v[60:63], a[72:75], v[176:191]
    ds_read_b128 a[88:91], v8 offset:10240
    v_mfma_f32_32x32x16_bf16 v[240:255], v[60:63], a[76:79], v[240:255]
    buffer_load_dwordx4 v20, s[16:19], s47 offen offset:2048 nt lds
    s_waitcnt lgkmcnt(7)
    v_mfma_f32_32x32x16_bf16 v[64:79], v[32:35], a[80:83], v[64:79]
    s_waitcnt lgkmcnt(1)
    v_mfma_f32_32x32x16_bf16 v[128:143], v[32:35], a[84:87], v[128:143]
    buffer_load_dwordx4 v20, s[16:19], s48 offen offset:3072 nt lds
    s_waitcnt lgkmcnt(0)
    v_xor_b32 v20, 24576, v20
    v_mfma_f32_32x32x16_bf16 v[192:207], v[32:35], a[88:91], v[192:207]
    s_waitcnt vmcnt(11)
    ds_read_b64_tr_b16 v[48:49], v4 offset:49152
    ds_read_b64_tr_b16 v[50:51], v4 offset:50176
    v_mfma_f32_32x32x16_bf16 v[80:95], v[36:39], a[80:83], v[80:95]
    s_add_u32 m0, s52, 32768
    ds_read_b64_tr_b16 v[52:53], v5 offset:49152
    buffer_load_dwordx4 v18, s[12:15], 0 offen offset:0 lds
    v_mfma_f32_32x32x16_bf16 v[144:159], v[36:39], a[84:87], v[144:159]
    ds_read_b64_tr_b16 v[54:55], v5 offset:50176
    v_mfma_f32_32x32x16_bf16 v[208:223], v[36:39], a[88:91], v[208:223]
    ds_read_b64_tr_b16 v[56:57], v6 offset:49152
    ds_read_b64_tr_b16 v[58:59], v6 offset:50176
    buffer_load_dwordx4 v18, s[12:15], s40 offen offset:1024 lds
    v_mfma_f32_32x32x16_bf16 v[96:111], v[40:43], a[80:83], v[96:111]
    ds_read_b64_tr_b16 v[60:61], v7 offset:49152
    v_mfma_f32_32x32x16_bf16 v[160:175], v[40:43], a[84:87], v[160:175]
    ds_read_b64_tr_b16 v[62:63], v7 offset:50176
    buffer_load_dwordx4 v18, s[12:15], s41 offen offset:2048 lds
    v_mfma_f32_32x32x16_bf16 v[224:239], v[40:43], a[88:91], v[224:239]
    ds_read_b128 a[92:95], v9 offset:8192
    v_mfma_f32_32x32x16_bf16 v[112:127], v[44:47], a[80:83], v[112:127]
    ds_read_b128 a[64:67], v9 offset:9216
    buffer_load_dwordx4 v18, s[12:15], s42 offen offset:3072 lds
    v_add_u32 v18, 131072, v18
    v_mfma_f32_32x32x16_bf16 v[176:191], v[44:47], a[84:87], v[176:191]
    ds_read_b128 a[68:71], v9 offset:10240
    s_add_u32 m0, s52, 40960
    v_mfma_f32_32x32x16_bf16 v[240:255], v[44:47], a[88:91], v[240:255]
    buffer_load_dwordx4 v18, s[12:15], 0 offen offset:0 lds
    s_waitcnt lgkmcnt(2)
    v_mfma_f32_32x32x16_bf16 v[64:79], a[32:35], a[92:95], v[64:79]
    s_waitcnt lgkmcnt(1)
    v_mfma_f32_32x32x16_bf16 v[128:143], a[32:35], a[64:67], v[128:143]
    s_waitcnt vmcnt(12)
    ds_read_b64_tr_b16 v[32:33], v4 offset:57344
    ds_read_b64_tr_b16 v[34:35], v4 offset:58368
    buffer_load_dwordx4 v18, s[12:15], s40 offen offset:1024 lds
    s_waitcnt lgkmcnt(2)
    v_mfma_f32_32x32x16_bf16 v[192:207], a[32:35], a[68:71], v[192:207]
    ds_read_b64_tr_b16 v[36:37], v5 offset:57344
    v_mfma_f32_32x32x16_bf16 v[80:95], a[36:39], a[92:95], v[80:95]
    ds_read_b64_tr_b16 v[38:39], v5 offset:58368
    buffer_load_dwordx4 v18, s[12:15], s41 offen offset:2048 lds
    v_mfma_f32_32x32x16_bf16 v[144:159], a[36:39], a[64:67], v[144:159]
    ds_read_b64_tr_b16 v[40:41], v6 offset:57344
    ds_read_b64_tr_b16 v[42:43], v6 offset:58368
    v_mfma_f32_32x32x16_bf16 v[208:223], a[36:39], a[68:71], v[208:223]
    ds_read_b64_tr_b16 v[44:45], v7 offset:57344
    buffer_load_dwordx4 v18, s[12:15], s42 offen offset:3072 lds
    v_add_u32 v18, 131072, v18
    v_mfma_f32_32x32x16_bf16 v[96:111], a[40:43], a[92:95], v[96:111]
    ds_read_b64_tr_b16 v[46:47], v7 offset:58368
    v_mfma_f32_32x32x16_bf16 v[160:175], a[40:43], a[64:67], v[160:175]
    s_add_u32 m0, s52, 49152
    ds_read_b128 a[72:75], v10 offset:8192
    buffer_load_dwordx4 v18, s[12:15], 0 offen offset:0 lds
    v_mfma_f32_32x32x16_bf16 v[224:239], a[40:43], a[68:71], v[224:239]
    ds_read_b128 a[76:79], v10 offset:9216
    v_mfma_f32_32x32x16_bf16 v[112:127], a[44:47], a[92:95], v[112:127]
    ds_read_b128 a[80:83], v10 offset:10240
    buffer_load_dwordx4 v18, s[12:15], s40 offen offset:1024 lds
    v_mfma_f32_32x32x16_bf16 v[176:191], a[44:47], a[64:67], v[176:191]
    v_mfma_f32_32x32x16_bf16 v[240:255], a[44:47], a[68:71], v[240:255]
    buffer_load_dwordx4 v18, s[12:15], s41 offen offset:2048 lds
    s_waitcnt lgkmcnt(2)
    v_mfma_f32_32x32x16_bf16 v[64:79], v[48:51], a[72:75], v[64:79]
    s_waitcnt lgkmcnt(1)
    v_mfma_f32_32x32x16_bf16 v[128:143], v[48:51], a[76:79], v[128:143]
    s_waitcnt vmcnt(7)
    ds_read_b64_tr_b16 a[48:49], v4 offset:32768
    ds_read_b64_tr_b16 a[50:51], v4 offset:33792
    buffer_load_dwordx4 v18, s[12:15], s42 offen offset:3072 lds
    s_waitcnt lgkmcnt(2)
    v_add_u32 v18, 131072, v18
    v_mfma_f32_32x32x16_bf16 v[192:207], v[48:51], a[80:83], v[192:207]
    ds_read_b64_tr_b16 a[52:53], v5 offset:32768
    v_mfma_f32_32x32x16_bf16 v[80:95], v[52:55], a[72:75], v[80:95]
    s_add_u32 m0, s52, 57344
    ds_read_b64_tr_b16 a[54:55], v5 offset:33792
    buffer_load_dwordx4 v18, s[12:15], 0 offen offset:0 lds
    v_mfma_f32_32x32x16_bf16 v[144:159], v[52:55], a[76:79], v[144:159]
    ds_read_b64_tr_b16 a[56:57], v6 offset:32768
    ds_read_b64_tr_b16 a[58:59], v6 offset:33792
    v_mfma_f32_32x32x16_bf16 v[208:223], v[52:55], a[80:83], v[208:223]
    ds_read_b64_tr_b16 a[60:61], v7 offset:32768
    buffer_load_dwordx4 v18, s[12:15], s40 offen offset:1024 lds
    v_mfma_f32_32x32x16_bf16 v[96:111], v[56:59], a[72:75], v[96:111]
    ds_read_b64_tr_b16 a[62:63], v7 offset:33792
    v_mfma_f32_32x32x16_bf16 v[160:175], v[56:59], a[76:79], v[160:175]
    ds_read_b128 a[84:87], v11 offset:8192
    buffer_load_dwordx4 v18, s[12:15], s41 offen offset:2048 lds
    v_mfma_f32_32x32x16_bf16 v[224:239], v[56:59], a[80:83], v[224:239]
    ds_read_b128 a[88:91], v11 offset:9216
    v_mfma_f32_32x32x16_bf16 v[112:127], v[60:63], a[72:75], v[112:127]
    ds_read_b128 a[92:95], v11 offset:10240
    buffer_load_dwordx4 v18, s[12:15], s42 offen offset:3072 lds
    v_add_u32 v18, 131072, v18
    v_mfma_f32_32x32x16_bf16 v[176:191], v[60:63], a[76:79], v[176:191]
    s_add_u32 m0, s52, 32768
    v_mfma_f32_32x32x16_bf16 v[240:255], v[60:63], a[80:83], v[240:255]
    s_waitcnt lgkmcnt(3)
    buffer_load_dwordx4 v18, s[12:15], 0 offen offset:0 lds
    s_waitcnt lgkmcnt(2)
    v_mfma_f32_32x32x16_bf16 v[64:79], v[32:35], a[84:87], v[64:79]
    s_waitcnt lgkmcnt(0)
    s_barrier
    v_mfma_f32_32x32x16_bf16 v[128:143], v[32:35], a[88:91], v[128:143]
    s_waitcnt vmcnt(9)
    ds_read_b64_tr_b16 a[32:33], v4 offset:40960
    ds_read_b64_tr_b16 a[34:35], v4 offset:41984
    buffer_load_dwordx4 v18, s[12:15], s40 offen offset:1024 lds
    v_mfma_f32_32x32x16_bf16 v[192:207], v[32:35], a[92:95], v[192:207]
    ds_read_b64_tr_b16 a[36:37], v5 offset:40960
    ds_read_b64_tr_b16 a[38:39], v5 offset:41984
    v_mfma_f32_32x32x16_bf16 v[80:95], v[36:39], a[84:87], v[80:95]
    ds_read_b64_tr_b16 a[40:41], v6 offset:40960
    ds_read_b64_tr_b16 a[42:43], v6 offset:41984
    buffer_load_dwordx4 v18, s[12:15], s41 offen offset:2048 lds
    v_mfma_f32_32x32x16_bf16 v[144:159], v[36:39], a[88:91], v[144:159]
    ds_read_b64_tr_b16 a[44:45], v7 offset:40960
    ds_read_b128 a[160:163], v12 offset:8192
    v_mfma_f32_32x32x16_bf16 v[208:223], v[36:39], a[92:95], v[208:223]
    ds_read_b64_tr_b16 a[46:47], v7 offset:41984
    buffer_load_dwordx4 v18, s[12:15], s42 offen offset:3072 lds
    v_add_u32 v18, 131072, v18
    v_mfma_f32_32x32x16_bf16 v[96:111], v[40:43], a[84:87], v[96:111]
    ds_read_b128 a[64:67], v8 offset:0
    ds_read_b128 a[164:167], v13 offset:8192
    v_mfma_f32_32x32x16_bf16 v[160:175], v[40:43], a[88:91], v[160:175]
    s_add_u32 m0, s53, 73728
    ds_read_b128 a[68:71], v8 offset:1024
    buffer_load_dwordx4 v19, s[8:11], 0 offen offset:0 lds
    v_mfma_f32_32x32x16_bf16 v[224:239], v[40:43], a[92:95], v[224:239]
    ds_read_b128 a[72:75], v8 offset:2048
    v_mfma_f32_32x32x16_bf16 v[112:127], v[44:47], a[84:87], v[112:127]
    buffer_load_dwordx4 v19, s[8:11], s43 offen offset:1024 lds
    v_mfma_f32_32x32x16_bf16 v[176:191], v[44:47], a[88:91], v[176:191]
    v_mfma_f32_32x32x16_bf16 v[240:255], v[44:47], a[92:95], v[240:255]
    s_waitcnt vmcnt(10)
    ds_read_b64_tr_b16 v[48:49], v4 offset:49152
    ds_read_b64_tr_b16 v[50:51], v4 offset:50176
    buffer_load_dwordx4 v19, s[8:11], s44 offen offset:2048 lds
    s_waitcnt lgkmcnt(5)
    v_add_u32 v19, 128, v19
    v_mfma_f32_32x32x16_bf16 v[64:79], a[48:51], a[64:67], v[64:79]
    ds_read_b64_tr_b16 v[52:53], v5 offset:49152
    ds_read_b128 a[168:171], v14 offset:8192
    s_waitcnt lgkmcnt(5)
    v_mfma_f32_32x32x16_bf16 v[128:143], a[48:51], a[68:71], v[128:143]
    s_add_u32 m0, s52, 24576
    ds_read_b64_tr_b16 v[54:55], v5 offset:50176
    buffer_load_dwordx4 v21, s[20:23], s45 offen offset:0 nt lds
    s_waitcnt lgkmcnt(5)
    v_mfma_f32_32x32x16_bf16 v[192:207], a[48:51], a[72:75], v[192:207]
    ds_read_b64_tr_b16 v[56:57], v6 offset:49152
    ds_read_b64_tr_b16 v[58:59], v6 offset:50176
    v_mfma_f32_32x32x16_bf16 v[80:95], a[52:55], a[64:67], v[80:95]
    ds_read_b64_tr_b16 v[60:61], v7 offset:49152
    buffer_load_dwordx4 v21, s[20:23], s46 offen offset:1024 nt lds
    v_mfma_f32_32x32x16_bf16 v[144:159], a[52:55], a[68:71], v[144:159]
    ds_read_b64_tr_b16 v[62:63], v7 offset:50176
    v_mfma_f32_32x32x16_bf16 v[208:223], a[52:55], a[72:75], v[208:223]
    ds_read_b128 a[76:79], v9 offset:0
    buffer_load_dwordx4 v21, s[20:23], s47 offen offset:2048 nt lds
    v_mfma_f32_32x32x16_bf16 v[96:111], a[56:59], a[64:67], v[96:111]
    ds_read_b128 a[80:83], v9 offset:1024
    ds_read_b128 a[172:175], v15 offset:8192
    v_mfma_f32_32x32x16_bf16 v[160:175], a[56:59], a[68:71], v[160:175]
    ds_read_b128 a[84:87], v9 offset:2048
    buffer_load_dwordx4 v21, s[20:23], s48 offen offset:3072 nt lds
    v_xor_b32 v21, 24576, v21
    v_mfma_f32_32x32x16_bf16 v[224:239], a[56:59], a[72:75], v[224:239]
    s_add_u32 m0, s52, 40960
    v_mfma_f32_32x32x16_bf16 v[112:127], a[60:63], a[64:67], v[112:127]
    buffer_load_dwordx4 v18, s[12:15], 0 offen offset:0 lds
    v_mfma_f32_32x32x16_bf16 v[176:191], a[60:63], a[68:71], v[176:191]
    s_waitcnt vmcnt(12)
    ds_read_b64_tr_b16 v[32:33], v4 offset:57344
    ds_read_b64_tr_b16 v[34:35], v4 offset:58368
    v_mfma_f32_32x32x16_bf16 v[240:255], a[60:63], a[72:75], v[240:255]
    ds_read_b64_tr_b16 v[36:37], v5 offset:57344
    buffer_load_dwordx4 v18, s[12:15], s40 offen offset:1024 lds
    s_waitcnt lgkmcnt(6)
    v_mfma_f32_32x32x16_bf16 v[64:79], a[32:35], a[76:79], v[64:79]
    ds_read_b64_tr_b16 v[38:39], v5 offset:58368
    ds_read_b128 a[176:179], v12 offset:9216
    s_waitcnt lgkmcnt(7)
    v_mfma_f32_32x32x16_bf16 v[128:143], a[32:35], a[80:83], v[128:143]
    ds_read_b64_tr_b16 v[40:41], v6 offset:57344
    ds_read_b64_tr_b16 v[42:43], v6 offset:58368
    buffer_load_dwordx4 v18, s[12:15], s41 offen offset:2048 lds
    s_waitcnt lgkmcnt(7)
    v_mfma_f32_32x32x16_bf16 v[192:207], a[32:35], a[84:87], v[192:207]
    ds_read_b64_tr_b16 v[44:45], v7 offset:57344
    v_mfma_f32_32x32x16_bf16 v[80:95], a[36:39], a[76:79], v[80:95]
    ds_read_b64_tr_b16 v[46:47], v7 offset:58368
    buffer_load_dwordx4 v18, s[12:15], s42 offen offset:3072 lds
    v_add_u32 v18, 131072, v18
    v_mfma_f32_32x32x16_bf16 v[144:159], a[36:39], a[80:83], v[144:159]
    ds_read_b128 a[88:91], v10 offset:0
    ds_read_b128 a[180:183], v13 offset:9216
    v_mfma_f32_32x32x16_bf16 v[208:223], a[36:39], a[84:87], v[208:223]
    s_add_u32 m0, s52, 49152
    ds_read_b128 a[92:95], v10 offset:1024
    buffer_load_dwordx4 v18, s[12:15], 0 offen offset:0 lds
    v_mfma_f32_32x32x16_bf16 v[96:111], a[40:43], a[76:79], v[96:111]
    ds_read_b128 a[64:67], v10 offset:2048
    v_mfma_f32_32x32x16_bf16 v[160:175], a[40:43], a[80:83], v[160:175]
    buffer_load_dwordx4 v18, s[12:15], s40 offen offset:1024 lds
    v_mfma_f32_32x32x16_bf16 v[224:239], a[40:43], a[84:87], v[224:239]
    v_mfma_f32_32x32x16_bf16 v[112:127], a[44:47], a[76:79], v[112:127]
    s_waitcnt vmcnt(13)
    ds_read_b64_tr_b16 a[48:49], v4 offset:32768
    ds_read_b64_tr_b16 a[50:51], v4 offset:33792
    buffer_load_dwordx4 v18, s[12:15], s41 offen offset:2048 lds
    v_mfma_f32_32x32x16_bf16 v[176:191], a[44:47], a[80:83], v[176:191]
    ds_read_b64_tr_b16 a[52:53], v5 offset:32768
    ds_read_b128 a[184:187], v14 offset:9216
    v_mfma_f32_32x32x16_bf16 v[240:255], a[44:47], a[84:87], v[240:255]
    ds_read_b64_tr_b16 a[54:55], v5 offset:33792
    buffer_load_dwordx4 v18, s[12:15], s42 offen offset:3072 lds
    s_waitcnt lgkmcnt(6)
    v_add_u32 v18, 131072, v18
    v_mfma_f32_32x32x16_bf16 v[64:79], v[48:51], a[88:91], v[64:79]
    ds_read_b64_tr_b16 a[56:57], v6 offset:32768
    ds_read_b64_tr_b16 a[58:59], v6 offset:33792
    v_mfma_f32_32x32x16_bf16 v[128:143], v[48:51], a[92:95], v[128:143]
    s_add_u32 m0, s52, 57344
    ds_read_b64_tr_b16 a[60:61], v7 offset:32768
    buffer_load_dwordx4 v18, s[12:15], 0 offen offset:0 lds
    s_waitcnt lgkmcnt(8)
    v_mfma_f32_32x32x16_bf16 v[192:207], v[48:51], a[64:67], v[192:207]
    ds_read_b64_tr_b16 a[62:63], v7 offset:33792
    v_mfma_f32_32x32x16_bf16 v[80:95], v[52:55], a[88:91], v[80:95]
    ds_read_b128 a[68:71], v11 offset:0
    buffer_load_dwordx4 v18, s[12:15], s40 offen offset:1024 lds
    v_mfma_f32_32x32x16_bf16 v[144:159], v[52:55], a[92:95], v[144:159]
    ds_read_b128 a[72:75], v11 offset:1024
    ds_read_b128 a[188:191], v15 offset:9216
    v_mfma_f32_32x32x16_bf16 v[208:223], v[52:55], a[64:67], v[208:223]
    ds_read_b128 a[76:79], v11 offset:2048
    buffer_load_dwordx4 v18, s[12:15], s41 offen offset:2048 lds
    v_mfma_f32_32x32x16_bf16 v[96:111], v[56:59], a[88:91], v[96:111]
    v_mfma_f32_32x32x16_bf16 v[160:175], v[56:59], a[92:95], v[160:175]
    buffer_load_dwordx4 v18, s[12:15], s42 offen offset:3072 lds
    v_add_u32 v18, 131072, v18
    v_mfma_f32_32x32x16_bf16 v[224:239], v[56:59], a[64:67], v[224:239]
    v_mfma_f32_32x32x16_bf16 v[112:127], v[60:63], a[88:91], v[112:127]
    s_add_u32 m0, s52, 32768
    s_waitcnt vmcnt(8)
    ds_read_b64_tr_b16 a[32:33], v4 offset:40960
    ds_read_b64_tr_b16 a[34:35], v4 offset:41984
    s_waitcnt lgkmcnt(5)
    buffer_load_dwordx4 v18, s[12:15], 0 offen offset:0 lds
    v_mfma_f32_32x32x16_bf16 v[176:191], v[60:63], a[92:95], v[176:191]
    ds_read_b64_tr_b16 a[36:37], v5 offset:40960
    v_mfma_f32_32x32x16_bf16 v[240:255], v[60:63], a[64:67], v[240:255]
    ds_read_b64_tr_b16 a[38:39], v5 offset:41984
    buffer_load_dwordx4 v18, s[12:15], s40 offen offset:1024 lds
    v_mfma_f32_32x32x16_bf16 v[64:79], v[32:35], a[68:71], v[64:79]
    s_waitcnt lgkmcnt(4)
    s_barrier
    v_mfma_f32_32x32x16_bf16 v[128:143], v[32:35], a[72:75], v[128:143]
    ds_read_b64_tr_b16 a[40:41], v6 offset:40960
    ds_read_b64_tr_b16 a[42:43], v6 offset:41984
    buffer_load_dwordx4 v18, s[12:15], s41 offen offset:2048 lds
    v_mfma_f32_32x32x16_bf16 v[192:207], v[32:35], a[76:79], v[192:207]
    ds_read_b64_tr_b16 a[44:45], v7 offset:40960
    ds_read_b64_tr_b16 a[46:47], v7 offset:41984
    v_mfma_f32_32x32x16_bf16 v[80:95], v[36:39], a[68:71], v[80:95]
    ds_read_b128 a[80:83], v8 offset:8192
    buffer_load_dwordx4 v18, s[12:15], s42 offen offset:3072 lds
    v_add_u32 v18, 131072, v18
    v_mfma_f32_32x32x16_bf16 v[144:159], v[36:39], a[72:75], v[144:159]
    ds_read_b128 a[84:87], v8 offset:9216
    ds_read_b64_tr_b16 a[192:193], v16 offset:8192
    v_mfma_f32_32x32x16_bf16 v[208:223], v[36:39], a[76:79], v[208:223]
    s_add_u32 m0, s53, 65536
    ds_read_b128 a[88:91], v8 offset:10240
    buffer_load_dwordx4 v19, s[8:11], 0 offen offset:0 lds
    v_mfma_f32_32x32x16_bf16 v[96:111], v[40:43], a[68:71], v[96:111]
    ds_read_b64_tr_b16 a[194:195], v16 offset:12288
    ds_read_b64_tr_b16 a[196:197], v17 offset:8192
    v_mfma_f32_32x32x16_bf16 v[160:175], v[40:43], a[72:75], v[160:175]
    buffer_load_dwordx4 v19, s[8:11], s43 offen offset:1024 lds
    v_mfma_f32_32x32x16_bf16 v[224:239], v[40:43], a[76:79], v[224:239]
    s_waitcnt vmcnt(10)
    ds_read_b64_tr_b16 v[48:49], v4 offset:49152
    ds_read_b64_tr_b16 v[50:51], v4 offset:50176
    v_mfma_f32_32x32x16_bf16 v[112:127], v[44:47], a[68:71], v[112:127]
    ds_read_b64_tr_b16 v[52:53], v5 offset:49152
    buffer_load_dwordx4 v19, s[8:11], s44 offen offset:2048 lds
    v_add_u32 v19, 128, v19
    v_mfma_f32_32x32x16_bf16 v[176:191], v[44:47], a[72:75], v[176:191]
    ds_read_b64_tr_b16 v[54:55], v5 offset:50176
    ds_read_b64_tr_b16 a[198:199], v17 offset:12288
    v_mfma_f32_32x32x16_bf16 v[240:255], v[44:47], a[76:79], v[240:255]
    s_add_u32 m0, s52, 0
    ds_read_b64_tr_b16 v[56:57], v6 offset:49152
    ds_read_b64_tr_b16 v[58:59], v6 offset:50176
    buffer_load_dwordx4 v20, s[16:19], s45 offen offset:0 nt lds
    s_waitcnt lgkmcnt(9)
    v_mfma_f32_32x32x16_bf16 v[64:79], a[48:51], a[80:83], v[64:79]
    ds_read_b64_tr_b16 v[60:61], v7 offset:49152
    ds_read_b64_tr_b16 a[200:201], v16 offset:9216
    v_mfma_f32_32x32x16_bf16 v[128:143], a[48:51], a[84:87], v[128:143]
    ds_read_b64_tr_b16 v[62:63], v7 offset:50176
    buffer_load_dwordx4 v20, s[16:19], s46 offen offset:1024 nt lds
    v_mfma_f32_32x32x16_bf16 v[192:207], a[48:51], a[88:91], v[192:207]
    ds_read_b128 a[92:95], v9 offset:8192
    ds_read_b64_tr_b16 a[202:203], v16 offset:13312
    v_mfma_f32_32x32x16_bf16 v[80:95], a[52:55], a[80:83], v[80:95]
    ds_read_b128 a[64:67], v9 offset:9216
    buffer_load_dwordx4 v20, s[16:19], s47 offen offset:2048 nt lds
    v_mfma_f32_32x32x16_bf16 v[144:159], a[52:55], a[84:87], v[144:159]
    ds_read_b128 a[68:71], v9 offset:10240
    v_mfma_f32_32x32x16_bf16 v[208:223], a[52:55], a[88:91], v[208:223]
    buffer_load_dwordx4 v20, s[16:19], s48 offen offset:3072 nt lds
    ds_read_b64_tr_b16 a[204:205], v17 offset:9216
    v_xor_b32 v20, 8192, v20
    v_mfma_f32_32x32x16_bf16 v[96:111], a[56:59], a[80:83], v[96:111]
    v_mfma_f32_32x32x16_bf16 v[160:175], a[56:59], a[84:87], v[160:175]
    s_add_u32 m0, s52, 40960
    s_waitcnt vmcnt(11)
    ds_read_b64_tr_b16 v[32:33], v4 offset:57344
    ds_read_b64_tr_b16 v[34:35], v4 offset:58368
    buffer_load_dwordx4 v18, s[12:15], 0 offen offset:0 lds
    v_mfma_f32_32x32x16_bf16 v[224:239], a[56:59], a[88:91], v[224:239]
    ds_read_b64_tr_b16 v[36:37], v5 offset:57344
    ds_read_b64_tr_b16 a[206:207], v17 offset:13312
    v_mfma_f32_32x32x16_bf16 v[112:127], a[60:63], a[80:83], v[112:127]
    ds_read_b64_tr_b16 v[38:39], v5 offset:58368
    buffer_load_dwordx4 v18, s[12:15], s40 offen offset:1024 lds
    v_mfma_f32_32x32x16_bf16 v[176:191], a[60:63], a[84:87], v[176:191]
    ds_read_b64_tr_b16 v[40:41], v6 offset:57344
    ds_read_b64_tr_b16 v[42:43], v6 offset:58368
    v_mfma_f32_32x32x16_bf16 v[240:255], a[60:63], a[88:91], v[240:255]
    ds_read_b64_tr_b16 v[44:45], v7 offset:57344
    buffer_load_dwordx4 v18, s[12:15], s41 offen offset:2048 lds
    s_waitcnt lgkmcnt(9)
    v_mfma_f32_32x32x16_bf16 v[64:79], a[32:35], a[92:95], v[64:79]
    ds_read_b64_tr_b16 v[46:47], v7 offset:58368
    ds_read_b64_tr_b16 a[208:209], v16 offset:10240
    v_mfma_f32_32x32x16_bf16 v[128:143], a[32:35], a[64:67], v[128:143]
    buffer_load_dwordx4 v18, s[12:15], s42 offen offset:3072 lds
    ds_read_b64_tr_b16 a[210:211], v16 offset:14336
    v_add_u32 v18, 131072, v18
    v_mfma_f32_32x32x16_bf16 v[192:207], a[32:35], a[68:71], v[192:207]
    ds_read_b128 a[72:75], v10 offset:8192
    v_mfma_f32_32x32x16_bf16 v[80:95], a[36:39], a[92:95], v[80:95]
    s_add_u32 m0, s52, 49152
    ds_read_b128 a[76:79], v10 offset:9216
    buffer_load_dwordx4 v18, s[12:15], 0 offen offset:0 lds
    v_mfma_f32_32x32x16_bf16 v[144:159], a[36:39], a[64:67], v[144:159]
    ds_read_b128 a[80:83], v10 offset:10240
    ds_read_b64_tr_b16 a[212:213], v17 offset:10240
    v_mfma_f32_32x32x16_bf16 v[208:223], a[36:39], a[68:71], v[208:223]
    buffer_load_dwordx4 v18, s[12:15], s40 offen offset:1024 lds
    v_mfma_f32_32x32x16_bf16 v[96:111], a[40:43], a[92:95], v[96:111]
    s_waitcnt vmcnt(13)
    ds_read_b64_tr_b16 a[48:49], v4 offset:32768
    ds_read_b64_tr_b16 a[50:51], v4 offset:33792
    v_mfma_f32_32x32x16_bf16 v[160:175], a[40:43], a[64:67], v[160:175]
    ds_read_b64_tr_b16 a[52:53], v5 offset:32768
    buffer_load_dwordx4 v18, s[12:15], s41 offen offset:2048 lds
    v_mfma_f32_32x32x16_bf16 v[224:239], a[40:43], a[68:71], v[224:239]
    ds_read_b64_tr_b16 a[54:55], v5 offset:33792
    ds_read_b64_tr_b16 a[214:215], v17 offset:14336
    v_mfma_f32_32x32x16_bf16 v[112:127], a[44:47], a[92:95], v[112:127]
    ds_read_b64_tr_b16 a[56:57], v6 offset:32768
    ds_read_b64_tr_b16 a[58:59], v6 offset:33792
    buffer_load_dwordx4 v18, s[12:15], s42 offen offset:3072 lds
    v_add_u32 v18, 131072, v18
    v_mfma_f32_32x32x16_bf16 v[176:191], a[44:47], a[64:67], v[176:191]
    ds_read_b64_tr_b16 a[60:61], v7 offset:32768
    ds_read_b64_tr_b16 a[216:217], v16 offset:11264
    v_mfma_f32_32x32x16_bf16 v[240:255], a[44:47], a[68:71], v[240:255]
    s_add_u32 m0, s52, 57344
    ds_read_b64_tr_b16 a[62:63], v7 offset:33792
    s_waitcnt lgkmcnt(10)
    buffer_load_dwordx4 v18, s[12:15], 0 offen offset:0 lds
    v_mfma_f32_32x32x16_bf16 v[64:79], v[48:51], a[72:75], v[64:79]
    ds_read_b64_tr_b16 a[218:219], v16 offset:15360
    v_mfma_f32_32x32x16_bf16 v[128:143], v[48:51], a[76:79], v[128:143]
    buffer_load_dwordx4 v18, s[12:15], s40 offen offset:1024 lds
    v_mfma_f32_32x32x16_bf16 v[192:207], v[48:51], a[80:83], v[192:207]
    ds_read_b128 a[84:87], v11 offset:8192
    v_mfma_f32_32x32x16_bf16 v[80:95], v[52:55], a[72:75], v[80:95]
    ds_read_b128 a[88:91], v11 offset:9216
    buffer_load_dwordx4 v18, s[12:15], s41 offen offset:2048 lds
    v_mfma_f32_32x32x16_bf16 v[144:159], v[52:55], a[76:79], v[144:159]
    ds_read_b128 a[92:95], v11 offset:10240
    ds_read_b64_tr_b16 a[220:221], v17 offset:11264
    v_mfma_f32_32x32x16_bf16 v[208:223], v[52:55], a[80:83], v[208:223]
    s_waitcnt vmcnt(7)
    ds_read_b64_tr_b16 a[32:33], v4 offset:40960
    ds_read_b64_tr_b16 a[34:35], v4 offset:41984
    buffer_load_dwordx4 v18, s[12:15], s42 offen offset:3072 lds
    v_add_u32 v18, 131072, v18
    v_mfma_f32_32x32x16_bf16 v[96:111], v[56:59], a[72:75], v[96:111]
    ds_read_b64_tr_b16 a[36:37], v5 offset:40960
    ds_read_b64_tr_b16 a[222:223], v17 offset:15360
    v_mfma_f32_32x32x16_bf16 v[160:175], v[56:59], a[76:79], v[160:175]
    s_add_u32 m0, s52, 32768
    ds_read_b64_tr_b16 a[38:39], v5 offset:41984
    s_waitcnt lgkmcnt(9)
    buffer_load_dwordx4 v18, s[12:15], 0 offen offset:0 lds
    v_mfma_f32_32x32x16_bf16 v[224:239], v[56:59], a[80:83], v[224:239]
    ds_read_b64_tr_b16 a[40:41], v6 offset:40960
    ds_read_b64_tr_b16 a[42:43], v6 offset:41984
    v_mfma_f32_32x32x16_bf16 v[112:127], v[60:63], a[72:75], v[112:127]
    ds_read_b64_tr_b16 a[44:45], v7 offset:40960
    buffer_load_dwordx4 v18, s[12:15], s40 offen offset:1024 lds
    v_mfma_f32_32x32x16_bf16 v[176:191], v[60:63], a[76:79], v[176:191]
    ds_read_b64_tr_b16 a[46:47], v7 offset:41984
    v_mfma_f32_32x32x16_bf16 v[240:255], v[60:63], a[80:83], v[240:255]
    buffer_load_dwordx4 v18, s[12:15], s41 offen offset:2048 lds
    s_waitcnt lgkmcnt(9)
    v_mfma_f32_32x32x16_bf16 v[64:79], v[32:35], a[84:87], v[64:79]
    s_waitcnt lgkmcnt(5)
    s_barrier
    v_mfma_f32_32x32x16_bf16 v[128:143], v[32:35], a[88:91], v[128:143]
    buffer_load_dwordx4 v18, s[12:15], s42 offen offset:3072 lds
    ds_read_b128 a[224:227], v12 offset:0
    v_add_u32 v18, 131072, v18
    v_mfma_f32_32x32x16_bf16 v[192:207], v[32:35], a[92:95], v[192:207]
    ds_read_b128 a[64:67], v8 offset:0
    v_mfma_f32_32x32x16_bf16 v[80:95], v[36:39], a[84:87], v[80:95]
    s_add_u32 m0, s53, 73728
    ds_read_b128 a[68:71], v8 offset:1024
    buffer_load_dwordx4 v19, s[8:11], 0 offen offset:0 lds
    v_mfma_f32_32x32x16_bf16 v[144:159], v[36:39], a[88:91], v[144:159]
    ds_read_b128 a[72:75], v8 offset:2048
    v_mfma_f32_32x32x16_bf16 v[208:223], v[36:39], a[92:95], v[208:223]
    s_waitcnt vmcnt(9)
    ds_read_b64_tr_b16 v[48:49], v4 offset:49152
    ds_read_b64_tr_b16 v[50:51], v4 offset:50176
    buffer_load_dwordx4 v19, s[8:11], s43 offen offset:1024 lds
    v_mfma_f32_32x32x16_bf16 v[96:111], v[40:43], a[84:87], v[96:111]
    ds_read_b64_tr_b16 v[52:53], v5 offset:49152
    ds_read_b128 a[228:231], v13 offset:0
    v_mfma_f32_32x32x16_bf16 v[160:175], v[40:43], a[88:91], v[160:175]
    ds_read_b64_tr_b16 v[54:55], v5 offset:50176
    buffer_load_dwordx4 v19, s[8:11], s44 offen offset:2048 lds
    v_add_u32 v19, 128, v19
    v_mfma_f32_32x32x16_bf16 v[224:239], v[40:43], a[92:95], v[224:239]
    ds_read_b64_tr_b16 v[56:57], v6 offset:49152
    ds_read_b64_tr_b16 v[58:59], v6 offset:50176
    v_mfma_f32_32x32x16_bf16 v[112:127], v[44:47], a[84:87], v[112:127]
    s_add_u32 m0, s52, 16384
    ds_read_b64_tr_b16 v[60:61], v7 offset:49152
    buffer_load_dwordx4 v21, s[20:23], s45 offen offset:0 nt lds
    v_mfma_f32_32x32x16_bf16 v[176:191], v[44:47], a[88:91], v[176:191]
    ds_read_b64_tr_b16 v[62:63], v7 offset:50176
    v_mfma_f32_32x32x16_bf16 v[240:255], v[44:47], a[92:95], v[240:255]
    buffer_load_dwordx4 v21, s[20:23], s46 offen offset:1024 nt lds
    s_waitcnt lgkmcnt(9)
    v_mfma_f32_32x32x16_bf16 v[64:79], a[48:51], a[64:67], v[64:79]
    ds_read_b128 a[232:235], v14 offset:0
    v_mfma_f32_32x32x16_bf16 v[128:143], a[48:51], a[68:71], v[128:143]
    buffer_load_dwordx4 v21, s[20:23], s47 offen offset:2048 nt lds
    v_mfma_f32_32x32x16_bf16 v[192:207], a[48:51], a[72:75], v[192:207]
    ds_read_b128 a[76:79], v9 offset:0
    v_mfma_f32_32x32x16_bf16 v[80:95], a[52:55], a[64:67], v[80:95]
    ds_read_b128 a[80:83], v9 offset:1024
    buffer_load_dwordx4 v21, s[20:23], s48 offen offset:3072 nt lds
    v_xor_b32 v21, 8192, v21
    v_mfma_f32_32x32x16_bf16 v[144:159], a[52:55], a[68:71], v[144:159]
    s_waitcnt vmcnt(11)
    ds_read_b64_tr_b16 v[32:33], v4 offset:57344
    ds_read_b64_tr_b16 v[34:35], v4 offset:58368
    v_mfma_f32_32x32x16_bf16 v[208:223], a[52:55], a[72:75], v[208:223]
    s_add_u32 m0, s52, 40960
    ds_read_b64_tr_b16 v[36:37], v5 offset:57344
    buffer_load_dwordx4 v18, s[12:15], 0 offen offset:0 lds
    v_mfma_f32_32x32x16_bf16 v[96:111], a[56:59], a[64:67], v[96:111]
    ds_read_b64_tr_b16 v[38:39], v5 offset:58368
    ds_read_b128 a[236:239], v15 offset:0
    v_mfma_f32_32x32x16_bf16 v[160:175], a[56:59], a[68:71], v[160:175]
    ds_read_b64_tr_b16 v[40:41], v6 offset:57344
    ds_read_b64_tr_b16 v[42:43], v6 offset:58368
    buffer_load_dwordx4 v18, s[12:15], s40 offen offset:1024 lds
    v_mfma_f32_32x32x16_bf16 v[224:239], a[56:59], a[72:75], v[224:239]
    ds_read_b64_tr_b16 v[44:45], v7 offset:57344
    v_mfma_f32_32x32x16_bf16 v[112:127], a[60:63], a[64:67], v[112:127]
    ds_read_b64_tr_b16 v[46:47], v7 offset:58368
    buffer_load_dwordx4 v18, s[12:15], s41 offen offset:2048 lds
    v_mfma_f32_32x32x16_bf16 v[176:191], a[60:63], a[68:71], v[176:191]
    ds_read_b128 a[84:87], v9 offset:2048
    v_mfma_f32_32x32x16_bf16 v[240:255], a[60:63], a[72:75], v[240:255]
    buffer_load_dwordx4 v18, s[12:15], s42 offen offset:3072 lds
    ds_read_b128 a[240:243], v12 offset:1024
    s_waitcnt lgkmcnt(8)
    v_add_u32 v18, 131072, v18
    v_mfma_f32_32x32x16_bf16 v[64:79], a[32:35], a[76:79], v[64:79]
    s_add_u32 m0, s52, 49152
    v_mfma_f32_32x32x16_bf16 v[128:143], a[32:35], a[80:83], v[128:143]
    buffer_load_dwordx4 v18, s[12:15], 0 offen offset:0 lds
    s_waitcnt lgkmcnt(1)
    v_mfma_f32_32x32x16_bf16 v[192:207], a[32:35], a[84:87], v[192:207]
    ds_read_b128 a[88:91], v10 offset:0
    v_mfma_f32_32x32x16_bf16 v[80:95], a[36:39], a[76:79], v[80:95]
    s_waitcnt vmcnt(12)
    ds_read_b64_tr_b16 a[48:49], v4 offset:32768
    ds_read_b64_tr_b16 a[50:51], v4 offset:33792
    buffer_load_dwordx4 v18, s[12:15], s40 offen offset:1024 lds
    v_mfma_f32_32x32x16_bf16 v[144:159], a[36:39], a[80:83], v[144:159]
    ds_read_b64_tr_b16 a[52:53], v5 offset:32768
    ds_read_b128 a[244:247], v13 offset:1024
    v_mfma_f32_32x32x16_bf16 v[208:223], a[36:39], a[84:87], v[208:223]
    ds_read_b64_tr_b16 a[54:55], v5 offset:33792
    buffer_load_dwordx4 v18, s[12:15], s41 offen offset:2048 lds
    v_mfma_f32_32x32x16_bf16 v[96:111], a[40:43], a[76:79], v[96:111]
    ds_read_b64_tr_b16 a[56:57], v6 offset:32768
    ds_read_b64_tr_b16 a[58:59], v6 offset:33792
    v_mfma_f32_32x32x16_bf16 v[160:175], a[40:43], a[80:83], v[160:175]
    ds_read_b64_tr_b16 a[60:61], v7 offset:32768
    buffer_load_dwordx4 v18, s[12:15], s42 offen offset:3072 lds
    v_add_u32 v18, 131072, v18
    v_mfma_f32_32x32x16_bf16 v[224:239], a[40:43], a[84:87], v[224:239]
    ds_read_b64_tr_b16 a[62:63], v7 offset:33792
    v_mfma_f32_32x32x16_bf16 v[112:127], a[44:47], a[76:79], v[112:127]
    s_add_u32 m0, s52, 57344
    ds_read_b128 a[92:95], v10 offset:1024
    buffer_load_dwordx4 v18, s[12:15], 0 offen offset:0 lds
    v_mfma_f32_32x32x16_bf16 v[176:191], a[44:47], a[80:83], v[176:191]
    ds_read_b128 a[64:67], v10 offset:2048
    ds_read_b128 a[248:251], v14 offset:1024
    v_mfma_f32_32x32x16_bf16 v[240:255], a[44:47], a[84:87], v[240:255]
    buffer_load_dwordx4 v18, s[12:15], s40 offen offset:1024 lds
    s_waitcnt lgkmcnt(8)
    v_mfma_f32_32x32x16_bf16 v[64:79], v[48:51], a[88:91], v[64:79]
    s_waitcnt lgkmcnt(2)
    v_mfma_f32_32x32x16_bf16 v[128:143], v[48:51], a[92:95], v[128:143]
    buffer_load_dwordx4 v18, s[12:15], s41 offen offset:2048 lds
    s_waitcnt lgkmcnt(1)
    v_mfma_f32_32x32x16_bf16 v[192:207], v[48:51], a[64:67], v[192:207]
    s_waitcnt vmcnt(7)
    ds_read_b64_tr_b16 a[32:33], v4 offset:40960
    ds_read_b64_tr_b16 a[34:35], v4 offset:41984
    v_mfma_f32_32x32x16_bf16 v[80:95], v[52:55], a[88:91], v[80:95]
    ds_read_b64_tr_b16 a[36:37], v5 offset:40960
    buffer_load_dwordx4 v18, s[12:15], s42 offen offset:3072 lds
    v_add_u32 v18, 131072, v18
    v_mfma_f32_32x32x16_bf16 v[144:159], v[52:55], a[92:95], v[144:159]
    ds_read_b64_tr_b16 a[38:39], v5 offset:41984
    ds_read_b128 a[252:255], v15 offset:1024
    v_mfma_f32_32x32x16_bf16 v[208:223], v[52:55], a[64:67], v[208:223]
    s_add_u32 m0, s52, 8192
    ds_read_b64_tr_b16 a[40:41], v6 offset:40960
    ds_read_b64_tr_b16 a[42:43], v6 offset:41984
    buffer_load_dwordx4 v20, s[16:19], s45 offen offset:0 nt lds
    v_mfma_f32_32x32x16_bf16 v[96:111], v[56:59], a[88:91], v[96:111]
    ds_read_b64_tr_b16 a[44:45], v7 offset:40960
    v_mfma_f32_32x32x16_bf16 v[160:175], v[56:59], a[92:95], v[160:175]
    ds_read_b64_tr_b16 a[46:47], v7 offset:41984
    buffer_load_dwordx4 v20, s[16:19], s46 offen offset:1024 nt lds
    v_mfma_f32_32x32x16_bf16 v[224:239], v[56:59], a[64:67], v[224:239]
    ds_read_b128 a[68:71], v11 offset:0
    v_mfma_f32_32x32x16_bf16 v[112:127], v[60:63], a[88:91], v[112:127]
    ds_read_b128 a[72:75], v11 offset:1024
    buffer_load_dwordx4 v20, s[16:19], s47 offen offset:2048 nt lds
    v_mfma_f32_32x32x16_bf16 v[176:191], v[60:63], a[92:95], v[176:191]
    ds_read_b128 a[76:79], v11 offset:2048
    v_mfma_f32_32x32x16_bf16 v[240:255], v[60:63], a[64:67], v[240:255]
    buffer_load_dwordx4 v20, s[16:19], s48 offen offset:3072 nt lds
    s_waitcnt lgkmcnt(2)
    v_xor_b32 v20, 57344, v20
    v_mfma_f32_32x32x16_bf16 v[64:79], v[32:35], a[68:71], v[64:79]
    s_waitcnt lgkmcnt(0)
    s_barrier
    v_mfma_f32_32x32x16_bf16 v[128:143], v[32:35], a[72:75], v[128:143]
    s_waitcnt vmcnt(8)
    ds_read_b64_tr_b16 v[48:49], v4 offset:49152
    ds_read_b64_tr_b16 v[50:51], v4 offset:50176
    v_mfma_f32_32x32x16_bf16 v[192:207], v[32:35], a[76:79], v[192:207]
    ds_read_b64_tr_b16 v[52:53], v5 offset:49152
    v_mfma_f32_32x32x16_bf16 v[80:95], v[36:39], a[68:71], v[80:95]
    ds_read_b64_tr_b16 v[54:55], v5 offset:50176
    v_mfma_f32_32x32x16_bf16 v[144:159], v[36:39], a[72:75], v[144:159]
    ds_read_b64_tr_b16 v[56:57], v6 offset:49152
    ds_read_b64_tr_b16 v[58:59], v6 offset:50176
    v_mfma_f32_32x32x16_bf16 v[208:223], v[36:39], a[76:79], v[208:223]
    ds_read_b64_tr_b16 v[60:61], v7 offset:49152
    v_mfma_f32_32x32x16_bf16 v[96:111], v[40:43], a[68:71], v[96:111]
    ds_read_b64_tr_b16 v[62:63], v7 offset:50176
    v_mfma_f32_32x32x16_bf16 v[160:175], v[40:43], a[72:75], v[160:175]
    ds_read_b128 a[80:83], v8 offset:8192
    v_mfma_f32_32x32x16_bf16 v[224:239], v[40:43], a[76:79], v[224:239]
    ds_read_b128 a[84:87], v9 offset:8192
    v_mfma_f32_32x32x16_bf16 v[112:127], v[44:47], a[68:71], v[112:127]
    v_mfma_f32_32x32x16_bf16 v[176:191], v[44:47], a[72:75], v[176:191]
    ds_read_b128 a[88:91], v10 offset:8192
    v_mfma_f32_32x32x16_bf16 v[240:255], v[44:47], a[76:79], v[240:255]
    s_waitcnt lgkmcnt(2)
    v_mfma_f32_32x32x16_bf16 v[64:79], a[48:51], a[80:83], v[64:79]
    v_mfma_f32_32x32x16_bf16 v[80:95], a[52:55], a[80:83], v[80:95]
    s_add_u32 m0, s52, 24576
    s_waitcnt vmcnt(4)
    ds_read_b64_tr_b16 v[32:33], v4 offset:57344
    ds_read_b64_tr_b16 v[34:35], v4 offset:58368
    buffer_load_dwordx4 v21, s[20:23], s45 offen offset:0 nt lds
    v_mfma_f32_32x32x16_bf16 v[96:111], a[56:59], a[80:83], v[96:111]
    ds_read_b64_tr_b16 v[36:37], v5 offset:57344
    v_mfma_f32_32x32x16_bf16 v[112:127], a[60:63], a[80:83], v[112:127]
    ds_read_b64_tr_b16 v[38:39], v5 offset:58368
    buffer_load_dwordx4 v21, s[20:23], s46 offen offset:1024 nt lds
    s_waitcnt lgkmcnt(5)
    v_mfma_f32_32x32x16_bf16 v[64:79], a[32:35], a[84:87], v[64:79]
    ds_read_b64_tr_b16 v[40:41], v6 offset:57344
    ds_read_b64_tr_b16 v[42:43], v6 offset:58368
    v_mfma_f32_32x32x16_bf16 v[80:95], a[36:39], a[84:87], v[80:95]
    ds_read_b64_tr_b16 v[44:45], v7 offset:57344
    buffer_load_dwordx4 v21, s[20:23], s47 offen offset:2048 nt lds
    v_mfma_f32_32x32x16_bf16 v[96:111], a[40:43], a[84:87], v[96:111]
    ds_read_b64_tr_b16 v[46:47], v7 offset:58368
    v_mfma_f32_32x32x16_bf16 v[112:127], a[44:47], a[84:87], v[112:127]
    ds_read_b128 a[92:95], v11 offset:8192
    buffer_load_dwordx4 v21, s[20:23], s48 offen offset:3072 nt lds
    s_waitcnt lgkmcnt(7)
    v_xor_b32 v21, 57344, v21
    v_mfma_f32_32x32x16_bf16 v[64:79], v[48:51], a[88:91], v[64:79]
    ds_read_b128 a[64:67], v8 offset:9216
    v_mfma_f32_32x32x16_bf16 v[80:95], v[52:55], a[88:91], v[80:95]
    ds_read_b128 a[68:71], v9 offset:9216
    v_mfma_f32_32x32x16_bf16 v[96:111], v[56:59], a[88:91], v[96:111]
    ds_read_b128 a[72:75], v10 offset:9216
    v_mfma_f32_32x32x16_bf16 v[112:127], v[60:63], a[88:91], v[112:127]
    ds_read_b128 a[76:79], v11 offset:9216
    s_waitcnt lgkmcnt(4)
    v_mfma_f32_32x32x16_bf16 v[64:79], v[32:35], a[92:95], v[64:79]
    v_mfma_f32_32x32x16_bf16 v[80:95], v[36:39], a[92:95], v[80:95]
    v_mfma_f32_32x32x16_bf16 v[96:111], v[40:43], a[92:95], v[96:111]
    v_mul_f32 v64, s56, v64
    v_mul_f32 v65, s56, v65
    v_cvt_pk_bf16_f32 v64, v64, v65
    v_mul_f32 v66, s56, v66
    v_mul_f32 v67, s56, v67
    v_cvt_pk_bf16_f32 v65, v66, v67
    v_mfma_f32_32x32x16_bf16 v[112:127], v[44:47], a[92:95], v[112:127]
    s_waitcnt lgkmcnt(2)
    v_mul_f32 v68, s56, v68
    v_mul_f32 v69, s56, v69
    v_cvt_pk_bf16_f32 v66, v68, v69
    v_mul_f32 v70, s56, v70
    v_mul_f32 v71, s56, v71
    v_cvt_pk_bf16_f32 v67, v70, v71
    v_mfma_f32_32x32x16_bf16 v[128:143], a[48:51], a[64:67], v[128:143]
    ds_write_b128 v22, v[64:67] offset:32768
    v_mul_f32 v72, s56, v72
    v_mfma_f32_32x32x16_bf16 v[128:143], a[32:35], a[68:71], v[128:143]
    s_waitcnt lgkmcnt(1)
    v_mul_f32 v73, s56, v73
    v_cvt_pk_bf16_f32 v72, v72, v73
    v_mul_f32 v74, s56, v74
    v_mul_f32 v75, s56, v75
    v_cvt_pk_bf16_f32 v73, v74, v75
    v_mul_f32 v76, s56, v76
    v_mfma_f32_32x32x16_bf16 v[128:143], v[48:51], a[72:75], v[128:143]
    v_mul_f32 v77, s56, v77
    v_cvt_pk_bf16_f32 v74, v76, v77
    v_mul_f32 v78, s56, v78
    v_mul_f32 v79, s56, v79
    v_cvt_pk_bf16_f32 v75, v78, v79
    v_mfma_f32_32x32x16_bf16 v[128:143], v[32:35], a[76:79], v[128:143]
    ds_write_b128 v22, v[72:75] offset:33792
    v_mul_f32 v80, s56, v80
    v_mfma_f32_32x32x16_bf16 v[144:159], a[52:55], a[64:67], v[144:159]
    v_mul_f32 v81, s56, v81
    v_cvt_pk_bf16_f32 v80, v80, v81
    v_mul_f32 v82, s56, v82
    v_mul_f32 v83, s56, v83
    v_cvt_pk_bf16_f32 v81, v82, v83
    v_mul_f32 v84, s56, v84
    v_mfma_f32_32x32x16_bf16 v[144:159], a[36:39], a[68:71], v[144:159]
    v_mul_f32 v85, s56, v85
    v_cvt_pk_bf16_f32 v82, v84, v85
    v_mul_f32 v86, s56, v86
    v_mul_f32 v87, s56, v87
    v_cvt_pk_bf16_f32 v83, v86, v87
    v_mfma_f32_32x32x16_bf16 v[144:159], v[52:55], a[72:75], v[144:159]
    ds_read_b128 a[80:83], v8 offset:10240
    v_mfma_f32_32x32x16_bf16 v[144:159], v[36:39], a[76:79], v[144:159]
    ds_read_b128 a[84:87], v9 offset:10240
    v_mfma_f32_32x32x16_bf16 v[160:175], a[56:59], a[64:67], v[160:175]
    ds_read_b128 a[88:91], v10 offset:10240
    v_mfma_f32_32x32x16_bf16 v[160:175], a[40:43], a[68:71], v[160:175]
    s_add_u32 m0, s52, 0
    ds_read_b128 a[92:95], v11 offset:10240
    buffer_load_dwordx4 v20, s[16:19], s45 offen offset:0 nt lds
    v_mfma_f32_32x32x16_bf16 v[160:175], v[56:59], a[72:75], v[160:175]
    ds_write_b128 v22, v[80:83] offset:34816
    v_mul_f32 v88, s56, v88
    v_mfma_f32_32x32x16_bf16 v[160:175], v[40:43], a[76:79], v[160:175]
    buffer_load_dwordx4 v20, s[16:19], s46 offen offset:1024 nt lds
    v_mul_f32 v89, s56, v89
    v_cvt_pk_bf16_f32 v88, v88, v89
    v_mul_f32 v90, s56, v90
    v_mul_f32 v91, s56, v91
    v_cvt_pk_bf16_f32 v89, v90, v91
    v_mfma_f32_32x32x16_bf16 v[176:191], a[60:63], a[64:67], v[176:191]
    v_mul_f32 v92, s56, v92
    v_mul_f32 v93, s56, v93
    v_cvt_pk_bf16_f32 v90, v92, v93
    v_mul_f32 v94, s56, v94
    v_mul_f32 v95, s56, v95
    v_cvt_pk_bf16_f32 v91, v94, v95
    v_mfma_f32_32x32x16_bf16 v[176:191], a[44:47], a[68:71], v[176:191]
    buffer_load_dwordx4 v20, s[16:19], s47 offen offset:2048 nt lds
    v_mfma_f32_32x32x16_bf16 v[176:191], v[60:63], a[72:75], v[176:191]
    ds_write_b128 v22, v[88:91] offset:35840
    v_mul_f32 v96, s56, v96
    v_mfma_f32_32x32x16_bf16 v[176:191], v[44:47], a[76:79], v[176:191]
    buffer_load_dwordx4 v20, s[16:19], s48 offen offset:3072 nt lds
    s_waitcnt lgkmcnt(2)
    v_xor_b32 v20, 8192, v20
    v_mul_f32 v97, s56, v97
    v_cvt_pk_bf16_f32 v96, v96, v97
    v_mul_f32 v98, s56, v98
    v_mul_f32 v99, s56, v99
    v_mfma_f32_32x32x16_bf16 v[192:207], a[48:51], a[80:83], v[192:207]
    v_cvt_pk_bf16_f32 v97, v98, v99
    v_mul_f32 v100, s56, v100
    v_mul_f32 v101, s56, v101
    v_cvt_pk_bf16_f32 v98, v100, v101
    v_mul_f32 v102, s56, v102
    v_mul_f32 v103, s56, v103
    v_mfma_f32_32x32x16_bf16 v[192:207], a[32:35], a[84:87], v[192:207]
    v_cvt_pk_bf16_f32 v99, v102, v103
    v_mfma_f32_32x32x16_bf16 v[192:207], v[48:51], a[88:91], v[192:207]
    ds_write_b128 v22, v[96:99] offset:40960
    v_mov_b32 v24, 0
    v_mfma_f32_32x32x16_bf16 v[192:207], v[32:35], a[92:95], v[192:207]
    v_mul_f32 v104, s56, v104
    v_mul_f32 v105, s56, v105
    v_cvt_pk_bf16_f32 v104, v104, v105
    v_mul_f32 v106, s56, v106
    v_mul_f32 v107, s56, v107
    v_cvt_pk_bf16_f32 v105, v106, v107
    v_mfma_f32_32x32x16_bf16 v[208:223], a[52:55], a[80:83], v[208:223]
    v_mul_f32 v108, s56, v108
    v_mul_f32 v109, s56, v109
    v_cvt_pk_bf16_f32 v106, v108, v109
    v_mul_f32 v110, s56, v110
    v_mul_f32 v111, s56, v111
    v_cvt_pk_bf16_f32 v107, v110, v111
    v_mfma_f32_32x32x16_bf16 v[208:223], a[36:39], a[84:87], v[208:223]
    ds_write_b128 v22, v[104:107] offset:41984
    v_mov_b32 v25, 0
    v_mfma_f32_32x32x16_bf16 v[208:223], v[52:55], a[88:91], v[208:223]
    v_mul_f32 v112, s56, v112
    v_mul_f32 v113, s56, v113
    v_cvt_pk_bf16_f32 v112, v112, v113
    v_mul_f32 v114, s56, v114
    v_mul_f32 v115, s56, v115
    v_cvt_pk_bf16_f32 v113, v114, v115
    v_mfma_f32_32x32x16_bf16 v[208:223], v[36:39], a[92:95], v[208:223]
    v_mul_f32 v116, s56, v116
    v_mul_f32 v117, s56, v117
    v_cvt_pk_bf16_f32 v114, v116, v117
    v_mul_f32 v118, s56, v118
    v_mul_f32 v119, s56, v119
    v_cvt_pk_bf16_f32 v115, v118, v119
    v_mfma_f32_32x32x16_bf16 v[224:239], a[56:59], a[80:83], v[224:239]
    ds_write_b128 v22, v[112:115] offset:43008
    v_mul_f32 v120, s56, v120
    v_mfma_f32_32x32x16_bf16 v[224:239], a[40:43], a[84:87], v[224:239]
    v_mov_b32 v26, 0
    v_mul_f32 v121, s56, v121
    v_cvt_pk_bf16_f32 v120, v120, v121
    v_mul_f32 v122, s56, v122
    v_mul_f32 v123, s56, v123
    v_cvt_pk_bf16_f32 v121, v122, v123
    v_mfma_f32_32x32x16_bf16 v[224:239], v[56:59], a[88:91], v[224:239]
    v_mul_f32 v124, s56, v124
    v_mul_f32 v125, s56, v125
    v_cvt_pk_bf16_f32 v122, v124, v125
    v_mul_f32 v126, s56, v126
    v_mul_f32 v127, s56, v127
    v_cvt_pk_bf16_f32 v123, v126, v127
    v_mfma_f32_32x32x16_bf16 v[224:239], v[40:43], a[92:95], v[224:239]
    ds_write_b128 v22, v[120:123] offset:44032
    v_mul_f32 v128, s56, v128
    v_mfma_f32_32x32x16_bf16 v[240:255], a[60:63], a[80:83], v[240:255]
    v_mul_f32 v129, s56, v129
    v_cvt_pk_bf16_f32 v128, v128, v129
    v_mul_f32 v130, s56, v130
    v_mul_f32 v131, s56, v131
    v_cvt_pk_bf16_f32 v129, v130, v131
    v_mul_f32 v132, s56, v132
    v_mfma_f32_32x32x16_bf16 v[240:255], a[44:47], a[84:87], v[240:255]
    s_waitcnt lgkmcnt(0)
    s_barrier
    ds_read_b128 a[0:3], v23 offset:32768
    ds_read_b128 a[4:7], v23 offset:33792
    ds_read_b128 a[8:11], v23 offset:34816
    ds_read_b128 a[12:15], v23 offset:35840
    ds_read_b128 a[16:19], v23 offset:40960
    ds_read_b128 a[20:23], v23 offset:41984
    ds_read_b128 a[24:27], v23 offset:43008
    ds_read_b128 a[28:31], v23 offset:44032
    v_mfma_f32_32x32x16_bf16 v[240:255], v[60:63], a[88:91], v[240:255]
    v_mul_f32 v133, s56, v133
    v_cvt_pk_bf16_f32 v130, v132, v133
    v_mul_f32 v134, s56, v134
    v_mul_f32 v135, s56, v135
    v_cvt_pk_bf16_f32 v131, v134, v135
    v_mfma_f32_32x32x16_bf16 v[240:255], v[44:47], a[92:95], v[240:255]
    ds_write_b128 v22, v[128:131] offset:49152
    s_waitcnt lgkmcnt(8)
    v_mul_f32 v136, s56, v136
    v_mfma_f32_32x32x16_bf16 v[32:47], a[96:99], a[0:3], 0
    s_waitcnt lgkmcnt(7)
    v_mul_f32 v137, s56, v137
    v_cvt_pk_bf16_f32 v136, v136, v137
    v_mul_f32 v138, s56, v138
    v_mul_f32 v139, s56, v139
    v_cvt_pk_bf16_f32 v137, v138, v139
    v_mul_f32 v140, s56, v140
    v_mfma_f32_32x32x16_bf16 v[32:47], a[100:103], a[4:7], v[32:47]
    s_add_u32 m0, s52, 65536
    s_waitcnt lgkmcnt(6)
    v_mul_f32 v141, s56, v141
    v_cvt_pk_bf16_f32 v138, v140, v141
    v_mul_f32 v142, s56, v142
    v_mul_f32 v143, s56, v143
    v_cvt_pk_bf16_f32 v139, v142, v143
    v_mfma_f32_32x32x16_bf16 v[32:47], a[104:107], a[8:11], v[32:47]
    buffer_load_dwordx4 v21, s[20:23], s45 offen offset:0 nt lds
    s_waitcnt lgkmcnt(5)
    v_mfma_f32_32x32x16_bf16 v[32:47], a[108:111], a[12:15], v[32:47]
    ds_write_b128 v22, v[136:139] offset:50176
    s_waitcnt lgkmcnt(2)
    v_mul_f32 v144, s56, v144
    v_mfma_f32_32x32x16_bf16 v[32:47], a[112:115], a[16:19], v[32:47]
    buffer_load_dwordx4 v21, s[20:23], s46 offen offset:1024 nt lds
    v_mul_f32 v145, s56, v145
    v_cvt_pk_bf16_f32 v144, v144, v145
    v_mul_f32 v146, s56, v146
    v_mul_f32 v147, s56, v147
    v_cvt_pk_bf16_f32 v145, v146, v147
    v_mfma_f32_32x32x16_bf16 v[32:47], a[116:119], a[20:23], v[32:47]
    v_pk_mul_f32 v[148:149], v[148:149], s[56:57] op_sel:[0,0] op_sel_hi:[1,0]
    v_cvt_pk_bf16_f32 v146, v148, v149
    v_pk_mul_f32 v[150:151], v[150:151], s[56:57] op_sel:[0,0] op_sel_hi:[1,0]
    v_cvt_pk_bf16_f32 v147, v150, v151
    ds_write_b128 v22, v[144:147] offset:51200
    v_pk_mul_f32 v[152:153], v[152:153], s[56:57] op_sel:[0,0] op_sel_hi:[1,0]
    v_cvt_pk_bf16_f32 v152, v152, v153
    v_pk_mul_f32 v[154:155], v[154:155], s[56:57] op_sel:[0,0] op_sel_hi:[1,0]
    v_cvt_pk_bf16_f32 v153, v154, v155
    v_pk_mul_f32 v[156:157], v[156:157], s[56:57] op_sel:[0,0] op_sel_hi:[1,0]
    v_cvt_pk_bf16_f32 v154, v156, v157
    v_pk_mul_f32 v[158:159], v[158:159], s[56:57] op_sel:[0,0] op_sel_hi:[1,0]
    v_cvt_pk_bf16_f32 v155, v158, v159
    ds_write_b128 v22, v[152:155] offset:52224
    v_pk_mul_f32 v[160:161], v[160:161], s[56:57] op_sel:[0,0] op_sel_hi:[1,0]
    v_cvt_pk_bf16_f32 v160, v160, v161
    v_pk_mul_f32 v[162:163], v[162:163], s[56:57] op_sel:[0,0] op_sel_hi:[1,0]
    v_cvt_pk_bf16_f32 v161, v162, v163
    v_pk_mul_f32 v[164:165], v[164:165], s[56:57] op_sel:[0,0] op_sel_hi:[1,0]
    v_cvt_pk_bf16_f32 v162, v164, v165
    v_pk_mul_f32 v[166:167], v[166:167], s[56:57] op_sel:[0,0] op_sel_hi:[1,0]
    v_cvt_pk_bf16_f32 v163, v166, v167
    ds_write_b128 v22, v[160:163] offset:57344
    v_pk_mul_f32 v[168:169], v[168:169], s[56:57] op_sel:[0,0] op_sel_hi:[1,0]
    v_cvt_pk_bf16_f32 v168, v168, v169
    v_pk_mul_f32 v[170:171], v[170:171], s[56:57] op_sel:[0,0] op_sel_hi:[1,0]
    v_cvt_pk_bf16_f32 v169, v170, v171
    v_pk_mul_f32 v[172:173], v[172:173], s[56:57] op_sel:[0,0] op_sel_hi:[1,0]
    v_cvt_pk_bf16_f32 v170, v172, v173
    v_pk_mul_f32 v[174:175], v[174:175], s[56:57] op_sel:[0,0] op_sel_hi:[1,0]
    v_cvt_pk_bf16_f32 v171, v174, v175
    ds_write_b128 v22, v[168:171] offset:58368
    v_pk_mul_f32 v[176:177], v[176:177], s[56:57] op_sel:[0,0] op_sel_hi:[1,0]
    v_cvt_pk_bf16_f32 v176, v176, v177
    v_pk_mul_f32 v[178:179], v[178:179], s[56:57] op_sel:[0,0] op_sel_hi:[1,0]
    v_cvt_pk_bf16_f32 v177, v178, v179
    v_pk_mul_f32 v[180:181], v[180:181], s[56:57] op_sel:[0,0] op_sel_hi:[1,0]
    v_cvt_pk_bf16_f32 v178, v180, v181
    v_pk_mul_f32 v[182:183], v[182:183], s[56:57] op_sel:[0,0] op_sel_hi:[1,0]
    v_cvt_pk_bf16_f32 v179, v182, v183
    ds_write_b128 v22, v[176:179] offset:59392
    v_pk_mul_f32 v[184:185], v[184:185], s[56:57] op_sel:[0,0] op_sel_hi:[1,0]
    v_cvt_pk_bf16_f32 v184, v184, v185
    v_pk_mul_f32 v[186:187], v[186:187], s[56:57] op_sel:[0,0] op_sel_hi:[1,0]
    v_cvt_pk_bf16_f32 v185, v186, v187
    v_pk_mul_f32 v[188:189], v[188:189], s[56:57] op_sel:[0,0] op_sel_hi:[1,0]
    v_cvt_pk_bf16_f32 v186, v188, v189
    v_pk_mul_f32 v[190:191], v[190:191], s[56:57] op_sel:[0,0] op_sel_hi:[1,0]
    v_cvt_pk_bf16_f32 v187, v190, v191
    ds_write_b128 v22, v[184:187] offset:60416
    s_waitcnt lgkmcnt(0)
    s_barrier
    ds_read_b128 a[32:35], v23 offset:49152
    ds_read_b128 a[36:39], v23 offset:50176
    ds_read_b128 a[40:43], v23 offset:51200
    ds_read_b128 a[44:47], v23 offset:52224
    ds_read_b128 a[48:51], v23 offset:57344
    ds_read_b128 a[52:55], v23 offset:58368
    ds_read_b128 a[56:59], v23 offset:59392
    ds_read_b128 a[60:63], v23 offset:60416
    v_mfma_f32_32x32x16_bf16 v[32:47], a[120:123], a[24:27], v[32:47]
    buffer_load_dwordx4 v21, s[20:23], s47 offen offset:2048 nt lds
    v_mul_f32 v192, s56, v192
    v_mul_f32 v193, s56, v193
    v_cvt_pk_bf16_f32 v192, v192, v193
    v_mul_f32 v194, s56, v194
    v_mul_f32 v195, s56, v195
    v_mfma_f32_32x32x16_bf16 v[32:47], a[124:127], a[28:31], v[32:47]
    s_waitcnt lgkmcnt(7)
    v_cvt_pk_bf16_f32 v193, v194, v195
    v_mul_f32 v196, s56, v196
    v_mul_f32 v197, s56, v197
    v_cvt_pk_bf16_f32 v194, v196, v197
    v_mul_f32 v198, s56, v198
    v_mul_f32 v199, s56, v199
    v_mfma_f32_32x32x16_bf16 v[48:63], a[96:99], a[32:35], 0
    buffer_load_dwordx4 v21, s[20:23], s48 offen offset:3072 nt lds
    s_waitcnt lgkmcnt(6)
    v_xor_b32 v21, 8192, v21
    v_cvt_pk_bf16_f32 v195, v198, v199
    v_mfma_f32_32x32x16_bf16 v[48:63], a[100:103], a[36:39], v[48:63]
    s_waitcnt lgkmcnt(5)
    v_exp_f32 v32, v32
    v_exp_f32 v33, v33
    v_add_f32 v24, v24, v32
    v_mfma_f32_32x32x16_bf16 v[48:63], a[104:107], a[40:43], v[48:63]
    s_waitcnt lgkmcnt(4)
    v_exp_f32 v34, v34
    v_add_f32 v24, v24, v33
    v_cvt_pk_bf16_f32 v32, v32, v33
    v_exp_f32 v35, v35
    v_mfma_f32_32x32x16_bf16 v[48:63], a[108:111], a[44:47], v[48:63]
    s_waitcnt lgkmcnt(1)
    v_add_f32 v24, v24, v34
    v_exp_f32 v36, v36
    v_add_f32 v24, v24, v35
    v_cvt_pk_bf16_f32 v33, v34, v35
    v_mfma_f32_32x32x16_bf16 v[48:63], a[112:115], a[48:51], v[48:63]
    v_exp_f32 v37, v37
    v_add_f32 v24, v24, v36
    v_exp_f32 v38, v38
    v_add_f32 v24, v24, v37
    v_mfma_f32_32x32x16_bf16 v[48:63], a[116:119], a[52:55], v[48:63]
    v_cvt_pk_bf16_f32 v34, v36, v37
    v_exp_f32 v39, v39
    v_add_f32 v24, v24, v38
    v_exp_f32 v40, v40
    v_mfma_f32_32x32x16_bf16 v[48:63], a[120:123], a[56:59], v[48:63]
    s_waitcnt lgkmcnt(0)
    v_add_f32 v24, v24, v39
    v_cvt_pk_bf16_f32 v35, v38, v39
    v_exp_f32 v41, v41
    v_add_f32 v24, v24, v40
    v_mfma_f32_32x32x16_bf16 v[48:63], a[124:127], a[60:63], v[48:63]
    v_exp_f32 v42, v42
    v_add_f32 v24, v24, v41
    v_cvt_pk_bf16_f32 v40, v40, v41
    v_exp_f32 v43, v43
    v_mfma_f32_32x32x16_bf16 v[64:79], a[128:131], v[32:35], 0
    v_add_f32 v24, v24, v42
    v_exp_f32 v44, v44
    v_add_f32 v24, v24, v43
    v_cvt_pk_bf16_f32 v41, v42, v43
    v_mfma_f32_32x32x16_bf16 v[80:95], a[132:135], v[32:35], 0
    v_exp_f32 v45, v45
    v_add_f32 v24, v24, v44
    v_exp_f32 v46, v46
    v_add_f32 v24, v24, v45
    v_mfma_f32_32x32x16_bf16 v[96:111], a[136:139], v[32:35], 0
    v_cvt_pk_bf16_f32 v42, v44, v45
    v_exp_f32 v47, v47
    v_add_f32 v24, v24, v46
    v_add_f32 v24, v24, v47
    v_cvt_pk_bf16_f32 v43, v46, v47
    v_mfma_f32_32x32x16_bf16 v[112:127], a[140:143], v[32:35], 0
    v_exp_f32 v48, v48
    v_exp_f32 v49, v49
    v_add_f32 v25, v25, v48
    v_mfma_f32_32x32x16_bf16 v[64:79], a[144:147], v[40:43], v[64:79]
    v_exp_f32 v50, v50
    v_add_f32 v25, v25, v49
    v_cvt_pk_bf16_f32 v48, v48, v49
    v_mfma_f32_32x32x16_bf16 v[80:95], a[148:151], v[40:43], v[80:95]
    v_exp_f32 v51, v51
    v_add_f32 v25, v25, v50
    v_exp_f32 v52, v52
    ds_write_b128 v22, v[192:195] offset:32768
    v_pk_mul_f32 v[200:201], v[200:201], s[56:57] op_sel:[0,0] op_sel_hi:[1,0]
    v_cvt_pk_bf16_f32 v200, v200, v201
    v_pk_mul_f32 v[202:203], v[202:203], s[56:57] op_sel:[0,0] op_sel_hi:[1,0]
    v_cvt_pk_bf16_f32 v201, v202, v203
    v_pk_mul_f32 v[204:205], v[204:205], s[56:57] op_sel:[0,0] op_sel_hi:[1,0]
    v_cvt_pk_bf16_f32 v202, v204, v205
    v_pk_mul_f32 v[206:207], v[206:207], s[56:57] op_sel:[0,0] op_sel_hi:[1,0]
    v_cvt_pk_bf16_f32 v203, v206, v207
    ds_write_b128 v22, v[200:203] offset:33792
    v_pk_mul_f32 v[208:209], v[208:209], s[56:57] op_sel:[0,0] op_sel_hi:[1,0]
    v_cvt_pk_bf16_f32 v208, v208, v209
    v_pk_mul_f32 v[210:211], v[210:211], s[56:57] op_sel:[0,0] op_sel_hi:[1,0]
    v_cvt_pk_bf16_f32 v209, v210, v211
    v_pk_mul_f32 v[212:213], v[212:213], s[56:57] op_sel:[0,0] op_sel_hi:[1,0]
    v_cvt_pk_bf16_f32 v210, v212, v213
    v_pk_mul_f32 v[214:215], v[214:215], s[56:57] op_sel:[0,0] op_sel_hi:[1,0]
    v_cvt_pk_bf16_f32 v211, v214, v215
    ds_write_b128 v22, v[208:211] offset:34816
    v_pk_mul_f32 v[216:217], v[216:217], s[56:57] op_sel:[0,0] op_sel_hi:[1,0]
    v_cvt_pk_bf16_f32 v216, v216, v217
    v_pk_mul_f32 v[218:219], v[218:219], s[56:57] op_sel:[0,0] op_sel_hi:[1,0]
    v_cvt_pk_bf16_f32 v217, v218, v219
    v_pk_mul_f32 v[220:221], v[220:221], s[56:57] op_sel:[0,0] op_sel_hi:[1,0]
    v_cvt_pk_bf16_f32 v218, v220, v221
    v_pk_mul_f32 v[222:223], v[222:223], s[56:57] op_sel:[0,0] op_sel_hi:[1,0]
    v_cvt_pk_bf16_f32 v219, v222, v223
    ds_write_b128 v22, v[216:219] offset:35840
    v_pk_mul_f32 v[224:225], v[224:225], s[56:57] op_sel:[0,0] op_sel_hi:[1,0]
    v_cvt_pk_bf16_f32 v224, v224, v225
    v_pk_mul_f32 v[226:227], v[226:227], s[56:57] op_sel:[0,0] op_sel_hi:[1,0]
    v_cvt_pk_bf16_f32 v225, v226, v227
    v_pk_mul_f32 v[228:229], v[228:229], s[56:57] op_sel:[0,0] op_sel_hi:[1,0]
    v_cvt_pk_bf16_f32 v226, v228, v229
    v_pk_mul_f32 v[230:231], v[230:231], s[56:57] op_sel:[0,0] op_sel_hi:[1,0]
    v_cvt_pk_bf16_f32 v227, v230, v231
    ds_write_b128 v22, v[224:227] offset:40960
    v_pk_mul_f32 v[232:233], v[232:233], s[56:57] op_sel:[0,0] op_sel_hi:[1,0]
    v_cvt_pk_bf16_f32 v232, v232, v233
    v_pk_mul_f32 v[234:235], v[234:235], s[56:57] op_sel:[0,0] op_sel_hi:[1,0]
    v_cvt_pk_bf16_f32 v233, v234, v235
    v_pk_mul_f32 v[236:237], v[236:237], s[56:57] op_sel:[0,0] op_sel_hi:[1,0]
    v_cvt_pk_bf16_f32 v234, v236, v237
    v_pk_mul_f32 v[238:239], v[238:239], s[56:57] op_sel:[0,0] op_sel_hi:[1,0]
    v_cvt_pk_bf16_f32 v235, v238, v239
    ds_write_b128 v22, v[232:235] offset:41984
    v_pk_mul_f32 v[240:241], v[240:241], s[56:57] op_sel:[0,0] op_sel_hi:[1,0]
    v_cvt_pk_bf16_f32 v240, v240, v241
    v_pk_mul_f32 v[242:243], v[242:243], s[56:57] op_sel:[0,0] op_sel_hi:[1,0]
    v_cvt_pk_bf16_f32 v241, v242, v243
    v_pk_mul_f32 v[244:245], v[244:245], s[56:57] op_sel:[0,0] op_sel_hi:[1,0]
    v_cvt_pk_bf16_f32 v242, v244, v245
    v_pk_mul_f32 v[246:247], v[246:247], s[56:57] op_sel:[0,0] op_sel_hi:[1,0]
    v_cvt_pk_bf16_f32 v243, v246, v247
    ds_write_b128 v22, v[240:243] offset:43008
    v_pk_mul_f32 v[248:249], v[248:249], s[56:57] op_sel:[0,0] op_sel_hi:[1,0]
    v_cvt_pk_bf16_f32 v248, v248, v249
    v_pk_mul_f32 v[250:251], v[250:251], s[56:57] op_sel:[0,0] op_sel_hi:[1,0]
    v_cvt_pk_bf16_f32 v249, v250, v251
    v_pk_mul_f32 v[252:253], v[252:253], s[56:57] op_sel:[0,0] op_sel_hi:[1,0]
    v_cvt_pk_bf16_f32 v250, v252, v253
    v_pk_mul_f32 v[254:255], v[254:255], s[56:57] op_sel:[0,0] op_sel_hi:[1,0]
    v_cvt_pk_bf16_f32 v251, v254, v255
    ds_write_b128 v22, v[248:251] offset:44032
    s_waitcnt lgkmcnt(0)
    s_barrier
    ds_read_b128 a[64:67], v23 offset:32768
    ds_read_b128 a[68:71], v23 offset:33792
    ds_read_b128 a[72:75], v23 offset:34816
    ds_read_b128 a[76:79], v23 offset:35840
    ds_read_b128 a[80:83], v23 offset:40960
    ds_read_b128 a[84:87], v23 offset:41984
    ds_read_b128 a[88:91], v23 offset:43008
    ds_read_b128 a[92:95], v23 offset:44032
    v_mfma_f32_32x32x16_bf16 v[96:111], a[152:155], v[40:43], v[96:111]
    v_add_f32 v25, v25, v51
    v_cvt_pk_bf16_f32 v49, v50, v51
    v_exp_f32 v53, v53
    v_add_f32 v25, v25, v52
    v_mfma_f32_32x32x16_bf16 v[112:127], a[156:159], v[40:43], v[112:127]
    s_waitcnt lgkmcnt(7)
    v_exp_f32 v54, v54
    v_add_f32 v25, v25, v53
    v_cvt_pk_bf16_f32 v50, v52, v53
    v_mfma_f32_32x32x16_bf16 v[32:47], a[96:99], a[64:67], 0
    s_waitcnt lgkmcnt(6)
    v_exp_f32 v55, v55
    v_add_f32 v25, v25, v54
    v_exp_f32 v56, v56
    v_mfma_f32_32x32x16_bf16 v[32:47], a[100:103], a[68:71], v[32:47]
    s_waitcnt lgkmcnt(5)
    v_add_f32 v25, v25, v55
    v_cvt_pk_bf16_f32 v51, v54, v55
    v_exp_f32 v57, v57
    v_add_f32 v25, v25, v56
    v_mfma_f32_32x32x16_bf16 v[32:47], a[104:107], a[72:75], v[32:47]
    s_waitcnt lgkmcnt(4)
    v_exp_f32 v58, v58
    v_add_f32 v25, v25, v57
    v_cvt_pk_bf16_f32 v56, v56, v57
    v_mfma_f32_32x32x16_bf16 v[32:47], a[108:111], a[76:79], v[32:47]
    s_waitcnt lgkmcnt(1)
    v_exp_f32 v59, v59
    v_add_f32 v25, v25, v58
    v_exp_f32 v60, v60
    v_mfma_f32_32x32x16_bf16 v[32:47], a[112:115], a[80:83], v[32:47]
    v_add_f32 v25, v25, v59
    v_cvt_pk_bf16_f32 v57, v58, v59
    v_exp_f32 v61, v61
    v_add_f32 v25, v25, v60
    v_mfma_f32_32x32x16_bf16 v[32:47], a[116:119], a[84:87], v[32:47]
    v_exp_f32 v62, v62
    v_add_f32 v25, v25, v61
    v_cvt_pk_bf16_f32 v58, v60, v61
    v_mfma_f32_32x32x16_bf16 v[32:47], a[120:123], a[88:91], v[32:47]
    s_waitcnt lgkmcnt(0)
    s_barrier
    v_exp_f32 v63, v63
    v_add_f32 v25, v25, v62
    v_add_f32 v25, v25, v63
    v_cvt_pk_bf16_f32 v59, v62, v63
    v_mfma_f32_32x32x16_bf16 v[32:47], a[124:127], a[92:95], v[32:47]
    v_mfma_f32_32x32x16_bf16 v[128:143], a[128:131], v[48:51], 0
    s_mul_i32 s74, s38, 3072
    s_add_u32 m0, s52, 49152
    v_mfma_f32_32x32x16_bf16 v[144:159], a[132:135], v[48:51], 0
    buffer_load_dwordx4 v20, s[16:19], s45 offen offset:0 nt lds
    v_exp_f32 v32, v32
    v_exp_f32 v33, v33
    v_mfma_f32_32x32x16_bf16 v[160:175], a[136:139], v[48:51], 0
    v_add_f32 v26, v26, v32
    v_exp_f32 v34, v34
    v_add_f32 v26, v26, v33
    v_cvt_pk_bf16_f32 v32, v32, v33
    v_mov_b32 v9, s74
    v_mfma_f32_32x32x16_bf16 v[176:191], a[140:143], v[48:51], 0
    buffer_load_dwordx4 v20, s[16:19], s46 offen offset:1024 nt lds
    v_exp_f32 v35, v35
    v_add_f32 v26, v26, v34
    v_mfma_f32_32x32x16_bf16 v[128:143], a[144:147], v[56:59], v[128:143]
    v_exp_f32 v36, v36
    v_add_f32 v26, v26, v35
    v_cvt_pk_bf16_f32 v33, v34, v35
    v_lshl_add_u32 v8, v0, 4, v9
    v_mfma_f32_32x32x16_bf16 v[144:159], a[148:151], v[56:59], v[144:159]
    buffer_load_dwordx4 v20, s[16:19], s47 offen offset:2048 nt lds
    v_exp_f32 v37, v37
    v_add_f32 v26, v26, v36
    v_mfma_f32_32x32x16_bf16 v[160:175], a[152:155], v[56:59], v[160:175]
    v_exp_f32 v38, v38
    v_add_f32 v26, v26, v37
    v_cvt_pk_bf16_f32 v34, v36, v37
    v_mov_b32 v4, -1
    v_mfma_f32_32x32x16_bf16 v[176:191], a[156:159], v[56:59], v[176:191]
    buffer_load_dwordx4 v20, s[16:19], s48 offen offset:3072 nt lds
    v_xor_b32 v20, 24576, v20
    v_exp_f32 v39, v39
    v_add_f32 v26, v26, v38
    v_mfma_f32_32x32x16_bf16 v[48:63], a[160:163], a[0:3], 0
    v_exp_f32 v40, v40
    v_add_f32 v26, v26, v39
    v_cvt_pk_bf16_f32 v35, v38, v39
    v_mfma_f32_32x32x16_bf16 v[48:63], a[164:167], a[4:7], v[48:63]
    v_exp_f32 v41, v41
    v_add_f32 v26, v26, v40
    v_exp_f32 v42, v42
    v_mov_b32 v5, -1
    v_mfma_f32_32x32x16_bf16 v[48:63], a[168:171], a[8:11], v[48:63]
    v_add_f32 v26, v26, v41
    v_cvt_pk_bf16_f32 v40, v40, v41
    v_exp_f32 v43, v43
    v_add_f32 v26, v26, v42
    v_mfma_f32_32x32x16_bf16 v[48:63], a[172:175], a[12:15], v[48:63]
    v_exp_f32 v44, v44
    v_add_f32 v26, v26, v43
    v_cvt_pk_bf16_f32 v41, v42, v43
    v_mov_b32 v6, -1
    v_mfma_f32_32x32x16_bf16 v[48:63], a[176:179], a[16:19], v[48:63]
    v_exp_f32 v45, v45
    v_add_f32 v26, v26, v44
    v_exp_f32 v46, v46
    v_mfma_f32_32x32x16_bf16 v[48:63], a[180:183], a[20:23], v[48:63]
    v_add_f32 v26, v26, v45
    v_cvt_pk_bf16_f32 v42, v44, v45
    v_exp_f32 v47, v47
    v_add_f32 v26, v26, v46
    v_mov_b32 v7, -1
    v_mfma_f32_32x32x16_bf16 v[48:63], a[184:187], a[24:27], v[48:63]
    v_add_f32 v26, v26, v47
    v_cvt_pk_bf16_f32 v43, v46, v47
    v_mfma_f32_32x32x16_bf16 v[48:63], a[188:191], a[28:31], v[48:63]
    v_bfe_u32 v1, v0, 4, 1
    v_mfma_f32_32x32x16_bf16 v[192:207], a[128:131], v[32:35], 0
    v_mfma_f32_32x32x16_bf16 v[208:223], a[132:135], v[32:35], 0
    v_exp_f32 v48, v48
    v_exp_f32 v49, v49
    v_mfma_f32_32x32x16_bf16 v[224:239], a[136:139], v[32:35], 0
    s_lshl_b32 s74, s6, 2
    v_add_f32 v24, v24, v48
    v_exp_f32 v50, v50
    v_add_f32 v24, v24, v49
    v_mfma_f32_32x32x16_bf16 v[240:255], a[140:143], v[32:35], 0
    v_cvt_pk_bf16_f32 v48, v48, v49
    v_exp_f32 v51, v51
    v_add_f32 v24, v24, v50
    v_mfma_f32_32x32x16_bf16 v[192:207], a[144:147], v[40:43], v[192:207]
    v_exp_f32 v52, v52
    v_add_f32 v24, v24, v51
    v_cvt_pk_bf16_f32 v49, v50, v51
    v_lshl_add_u32 v1, v1, 1, s74
    v_mfma_f32_32x32x16_bf16 v[208:223], a[148:151], v[40:43], v[208:223]
    v_exp_f32 v53, v53
    v_add_f32 v24, v24, v52
    v_mfma_f32_32x32x16_bf16 v[224:239], a[152:155], v[40:43], v[224:239]
    v_exp_f32 v54, v54
    v_add_f32 v24, v24, v53
    v_cvt_pk_bf16_f32 v50, v52, v53
    v_and_b32 v2, 7, v0
    v_mfma_f32_32x32x16_bf16 v[240:255], a[156:159], v[40:43], v[240:255]
    v_exp_f32 v55, v55
    v_add_f32 v24, v24, v54
    v_mfma_f32_32x32x16_bf16 v[32:47], a[160:163], a[32:35], 0
    v_exp_f32 v56, v56
    v_add_f32 v24, v24, v55
    v_cvt_pk_bf16_f32 v51, v54, v55
    v_xor_b32 v1, v1, v2
    v_mfma_f32_32x32x16_bf16 v[32:47], a[164:167], a[36:39], v[32:47]
    v_exp_f32 v57, v57
    v_add_f32 v24, v24, v56
    v_mfma_f32_32x32x16_bf16 v[32:47], a[168:171], a[40:43], v[32:47]
    v_exp_f32 v58, v58
    v_add_f32 v24, v24, v57
    v_cvt_pk_bf16_f32 v56, v56, v57
    v_mfma_f32_32x32x16_bf16 v[32:47], a[172:175], a[44:47], v[32:47]
    v_exp_f32 v59, v59
    v_add_f32 v24, v24, v58
    v_lshlrev_b32 v1, 4, v1
    v_mfma_f32_32x32x16_bf16 v[32:47], a[176:179], a[48:51], v[32:47]
    v_exp_f32 v60, v60
    v_add_f32 v24, v24, v59
    v_cvt_pk_bf16_f32 v57, v58, v59
    v_mfma_f32_32x32x16_bf16 v[32:47], a[180:183], a[52:55], v[32:47]
    v_exp_f32 v61, v61
    v_add_f32 v24, v24, v60
    v_lshrrev_b32 v2, 3, v0
    v_mfma_f32_32x32x16_bf16 v[32:47], a[184:187], a[56:59], v[32:47]
    v_exp_f32 v62, v62
    v_add_f32 v24, v24, v61
    v_cvt_pk_bf16_f32 v58, v60, v61
    v_mfma_f32_32x32x16_bf16 v[32:47], a[188:191], a[60:63], v[32:47]
    s_add_u32 m0, s52, 73728
    v_exp_f32 v63, v63
    v_add_f32 v24, v24, v62
    v_add_f32 v24, v24, v63
    v_lshl_add_u32 v1, v2, 10, v1
    v_mfma_f32_32x32x16_bf16 v[64:79], a[192:195], v[48:51], v[64:79]
    buffer_load_dwordx4 v21, s[20:23], s45 offen offset:0 nt lds
    v_cvt_pk_bf16_f32 v59, v62, v63
    v_mfma_f32_32x32x16_bf16 v[80:95], a[196:199], v[48:51], v[80:95]
    s_lshl_b32 s74, s3, 2
    v_exp_f32 v32, v32
    v_exp_f32 v33, v33
    v_add_f32 v25, v25, v32
    v_mfma_f32_32x32x16_bf16 v[96:111], a[200:203], v[48:51], v[96:111]
    buffer_load_dwordx4 v21, s[20:23], s46 offen offset:1024 nt lds
    v_exp_f32 v34, v34
    v_add_f32 v25, v25, v33
    v_cvt_pk_bf16_f32 v32, v32, v33
    v_mfma_f32_32x32x16_bf16 v[112:127], a[204:207], v[48:51], v[112:127]
    v_exp_f32 v35, v35
    v_add_f32 v25, v25, v34
    v_exp_f32 v36, v36
    v_mfma_f32_32x32x16_bf16 v[64:79], a[208:211], v[56:59], v[64:79]
    buffer_load_dwordx4 v21, s[20:23], s47 offen offset:2048 nt lds
    s_add_u32 s74, s74, s38
    v_add_f32 v25, v25, v35
    v_cvt_pk_bf16_f32 v33, v34, v35
    v_exp_f32 v37, v37
    v_mfma_f32_32x32x16_bf16 v[80:95], a[212:215], v[56:59], v[80:95]
    v_add_f32 v25, v25, v36
    v_exp_f32 v38, v38
    v_add_f32 v25, v25, v37
    v_cvt_pk_bf16_f32 v34, v36, v37
    v_mfma_f32_32x32x16_bf16 v[96:111], a[216:219], v[56:59], v[96:111]
    buffer_load_dwordx4 v21, s[20:23], s48 offen offset:3072 nt lds
    s_lshl_b32 s74, s74, 17
    v_xor_b32 v21, 24576, v21
    v_exp_f32 v39, v39
    v_add_f32 v25, v25, v38
    v_mfma_f32_32x32x16_bf16 v[112:127], a[220:223], v[56:59], v[112:127]
    v_exp_f32 v40, v40
    v_add_f32 v25, v25, v39
    v_cvt_pk_bf16_f32 v35, v38, v39
    v_mfma_f32_32x32x16_bf16 v[48:63], a[160:163], a[64:67], 0
    v_exp_f32 v41, v41
    v_add_f32 v25, v25, v40
    v_exp_f32 v42, v42
    v_add_u32 v19, s74, v1
    v_mfma_f32_32x32x16_bf16 v[48:63], a[164:167], a[68:71], v[48:63]
    v_add_f32 v25, v25, v41
    v_cvt_pk_bf16_f32 v40, v40, v41
    v_exp_f32 v43, v43
    v_add_f32 v25, v25, v42
    v_mfma_f32_32x32x16_bf16 v[48:63], a[168:171], a[72:75], v[48:63]
    v_exp_f32 v44, v44
    v_add_f32 v25, v25, v43
    v_cvt_pk_bf16_f32 v41, v42, v43
    v_add_u32 v18, s59, v19
    v_mfma_f32_32x32x16_bf16 v[48:63], a[172:175], a[76:79], v[48:63]
    v_exp_f32 v45, v45
    v_add_f32 v25, v25, v44
    v_exp_f32 v46, v46
    v_mfma_f32_32x32x16_bf16 v[48:63], a[176:179], a[80:83], v[48:63]
    v_add_f32 v25, v25, v45
    v_cvt_pk_bf16_f32 v42, v44, v45
    v_exp_f32 v47, v47
    v_add_f32 v25, v25, v46
    v_mfma_f32_32x32x16_bf16 v[48:63], a[180:183], a[84:87], v[48:63]
    v_add_f32 v25, v25, v47
    v_cvt_pk_bf16_f32 v43, v46, v47
    v_xor_b32 v23, 0x1000, v22
    v_mfma_f32_32x32x16_bf16 v[48:63], a[184:187], a[88:91], v[48:63]
    s_barrier
    v_mfma_f32_32x32x16_bf16 v[48:63], a[188:191], a[92:95], v[48:63]
    v_mov_b32 v28, s39
    v_mfma_f32_32x32x16_bf16 v[128:143], a[192:195], v[32:35], v[128:143]
    v_mfma_f32_32x32x16_bf16 v[144:159], a[196:199], v[32:35], v[144:159]
    v_exp_f32 v48, v48
    v_exp_f32 v49, v49
    v_add_f32 v26, v26, v48
    v_med3_u32 v2, v2, 1, 7
    v_mfma_f32_32x32x16_bf16 v[160:175], a[200:203], v[32:35], v[160:175]
    v_exp_f32 v50, v50
    v_add_f32 v26, v26, v49
    v_cvt_pk_bf16_f32 v48, v48, v49
    v_mfma_f32_32x32x16_bf16 v[176:191], a[204:207], v[32:35], v[176:191]
    v_exp_f32 v51, v51
    v_add_f32 v26, v26, v50
    v_exp_f32 v52, v52
    v_lshl_add_u32 v10, v2, 2, v9
    v_mfma_f32_32x32x16_bf16 v[128:143], a[208:211], v[40:43], v[128:143]
    v_add_f32 v26, v26, v51
    v_cvt_pk_bf16_f32 v49, v50, v51
    v_exp_f32 v53, v53
    v_add_f32 v26, v26, v52
    v_mfma_f32_32x32x16_bf16 v[144:159], a[212:215], v[40:43], v[144:159]
    v_exp_f32 v54, v54
    v_add_f32 v26, v26, v53
    v_cvt_pk_bf16_f32 v50, v52, v53
    v_mfma_f32_32x32x16_bf16 v[160:175], a[216:219], v[40:43], v[160:175]
    v_exp_f32 v55, v55
    v_add_f32 v26, v26, v54
    v_exp_f32 v56, v56
    v_mov_b32 v11, 1
    v_mfma_f32_32x32x16_bf16 v[176:191], a[220:223], v[40:43], v[176:191]
    ds_read_b64_tr_b16 a[96:97], v16 offset:0
    v_add_f32 v26, v26, v55
    v_cvt_pk_bf16_f32 v51, v54, v55
    v_exp_f32 v57, v57
    v_mfma_f32_32x32x16_bf16 v[32:47], a[224:227], a[0:3], 0
    ds_read_b64_tr_b16 a[98:99], v16 offset:4096
    v_add_f32 v26, v26, v56
    v_exp_f32 v58, v58
    v_add_f32 v26, v26, v57
    v_lshrrev_b32 v1, 4, v0
    v_mfma_f32_32x32x16_bf16 v[32:47], a[228:231], a[4:7], v[32:47]
    ds_read_b64_tr_b16 a[100:101], v17 offset:0
    v_cvt_pk_bf16_f32 v56, v56, v57
    v_exp_f32 v59, v59
    v_add_f32 v26, v26, v58
    v_mfma_f32_32x32x16_bf16 v[32:47], a[232:235], a[8:11], v[32:47]
    v_exp_f32 v60, v60
    v_add_f32 v26, v26, v59
    v_cvt_pk_bf16_f32 v57, v58, v59
    v_mul_u32_u24 v1, 3072, v1
    v_mfma_f32_32x32x16_bf16 v[32:47], a[236:239], a[12:15], v[32:47]
    ds_read_b64_tr_b16 a[102:103], v17 offset:4096
    v_exp_f32 v61, v61
    v_add_f32 v26, v26, v60
    v_mfma_f32_32x32x16_bf16 v[32:47], a[240:243], a[16:19], v[32:47]
    ds_read_b64_tr_b16 a[104:105], v16 offset:1024
    v_exp_f32 v62, v62
    v_add_f32 v26, v26, v61
    v_cvt_pk_bf16_f32 v58, v60, v61
    v_and_b32 v2, 15, v0
    v_mfma_f32_32x32x16_bf16 v[32:47], a[244:247], a[20:23], v[32:47]
    v_exp_f32 v63, v63
    v_add_f32 v26, v26, v62
    v_add_f32 v26, v26, v63
    v_cvt_pk_bf16_f32 v59, v62, v63
    v_mfma_f32_32x32x16_bf16 v[32:47], a[248:251], a[24:27], v[32:47]
    ds_read_b64_tr_b16 a[106:107], v16 offset:5120
    s_add_u32 m0, s52, 57344
    v_mfma_f32_32x32x16_bf16 v[32:47], a[252:255], a[28:31], v[32:47]
    buffer_load_dwordx4 v20, s[16:19], s45 offen offset:0 nt lds
    v_lshl_add_u32 v29, v2, 2, v1
    v_mfma_f32_32x32x16_bf16 v[192:207], a[192:195], v[48:51], v[192:207]
    ds_read_b64_tr_b16 a[108:109], v17 offset:1024
    v_mfma_f32_32x32x16_bf16 v[208:223], a[196:199], v[48:51], v[208:223]
    buffer_load_dwordx4 v20, s[16:19], s46 offen offset:1024 nt lds
    v_exp_f32 v32, v32
    v_exp_f32 v33, v33
    v_mov_b32 v30, 0
    v_mfma_f32_32x32x16_bf16 v[224:239], a[200:203], v[48:51], v[224:239]
    ds_read_b64_tr_b16 a[110:111], v17 offset:5120
    v_add_f32 v24, v24, v32
    v_exp_f32 v34, v34
    v_add_f32 v24, v24, v33
    v_mfma_f32_32x32x16_bf16 v[240:255], a[204:207], v[48:51], v[240:255]
    buffer_load_dwordx4 v20, s[16:19], s47 offen offset:2048 nt lds
    s_lshl_b32 s74, s3, 4
    v_cvt_pk_bf16_f32 v32, v32, v33
    v_exp_f32 v35, v35
    v_add_f32 v24, v24, v34
    v_mfma_f32_32x32x16_bf16 v[192:207], a[208:211], v[56:59], v[192:207]
    ds_read_b64_tr_b16 a[112:113], v16 offset:2048
    v_exp_f32 v36, v36
    v_add_f32 v24, v24, v35
    v_cvt_pk_bf16_f32 v33, v34, v35
    v_mfma_f32_32x32x16_bf16 v[208:223], a[212:215], v[56:59], v[208:223]
    buffer_load_dwordx4 v20, s[16:19], s48 offen offset:3072 nt lds
    s_add_u32 s74, s74, s4
    v_xor_b32 v20, 8192, v20
    v_exp_f32 v37, v37
    v_add_f32 v24, v24, v36
    v_mfma_f32_32x32x16_bf16 v[224:239], a[216:219], v[56:59], v[224:239]
    ds_read_b64_tr_b16 a[114:115], v16 offset:6144
    v_exp_f32 v38, v38
    v_add_f32 v24, v24, v37
    v_cvt_pk_bf16_f32 v34, v36, v37
    v_mfma_f32_32x32x16_bf16 v[240:255], a[220:223], v[56:59], v[240:255]
    ds_read_b64_tr_b16 a[116:117], v17 offset:2048
    v_exp_f32 v39, v39
    v_add_f32 v24, v24, v38
    v_mfma_f32_32x32x16_bf16 v[48:63], a[224:227], a[32:35], 0
    ds_read_b64_tr_b16 a[118:119], v17 offset:6144
    s_lshl_b32 s74, s74, 2
    v_exp_f32 v40, v40
    v_add_f32 v24, v24, v39
    v_cvt_pk_bf16_f32 v35, v38, v39
    v_mfma_f32_32x32x16_bf16 v[48:63], a[228:231], a[36:39], v[48:63]
    ds_read_b64_tr_b16 a[120:121], v16 offset:3072
    v_exp_f32 v41, v41
    v_add_f32 v24, v24, v40
    v_mfma_f32_32x32x16_bf16 v[48:63], a[232:235], a[40:43], v[48:63]
    ds_read_b64_tr_b16 a[122:123], v16 offset:7168
    s_add_u32 s74, s74, s38
    v_exp_f32 v42, v42
    v_add_f32 v24, v24, v41
    v_cvt_pk_bf16_f32 v40, v40, v41
    v_mfma_f32_32x32x16_bf16 v[48:63], a[236:239], a[44:47], v[48:63]
    ds_read_b64_tr_b16 a[124:125], v17 offset:3072
    v_exp_f32 v43, v43
    v_add_f32 v24, v24, v42
    v_mfma_f32_32x32x16_bf16 v[48:63], a[240:243], a[48:51], v[48:63]
    ds_read_b64_tr_b16 a[126:127], v17 offset:7168
    s_lshl_b32 s74, s74, 13
    v_exp_f32 v44, v44
    v_add_f32 v24, v24, v43
    v_cvt_pk_bf16_f32 v41, v42, v43
    v_mfma_f32_32x32x16_bf16 v[48:63], a[244:247], a[52:55], v[48:63]
    v_exp_f32 v45, v45
    v_add_f32 v24, v24, v44
    v_exp_f32 v46, v46
    v_mfma_f32_32x32x16_bf16 v[48:63], a[248:251], a[56:59], v[48:63]
    v_add_f32 v24, v24, v45
    v_cvt_pk_bf16_f32 v42, v44, v45
    v_exp_f32 v47, v47
    v_add_f32 v24, v24, v46
    v_lshl_add_u32 v27, v0, 7, s74
    v_mfma_f32_32x32x16_bf16 v[48:63], a[252:255], a[60:63], v[48:63]
    s_waitcnt lgkmcnt(3)
    v_add_f32 v24, v24, v47
    v_cvt_pk_bf16_f32 v43, v46, v47
    v_mfma_f32_32x32x16_bf16 v[64:79], a[96:99], v[32:35], v[64:79]
    v_mfma_f32_32x32x16_bf16 v[80:95], a[100:103], v[32:35], v[80:95]
    v_exp_f32 v48, v48
    v_exp_f32 v49, v49
    v_add_f32 v25, v25, v48
    v_mfma_f32_32x32x16_bf16 v[96:111], a[104:107], v[32:35], v[96:111]
    v_exp_f32 v50, v50
    v_add_f32 v25, v25, v49
    v_cvt_pk_bf16_f32 v48, v48, v49
    v_mfma_f32_32x32x16_bf16 v[112:127], a[108:111], v[32:35], v[112:127]
    v_exp_f32 v51, v51
    v_add_f32 v25, v25, v50
    v_exp_f32 v52, v52
    v_mfma_f32_32x32x16_bf16 v[64:79], a[112:115], v[40:43], v[64:79]
    v_add_f32 v25, v25, v51
    v_cvt_pk_bf16_f32 v49, v50, v51
    v_exp_f32 v53, v53
    v_add_f32 v25, v25, v52
    v_mfma_f32_32x32x16_bf16 v[80:95], a[116:119], v[40:43], v[80:95]
    s_waitcnt lgkmcnt(0)
    v_exp_f32 v54, v54
    v_add_f32 v25, v25, v53
    v_cvt_pk_bf16_f32 v50, v52, v53
    v_mfma_f32_32x32x16_bf16 v[96:111], a[120:123], v[40:43], v[96:111]
    v_exp_f32 v55, v55
    v_add_f32 v25, v25, v54
    v_exp_f32 v56, v56
    v_mfma_f32_32x32x16_bf16 v[112:127], a[124:127], v[40:43], v[112:127]
    v_add_f32 v25, v25, v55
    v_cvt_pk_bf16_f32 v51, v54, v55
    v_exp_f32 v57, v57
    v_add_f32 v25, v25, v56
    v_mfma_f32_32x32x16_bf16 v[32:47], a[224:227], a[64:67], 0
    v_exp_f32 v58, v58
    v_add_f32 v25, v25, v57
    v_cvt_pk_bf16_f32 v56, v56, v57
    v_mfma_f32_32x32x16_bf16 v[32:47], a[228:231], a[68:71], v[32:47]
    v_exp_f32 v59, v59
    v_add_f32 v25, v25, v58
    v_exp_f32 v60, v60
    v_mfma_f32_32x32x16_bf16 v[32:47], a[232:235], a[72:75], v[32:47]
    v_add_f32 v25, v25, v59
    v_cvt_pk_bf16_f32 v57, v58, v59
    v_exp_f32 v61, v61
    v_add_f32 v25, v25, v60
    v_mfma_f32_32x32x16_bf16 v[32:47], a[236:239], a[76:79], v[32:47]
    v_exp_f32 v62, v62
    v_add_f32 v25, v25, v61
    v_cvt_pk_bf16_f32 v58, v60, v61
    v_mfma_f32_32x32x16_bf16 v[32:47], a[240:243], a[80:83], v[32:47]
    v_exp_f32 v63, v63
    v_add_f32 v25, v25, v62
    v_add_f32 v25, v25, v63
    v_cvt_pk_bf16_f32 v59, v62, v63
    v_mfma_f32_32x32x16_bf16 v[32:47], a[244:247], a[84:87], v[32:47]
    s_cmp_lg_u32 s38, 0
    s_cbranch_scc1 L_w0_1
    buffer_store_dword v30, v29, s[32:35], s66 offen sc1
L_w0_1:
    v_mfma_f32_32x32x16_bf16 v[32:47], a[248:251], a[88:91], v[32:47]
    s_waitcnt vmcnt(20)
    s_barrier
    s_add_u32 m0, s52, 40960
    v_mfma_f32_32x32x16_bf16 v[32:47], a[252:255], a[92:95], v[32:47]
    buffer_load_dwordx4 v21, s[20:23], s45 offen offset:0 nt lds
    ds_read_b128 a[128:131], v12 offset:8192
    v_mfma_f32_32x32x16_bf16 v[128:143], a[96:99], v[48:51], v[128:143]
    ds_read_b128 a[132:135], v13 offset:8192
    v_mfma_f32_32x32x16_bf16 v[144:159], a[100:103], v[48:51], v[144:159]
    buffer_load_dwordx4 v21, s[20:23], s46 offen offset:1024 nt lds
    ds_read_b128 a[136:139], v14 offset:8192
    v_exp_f32 v32, v32
    v_mfma_f32_32x32x16_bf16 v[160:175], a[104:107], v[48:51], v[160:175]
    ds_read_b128 a[140:143], v15 offset:8192
    v_exp_f32 v33, v33
    v_add_f32 v26, v26, v32
    v_exp_f32 v34, v34
    v_mfma_f32_32x32x16_bf16 v[176:191], a[108:111], v[48:51], v[176:191]
    buffer_load_dwordx4 v21, s[20:23], s47 offen offset:2048 nt lds
    ds_read_b128 a[144:147], v12 offset:9216
    v_add_f32 v26, v26, v33
    v_cvt_pk_bf16_f32 v32, v32, v33
    v_mfma_f32_32x32x16_bf16 v[128:143], a[112:115], v[56:59], v[128:143]
    ds_read_b128 a[148:151], v13 offset:9216
    v_exp_f32 v35, v35
    v_add_f32 v26, v26, v34
    v_exp_f32 v36, v36
    v_mfma_f32_32x32x16_bf16 v[144:159], a[116:119], v[56:59], v[144:159]
    buffer_load_dwordx4 v21, s[20:23], s48 offen offset:3072 nt lds
    ds_read_b128 a[152:155], v14 offset:9216
    v_xor_b32 v21, 8192, v21
    v_add_f32 v26, v26, v35
    v_cvt_pk_bf16_f32 v33, v34, v35
    v_mfma_f32_32x32x16_bf16 v[160:175], a[120:123], v[56:59], v[160:175]
    ds_read_b128 a[156:159], v15 offset:9216
    v_exp_f32 v37, v37
    v_add_f32 v26, v26, v36
    v_exp_f32 v38, v38
    v_mfma_f32_32x32x16_bf16 v[176:191], a[124:127], v[56:59], v[176:191]
    ds_read_b64_tr_b16 a[160:161], v16 offset:8192
    s_waitcnt lgkmcnt(6)
    v_add_f32 v26, v26, v37
    v_cvt_pk_bf16_f32 v34, v36, v37
    v_exp_f32 v39, v39
    v_add_f32 v26, v26, v38
    v_mfma_f32_32x32x16_bf16 v[48:63], a[128:131], a[0:3], 0
    ds_read_b64_tr_b16 a[162:163], v16 offset:12288
    v_exp_f32 v40, v40
    v_add_f32 v26, v26, v39
    v_cvt_pk_bf16_f32 v35, v38, v39
    v_mfma_f32_32x32x16_bf16 v[48:63], a[132:135], a[4:7], v[48:63]
    ds_read_b64_tr_b16 a[164:165], v17 offset:8192
    v_exp_f32 v41, v41
    v_add_f32 v26, v26, v40
    v_exp_f32 v42, v42
    v_mfma_f32_32x32x16_bf16 v[48:63], a[136:139], a[8:11], v[48:63]
    s_waitcnt lgkmcnt(5)
    v_add_f32 v26, v26, v41
    v_cvt_pk_bf16_f32 v40, v40, v41
    v_exp_f32 v43, v43
    v_add_f32 v26, v26, v42
    v_mfma_f32_32x32x16_bf16 v[48:63], a[140:143], a[12:15], v[48:63]
    ds_read_b64_tr_b16 a[166:167], v17 offset:12288
    v_exp_f32 v44, v44
    v_add_f32 v26, v26, v43
    v_cvt_pk_bf16_f32 v41, v42, v43
    v_mfma_f32_32x32x16_bf16 v[48:63], a[144:147], a[16:19], v[48:63]
    ds_read_b64_tr_b16 a[168:169], v16 offset:9216
    v_exp_f32 v45, v45
    v_add_f32 v26, v26, v44
    v_exp_f32 v46, v46
    v_mfma_f32_32x32x16_bf16 v[48:63], a[148:151], a[20:23], v[48:63]
    s_waitcnt lgkmcnt(4)
    v_add_f32 v26, v26, v45
    v_cvt_pk_bf16_f32 v42, v44, v45
    v_exp_f32 v47, v47
    v_add_f32 v26, v26, v46
    v_add_f32 v26, v26, v47
    v_mfma_f32_32x32x16_bf16 v[48:63], a[152:155], a[24:27], v[48:63]
    ds_read_b64_tr_b16 a[170:171], v16 offset:13312
    v_cvt_pk_bf16_f32 v43, v46, v47
    v_mfma_f32_32x32x16_bf16 v[48:63], a[156:159], a[28:31], v[48:63]
    ds_read_b64_tr_b16 a[172:173], v17 offset:9216
    v_mfma_f32_32x32x16_bf16 v[192:207], a[96:99], v[32:35], v[192:207]
    v_mfma_f32_32x32x16_bf16 v[208:223], a[100:103], v[32:35], v[208:223]
    ds_read_b64_tr_b16 a[174:175], v17 offset:13312
    v_exp_f32 v48, v48
    v_exp_f32 v49, v49
    v_mfma_f32_32x32x16_bf16 v[224:239], a[104:107], v[32:35], v[224:239]
    ds_read_b64_tr_b16 a[176:177], v16 offset:10240
    v_add_f32 v24, v24, v48
    v_exp_f32 v50, v50
    v_add_f32 v24, v24, v49
    v_mfma_f32_32x32x16_bf16 v[240:255], a[108:111], v[32:35], v[240:255]
    ds_read_b64_tr_b16 a[178:179], v16 offset:14336
    v_cvt_pk_bf16_f32 v48, v48, v49
    v_exp_f32 v51, v51
    v_add_f32 v24, v24, v50
    v_mfma_f32_32x32x16_bf16 v[192:207], a[112:115], v[40:43], v[192:207]
    v_exp_f32 v52, v52
    v_add_f32 v24, v24, v51
    v_cvt_pk_bf16_f32 v49, v50, v51
    v_mfma_f32_32x32x16_bf16 v[208:223], a[116:119], v[40:43], v[208:223]
    ds_read_b64_tr_b16 a[180:181], v17 offset:10240
    v_exp_f32 v53, v53
    v_add_f32 v24, v24, v52
    v_mfma_f32_32x32x16_bf16 v[224:239], a[120:123], v[40:43], v[224:239]
    ds_read_b64_tr_b16 a[182:183], v17 offset:14336
    v_exp_f32 v54, v54
    v_add_f32 v24, v24, v53
    v_cvt_pk_bf16_f32 v50, v52, v53
    v_mfma_f32_32x32x16_bf16 v[240:255], a[124:127], v[40:43], v[240:255]
    v_exp_f32 v55, v55
    v_add_f32 v24, v24, v54
    v_exp_f32 v56, v56
    v_mfma_f32_32x32x16_bf16 v[32:47], a[128:131], a[32:35], 0
    ds_read_b64_tr_b16 a[184:185], v16 offset:11264
    v_add_f32 v24, v24, v55
    v_cvt_pk_bf16_f32 v51, v54, v55
    v_exp_f32 v57, v57
    v_mfma_f32_32x32x16_bf16 v[32:47], a[132:135], a[36:39], v[32:47]
    ds_read_b64_tr_b16 a[186:187], v16 offset:15360
    v_add_f32 v24, v24, v56
    v_exp_f32 v58, v58
    v_add_f32 v24, v24, v57
    v_mfma_f32_32x32x16_bf16 v[32:47], a[136:139], a[40:43], v[32:47]
    v_cvt_pk_bf16_f32 v56, v56, v57
    v_exp_f32 v59, v59
    v_add_f32 v24, v24, v58
    v_mfma_f32_32x32x16_bf16 v[32:47], a[140:143], a[44:47], v[32:47]
    ds_read_b64_tr_b16 a[188:189], v17 offset:11264
    v_exp_f32 v60, v60
    v_add_f32 v24, v24, v59
    v_cvt_pk_bf16_f32 v57, v58, v59
    v_mfma_f32_32x32x16_bf16 v[32:47], a[144:147], a[48:51], v[32:47]
    ds_read_b64_tr_b16 a[190:191], v17 offset:15360
    v_exp_f32 v61, v61
    v_add_f32 v24, v24, v60
    v_mfma_f32_32x32x16_bf16 v[32:47], a[148:151], a[52:55], v[32:47]
    s_add_u32 m0, s52, 32768
    v_exp_f32 v62, v62
    v_add_f32 v24, v24, v61
    v_cvt_pk_bf16_f32 v58, v60, v61
    v_mfma_f32_32x32x16_bf16 v[32:47], a[152:155], a[56:59], v[32:47]
    buffer_load_dwordx4 v20, s[16:19], s45 offen offset:0 nt lds
    v_exp_f32 v63, v63
    v_add_f32 v24, v24, v62
    v_add_f32 v24, v24, v63
    v_mfma_f32_32x32x16_bf16 v[32:47], a[156:159], a[60:63], v[32:47]
    s_waitcnt lgkmcnt(2)
    v_cvt_pk_bf16_f32 v59, v62, v63
    v_mfma_f32_32x32x16_bf16 v[64:79], a[160:163], v[48:51], v[64:79]
    buffer_load_dwordx4 v20, s[16:19], s46 offen offset:1024 nt lds
    v_mfma_f32_32x32x16_bf16 v[80:95], a[164:167], v[48:51], v[80:95]
    v_exp_f32 v32, v32
    v_exp_f32 v33, v33
    v_add_f32 v25, v25, v32
    v_mfma_f32_32x32x16_bf16 v[96:111], a[168:171], v[48:51], v[96:111]
    buffer_load_dwordx4 v20, s[16:19], s47 offen offset:2048 nt lds
    v_exp_f32 v34, v34
    v_add_f32 v25, v25, v33
    v_cvt_pk_bf16_f32 v32, v32, v33
    v_mfma_f32_32x32x16_bf16 v[112:127], a[172:175], v[48:51], v[112:127]
    v_exp_f32 v35, v35
    v_add_f32 v25, v25, v34
    v_exp_f32 v36, v36
    v_mfma_f32_32x32x16_bf16 v[64:79], a[176:179], v[56:59], v[64:79]
    buffer_load_dwordx4 v20, s[16:19], s48 offen offset:3072 nt lds
    v_xor_b32 v20, 122880, v20
    v_add_f32 v25, v25, v35
    v_cvt_pk_bf16_f32 v33, v34, v35
    v_mfma_f32_32x32x16_bf16 v[80:95], a[180:183], v[56:59], v[80:95]
    v_exp_f32 v37, v37
    v_add_f32 v25, v25, v36
    v_exp_f32 v38, v38
    v_mfma_f32_32x32x16_bf16 v[96:111], a[184:187], v[56:59], v[96:111]
    s_waitcnt lgkmcnt(0)
    v_add_f32 v25, v25, v37
    v_cvt_pk_bf16_f32 v34, v36, v37
    v_exp_f32 v39, v39
    v_add_f32 v25, v25, v38
    v_mfma_f32_32x32x16_bf16 v[112:127], a[188:191], v[56:59], v[112:127]
    v_exp_f32 v40, v40
    v_add_f32 v25, v25, v39
    v_cvt_pk_bf16_f32 v35, v38, v39
    v_mfma_f32_32x32x16_bf16 v[48:63], a[128:131], a[64:67], 0
    v_exp_f32 v41, v41
    v_add_f32 v25, v25, v40
    v_exp_f32 v42, v42
    v_mfma_f32_32x32x16_bf16 v[48:63], a[132:135], a[68:71], v[48:63]
    v_add_f32 v25, v25, v41
    v_cvt_pk_bf16_f32 v40, v40, v41
    v_exp_f32 v43, v43
    v_add_f32 v25, v25, v42
    v_mfma_f32_32x32x16_bf16 v[48:63], a[136:139], a[72:75], v[48:63]
    v_exp_f32 v44, v44
    v_add_f32 v25, v25, v43
    v_cvt_pk_bf16_f32 v41, v42, v43
    v_mfma_f32_32x32x16_bf16 v[48:63], a[140:143], a[76:79], v[48:63]
    v_exp_f32 v45, v45
    v_add_f32 v25, v25, v44
    v_exp_f32 v46, v46
    v_mfma_f32_32x32x16_bf16 v[48:63], a[144:147], a[80:83], v[48:63]
    v_add_f32 v25, v25, v45
    v_cvt_pk_bf16_f32 v42, v44, v45
    v_exp_f32 v47, v47
    v_add_f32 v25, v25, v46
    v_mfma_f32_32x32x16_bf16 v[48:63], a[148:151], a[84:87], v[48:63]
    v_add_f32 v25, v25, v47
    v_cvt_pk_bf16_f32 v43, v46, v47
    v_mfma_f32_32x32x16_bf16 v[48:63], a[152:155], a[88:91], v[48:63]
    s_waitcnt vmcnt(20)
    s_barrier
    v_mfma_f32_32x32x16_bf16 v[48:63], a[156:159], a[92:95], v[48:63]
    ds_read_b128 a[192:195], v12 offset:0
    v_mfma_f32_32x32x16_bf16 v[128:143], a[160:163], v[32:35], v[128:143]
    ds_read_b128 a[196:199], v13 offset:0
    v_mfma_f32_32x32x16_bf16 v[144:159], a[164:167], v[32:35], v[144:159]
    ds_read_b128 a[200:203], v14 offset:0
    v_exp_f32 v48, v48
    v_exp_f32 v49, v49
    v_mfma_f32_32x32x16_bf16 v[160:175], a[168:171], v[32:35], v[160:175]
    ds_read_b128 a[204:207], v15 offset:0
    v_add_f32 v26, v26, v48
    v_exp_f32 v50, v50
    v_add_f32 v26, v26, v49
    v_mfma_f32_32x32x16_bf16 v[176:191], a[172:175], v[32:35], v[176:191]
    ds_read_b128 a[208:211], v12 offset:1024
    v_cvt_pk_bf16_f32 v48, v48, v49
    v_exp_f32 v51, v51
    v_add_f32 v26, v26, v50
    v_mfma_f32_32x32x16_bf16 v[128:143], a[176:179], v[40:43], v[128:143]
    ds_read_b128 a[212:215], v13 offset:1024
    v_exp_f32 v52, v52
    v_add_f32 v26, v26, v51
    v_cvt_pk_bf16_f32 v49, v50, v51
    v_mfma_f32_32x32x16_bf16 v[144:159], a[180:183], v[40:43], v[144:159]
    ds_read_b128 a[216:219], v14 offset:1024
    v_exp_f32 v53, v53
    v_add_f32 v26, v26, v52
    v_mfma_f32_32x32x16_bf16 v[160:175], a[184:187], v[40:43], v[160:175]
    ds_read_b128 a[220:223], v15 offset:1024
    v_exp_f32 v54, v54
    v_add_f32 v26, v26, v53
    v_cvt_pk_bf16_f32 v50, v52, v53
    v_mfma_f32_32x32x16_bf16 v[176:191], a[188:191], v[40:43], v[176:191]
    ds_read_b64_tr_b16 a[224:225], v16 offset:49152
    s_waitcnt lgkmcnt(6)
    v_exp_f32 v55, v55
    v_add_f32 v26, v26, v54
    v_mfma_f32_32x32x16_bf16 v[32:47], a[192:195], a[0:3], 0
    ds_read_b64_tr_b16 a[226:227], v16 offset:53248
    v_exp_f32 v56, v56
    v_add_f32 v26, v26, v55
    v_cvt_pk_bf16_f32 v51, v54, v55
    v_mfma_f32_32x32x16_bf16 v[32:47], a[196:199], a[4:7], v[32:47]
    ds_read_b64_tr_b16 a[228:229], v17 offset:49152
    v_exp_f32 v57, v57
    v_add_f32 v26, v26, v56
    v_mfma_f32_32x32x16_bf16 v[32:47], a[200:203], a[8:11], v[32:47]
    s_waitcnt lgkmcnt(5)
    v_exp_f32 v58, v58
    v_add_f32 v26, v26, v57
    v_cvt_pk_bf16_f32 v56, v56, v57
    v_mfma_f32_32x32x16_bf16 v[32:47], a[204:207], a[12:15], v[32:47]
    ds_read_b64_tr_b16 a[230:231], v17 offset:53248
    v_exp_f32 v59, v59
    v_add_f32 v26, v26, v58
    v_mfma_f32_32x32x16_bf16 v[32:47], a[208:211], a[16:19], v[32:47]
    ds_read_b64_tr_b16 a[232:233], v16 offset:50176
    s_add_u32 m0, s52, 16384
    v_exp_f32 v60, v60
    v_add_f32 v26, v26, v59
    v_cvt_pk_bf16_f32 v57, v58, v59
    v_mfma_f32_32x32x16_bf16 v[32:47], a[212:215], a[20:23], v[32:47]
    buffer_load_dwordx4 v21, s[20:23], s45 offen offset:0 nt lds
    s_waitcnt lgkmcnt(4)
    v_exp_f32 v61, v61
    v_add_f32 v26, v26, v60
    v_mfma_f32_32x32x16_bf16 v[32:47], a[216:219], a[24:27], v[32:47]
    ds_read_b64_tr_b16 a[234:235], v16 offset:54272
    v_exp_f32 v62, v62
    v_add_f32 v26, v26, v61
    v_cvt_pk_bf16_f32 v58, v60, v61
    v_mfma_f32_32x32x16_bf16 v[32:47], a[220:223], a[28:31], v[32:47]
    buffer_load_dwordx4 v21, s[20:23], s46 offen offset:1024 nt lds
    v_exp_f32 v63, v63
    v_add_f32 v26, v26, v62
    v_add_f32 v26, v26, v63
    v_mfma_f32_32x32x16_bf16 v[192:207], a[160:163], v[48:51], v[192:207]
    ds_read_b64_tr_b16 a[236:237], v17 offset:50176
    v_cvt_pk_bf16_f32 v59, v62, v63
    v_mfma_f32_32x32x16_bf16 v[208:223], a[164:167], v[48:51], v[208:223]
    buffer_load_dwordx4 v21, s[20:23], s47 offen offset:2048 nt lds
    v_exp_f32 v32, v32
    v_exp_f32 v33, v33
    v_mfma_f32_32x32x16_bf16 v[224:239], a[168:171], v[48:51], v[224:239]
    ds_read_b64_tr_b16 a[238:239], v17 offset:54272
    v_add_f32 v24, v24, v32
    v_exp_f32 v34, v34
    v_add_f32 v24, v24, v33
    v_mfma_f32_32x32x16_bf16 v[240:255], a[172:175], v[48:51], v[240:255]
    buffer_load_dwordx4 v21, s[20:23], s48 offen offset:3072 nt lds
    v_xor_b32 v21, 122880, v21
    v_cvt_pk_bf16_f32 v32, v32, v33
    v_exp_f32 v35, v35
    v_mfma_f32_32x32x16_bf16 v[192:207], a[176:179], v[56:59], v[192:207]
    ds_read_b64_tr_b16 a[240:241], v16 offset:51200
    v_add_f32 v24, v24, v34
    v_exp_f32 v36, v36
    v_add_f32 v24, v24, v35
    v_mfma_f32_32x32x16_bf16 v[208:223], a[180:183], v[56:59], v[208:223]
    ds_read_b64_tr_b16 a[242:243], v16 offset:55296
    v_cvt_pk_bf16_f32 v33, v34, v35
    v_exp_f32 v37, v37
    v_add_f32 v24, v24, v36
    v_mfma_f32_32x32x16_bf16 v[224:239], a[184:187], v[56:59], v[224:239]
    ds_read_b64_tr_b16 a[244:245], v17 offset:51200
    v_exp_f32 v38, v38
    v_add_f32 v24, v24, v37
    v_cvt_pk_bf16_f32 v34, v36, v37
    v_mfma_f32_32x32x16_bf16 v[240:255], a[188:191], v[56:59], v[240:255]
    ds_read_b64_tr_b16 a[246:247], v17 offset:55296
    v_exp_f32 v39, v39
    v_add_f32 v24, v24, v38
    v_mfma_f32_32x32x16_bf16 v[48:63], a[192:195], a[32:35], 0
    ds_read_b64_tr_b16 a[248:249], v16 offset:52224
    v_exp_f32 v40, v40
    v_add_f32 v24, v24, v39
    v_cvt_pk_bf16_f32 v35, v38, v39
    v_mfma_f32_32x32x16_bf16 v[48:63], a[196:199], a[36:39], v[48:63]
    ds_read_b64_tr_b16 a[250:251], v16 offset:56320
    v_exp_f32 v41, v41
    v_add_f32 v24, v24, v40
    v_mfma_f32_32x32x16_bf16 v[48:63], a[200:203], a[40:43], v[48:63]
    v_exp_f32 v42, v42
    v_add_f32 v24, v24, v41
    v_cvt_pk_bf16_f32 v40, v40, v41
    v_mfma_f32_32x32x16_bf16 v[48:63], a[204:207], a[44:47], v[48:63]
    ds_read_b64_tr_b16 a[252:253], v17 offset:52224
    v_exp_f32 v43, v43
    v_add_f32 v24, v24, v42
    v_mfma_f32_32x32x16_bf16 v[48:63], a[208:211], a[48:51], v[48:63]
    ds_read_b64_tr_b16 a[254:255], v17 offset:56320
    v_exp_f32 v44, v44
    v_add_f32 v24, v24, v43
    v_cvt_pk_bf16_f32 v41, v42, v43
    v_mfma_f32_32x32x16_bf16 v[48:63], a[212:215], a[52:55], v[48:63]
    v_exp_f32 v45, v45
    v_add_f32 v24, v24, v44
    v_exp_f32 v46, v46
    v_mfma_f32_32x32x16_bf16 v[48:63], a[216:219], a[56:59], v[48:63]
    v_add_f32 v24, v24, v45
    v_cvt_pk_bf16_f32 v42, v44, v45
    v_exp_f32 v47, v47
    v_add_f32 v24, v24, v46
    v_mfma_f32_32x32x16_bf16 v[48:63], a[220:223], a[60:63], v[48:63]
    s_waitcnt lgkmcnt(2)
    v_add_f32 v24, v24, v47
    v_cvt_pk_bf16_f32 v43, v46, v47
    v_mfma_f32_32x32x16_bf16 v[64:79], a[224:227], v[32:35], v[64:79]
    v_mfma_f32_32x32x16_bf16 v[80:95], a[228:231], v[32:35], v[80:95]
    v_exp_f32 v48, v48
    v_exp_f32 v49, v49
    v_add_f32 v25, v25, v48
    v_mfma_f32_32x32x16_bf16 v[96:111], a[232:235], v[32:35], v[96:111]
    v_exp_f32 v50, v50
    v_add_f32 v25, v25, v49
    v_cvt_pk_bf16_f32 v48, v48, v49
    v_mfma_f32_32x32x16_bf16 v[112:127], a[236:239], v[32:35], v[112:127]
    v_exp_f32 v51, v51
    v_add_f32 v25, v25, v50
    v_exp_f32 v52, v52
    v_mfma_f32_32x32x16_bf16 v[64:79], a[240:243], v[40:43], v[64:79]
    v_add_f32 v25, v25, v51
    v_cvt_pk_bf16_f32 v49, v50, v51
    v_exp_f32 v53, v53
    v_add_f32 v25, v25, v52
    v_mfma_f32_32x32x16_bf16 v[80:95], a[244:247], v[40:43], v[80:95]
    v_exp_f32 v54, v54
    v_add_f32 v25, v25, v53
    v_cvt_pk_bf16_f32 v50, v52, v53
    v_mfma_f32_32x32x16_bf16 v[96:111], a[248:251], v[40:43], v[96:111]
    s_waitcnt lgkmcnt(0)
    v_exp_f32 v55, v55
    v_add_f32 v25, v25, v54
    v_exp_f32 v56, v56
    v_mfma_f32_32x32x16_bf16 v[112:127], a[252:255], v[40:43], v[112:127]
    v_add_f32 v25, v25, v55
    v_cvt_pk_bf16_f32 v51, v54, v55
    v_exp_f32 v57, v57
    v_add_f32 v25, v25, v56
    v_mfma_f32_32x32x16_bf16 v[32:47], a[192:195], a[64:67], 0
    v_exp_f32 v58, v58
    v_add_f32 v25, v25, v57
    v_cvt_pk_bf16_f32 v56, v56, v57
    v_mfma_f32_32x32x16_bf16 v[32:47], a[196:199], a[68:71], v[32:47]
    v_exp_f32 v59, v59
    v_add_f32 v25, v25, v58
    v_exp_f32 v60, v60
    v_mfma_f32_32x32x16_bf16 v[32:47], a[200:203], a[72:75], v[32:47]
    v_add_f32 v25, v25, v59
    v_cvt_pk_bf16_f32 v57, v58, v59
    v_exp_f32 v61, v61
    v_add_f32 v25, v25, v60
    v_mfma_f32_32x32x16_bf16 v[32:47], a[204:207], a[76:79], v[32:47]
    s_add_u32 m0, s52, 8192
    v_exp_f32 v62, v62
    v_add_f32 v25, v25, v61
    v_cvt_pk_bf16_f32 v58, v60, v61
    v_mfma_f32_32x32x16_bf16 v[32:47], a[208:211], a[80:83], v[32:47]
    buffer_load_dwordx4 v20, s[16:19], s45 offen offset:0 nt lds
    v_exp_f32 v63, v63
    v_add_f32 v25, v25, v62
    v_add_f32 v25, v25, v63
    v_mfma_f32_32x32x16_bf16 v[32:47], a[212:215], a[84:87], v[32:47]
    v_cvt_pk_bf16_f32 v59, v62, v63
    v_mfma_f32_32x32x16_bf16 v[32:47], a[216:219], a[88:91], v[32:47]
    s_waitcnt vmcnt(17)
    s_barrier
    v_mfma_f32_32x32x16_bf16 v[32:47], a[220:223], a[92:95], v[32:47]
    buffer_load_dwordx4 v20, s[16:19], s46 offen offset:1024 nt lds
    ds_read_b128 a[96:99], v12 offset:49152
    v_mfma_f32_32x32x16_bf16 v[128:143], a[224:227], v[48:51], v[128:143]
    ds_read_b128 a[100:103], v13 offset:49152
    v_mfma_f32_32x32x16_bf16 v[144:159], a[228:231], v[48:51], v[144:159]
    buffer_load_dwordx4 v20, s[16:19], s47 offen offset:2048 nt lds
    ds_read_b128 a[104:107], v14 offset:49152
    v_exp_f32 v32, v32
    v_mfma_f32_32x32x16_bf16 v[160:175], a[232:235], v[48:51], v[160:175]
    ds_read_b128 a[108:111], v15 offset:49152
    v_exp_f32 v33, v33
    v_add_f32 v26, v26, v32
    v_exp_f32 v34, v34
    v_mfma_f32_32x32x16_bf16 v[176:191], a[236:239], v[48:51], v[176:191]
    buffer_load_dwordx4 v20, s[16:19], s48 offen offset:3072 nt lds
    ds_read_b128 a[112:115], v12 offset:50176
    v_xor_b32 v20, 8192, v20
    v_add_f32 v26, v26, v33
    v_cvt_pk_bf16_f32 v32, v32, v33
    v_mfma_f32_32x32x16_bf16 v[128:143], a[240:243], v[56:59], v[128:143]
    ds_read_b128 a[116:119], v13 offset:50176
    v_exp_f32 v35, v35
    v_add_f32 v26, v26, v34
    v_exp_f32 v36, v36
    v_mfma_f32_32x32x16_bf16 v[144:159], a[244:247], v[56:59], v[144:159]
    ds_read_b128 a[120:123], v14 offset:50176
    v_add_f32 v26, v26, v35
    v_cvt_pk_bf16_f32 v33, v34, v35
    v_exp_f32 v37, v37
    v_add_f32 v26, v26, v36
    v_mfma_f32_32x32x16_bf16 v[160:175], a[248:251], v[56:59], v[160:175]
    ds_read_b128 a[124:127], v15 offset:50176
    v_exp_f32 v38, v38
    v_add_f32 v26, v26, v37
    v_cvt_pk_bf16_f32 v34, v36, v37
    v_mfma_f32_32x32x16_bf16 v[176:191], a[252:255], v[56:59], v[176:191]
    ds_read_b64_tr_b16 a[128:129], v16 offset:57344
    s_waitcnt lgkmcnt(6)
    v_exp_f32 v39, v39
    v_add_f32 v26, v26, v38
    v_exp_f32 v40, v40
    v_mfma_f32_32x32x16_bf16 v[48:63], a[96:99], a[0:3], 0
    ds_read_b64_tr_b16 a[130:131], v16 offset:61440
    v_add_f32 v26, v26, v39
    v_cvt_pk_bf16_f32 v35, v38, v39
    v_exp_f32 v41, v41
    v_add_f32 v26, v26, v40
    v_mfma_f32_32x32x16_bf16 v[48:63], a[100:103], a[4:7], v[48:63]
    ds_read_b64_tr_b16 a[132:133], v17 offset:57344
    v_exp_f32 v42, v42
    v_add_f32 v26, v26, v41
    v_cvt_pk_bf16_f32 v40, v40, v41
    v_mfma_f32_32x32x16_bf16 v[48:63], a[104:107], a[8:11], v[48:63]
    s_waitcnt lgkmcnt(5)
    v_exp_f32 v43, v43
    v_add_f32 v26, v26, v42
    v_exp_f32 v44, v44
    v_add_f32 v26, v26, v43
    v_mfma_f32_32x32x16_bf16 v[48:63], a[108:111], a[12:15], v[48:63]
    ds_read_b64_tr_b16 a[134:135], v17 offset:61440
    v_cvt_pk_bf16_f32 v41, v42, v43
    v_exp_f32 v45, v45
    v_add_f32 v26, v26, v44
    v_mfma_f32_32x32x16_bf16 v[48:63], a[112:115], a[16:19], v[48:63]
    ds_read_b64_tr_b16 a[136:137], v16 offset:58368
    v_exp_f32 v46, v46
    v_add_f32 v26, v26, v45
    v_cvt_pk_bf16_f32 v42, v44, v45
    v_mfma_f32_32x32x16_bf16 v[48:63], a[116:119], a[20:23], v[48:63]
    s_waitcnt lgkmcnt(4)
    v_exp_f32 v47, v47
    v_add_f32 v26, v26, v46
    v_add_f32 v26, v26, v47
    v_cvt_pk_bf16_f32 v43, v46, v47
    v_mfma_f32_32x32x16_bf16 v[48:63], a[120:123], a[24:27], v[48:63]
    ds_read_b64_tr_b16 a[138:139], v16 offset:62464
    v_mfma_f32_32x32x16_bf16 v[48:63], a[124:127], a[28:31], v[48:63]
    ds_read_b64_tr_b16 a[140:141], v17 offset:58368
    v_mfma_f32_32x32x16_bf16 v[192:207], a[224:227], v[32:35], v[192:207]
    v_mfma_f32_32x32x16_bf16 v[208:223], a[228:231], v[32:35], v[208:223]
    ds_read_b64_tr_b16 a[142:143], v17 offset:62464
    v_exp_f32 v48, v48
    v_exp_f32 v49, v49
    v_mfma_f32_32x32x16_bf16 v[224:239], a[232:235], v[32:35], v[224:239]
    ds_read_b64_tr_b16 a[144:145], v16 offset:59392
    v_add_f32 v24, v24, v48
    v_exp_f32 v50, v50
    v_add_f32 v24, v24, v49
    v_mfma_f32_32x32x16_bf16 v[240:255], a[236:239], v[32:35], v[240:255]
    ds_read_b64_tr_b16 a[146:147], v16 offset:63488
    v_cvt_pk_bf16_f32 v48, v48, v49
    v_exp_f32 v51, v51
    v_add_f32 v24, v24, v50
    v_mfma_f32_32x32x16_bf16 v[192:207], a[240:243], v[40:43], v[192:207]
    v_exp_f32 v52, v52
    v_add_f32 v24, v24, v51
    v_cvt_pk_bf16_f32 v49, v50, v51
    v_mfma_f32_32x32x16_bf16 v[208:223], a[244:247], v[40:43], v[208:223]
    ds_read_b64_tr_b16 a[148:149], v17 offset:59392
    v_exp_f32 v53, v53
    v_add_f32 v24, v24, v52
    v_mfma_f32_32x32x16_bf16 v[224:239], a[248:251], v[40:43], v[224:239]
    ds_read_b64_tr_b16 a[150:151], v17 offset:63488
    v_exp_f32 v54, v54
    v_add_f32 v24, v24, v53
    v_cvt_pk_bf16_f32 v50, v52, v53
    v_mfma_f32_32x32x16_bf16 v[240:255], a[252:255], v[40:43], v[240:255]
    v_exp_f32 v55, v55
    v_add_f32 v24, v24, v54
    v_exp_f32 v56, v56
    v_mfma_f32_32x32x16_bf16 v[32:47], a[96:99], a[32:35], 0
    ds_read_b64_tr_b16 a[152:153], v16 offset:60416
    v_add_f32 v24, v24, v55
    v_cvt_pk_bf16_f32 v51, v54, v55
    v_exp_f32 v57, v57
    v_mfma_f32_32x32x16_bf16 v[32:47], a[100:103], a[36:39], v[32:47]
    ds_read_b64_tr_b16 a[154:155], v16 offset:64512
    v_add_f32 v24, v24, v56
    v_exp_f32 v58, v58
    v_add_f32 v24, v24, v57
    v_mfma_f32_32x32x16_bf16 v[32:47], a[104:107], a[40:43], v[32:47]
    v_cvt_pk_bf16_f32 v56, v56, v57
    v_exp_f32 v59, v59
    v_add_f32 v24, v24, v58
    v_mfma_f32_32x32x16_bf16 v[32:47], a[108:111], a[44:47], v[32:47]
    ds_read_b64_tr_b16 a[156:157], v17 offset:60416
    s_add_u32 m0, s52, 24576
    v_exp_f32 v60, v60
    v_add_f32 v24, v24, v59
    v_cvt_pk_bf16_f32 v57, v58, v59
    v_mfma_f32_32x32x16_bf16 v[32:47], a[112:115], a[48:51], v[32:47]
    buffer_load_dwordx4 v21, s[20:23], s45 offen offset:0 nt lds
    v_exp_f32 v61, v61
    v_add_f32 v24, v24, v60
    v_mfma_f32_32x32x16_bf16 v[32:47], a[116:119], a[52:55], v[32:47]
    ds_read_b64_tr_b16 a[158:159], v17 offset:64512
    v_exp_f32 v62, v62
    v_add_f32 v24, v24, v61
    v_cvt_pk_bf16_f32 v58, v60, v61
    v_mfma_f32_32x32x16_bf16 v[32:47], a[120:123], a[56:59], v[32:47]
    buffer_load_dwordx4 v21, s[20:23], s46 offen offset:1024 nt lds
    v_exp_f32 v63, v63
    v_add_f32 v24, v24, v62
    v_add_f32 v24, v24, v63
    v_mfma_f32_32x32x16_bf16 v[32:47], a[124:127], a[60:63], v[32:47]
    s_waitcnt lgkmcnt(2)
    v_cvt_pk_bf16_f32 v59, v62, v63
    v_mfma_f32_32x32x16_bf16 v[64:79], a[128:131], v[48:51], v[64:79]
    buffer_load_dwordx4 v21, s[20:23], s47 offen offset:2048 nt lds
    v_mfma_f32_32x32x16_bf16 v[80:95], a[132:135], v[48:51], v[80:95]
    v_exp_f32 v32, v32
    v_exp_f32 v33, v33
    v_add_f32 v25, v25, v32
    v_mfma_f32_32x32x16_bf16 v[96:111], a[136:139], v[48:51], v[96:111]
    buffer_load_dwordx4 v21, s[20:23], s48 offen offset:3072 nt lds
    v_xor_b32 v21, 8192, v21
    v_exp_f32 v34, v34
    v_add_f32 v25, v25, v33
    v_mfma_f32_32x32x16_bf16 v[112:127], a[140:143], v[48:51], v[112:127]
    v_cvt_pk_bf16_f32 v32, v32, v33
    v_exp_f32 v35, v35
    v_add_f32 v25, v25, v34
    v_mfma_f32_32x32x16_bf16 v[64:79], a[144:147], v[56:59], v[64:79]
    v_exp_f32 v36, v36
    v_add_f32 v25, v25, v35
    v_cvt_pk_bf16_f32 v33, v34, v35
    v_mfma_f32_32x32x16_bf16 v[80:95], a[148:151], v[56:59], v[80:95]
    v_exp_f32 v37, v37
    v_add_f32 v25, v25, v36
    v_exp_f32 v38, v38
    v_mfma_f32_32x32x16_bf16 v[96:111], a[152:155], v[56:59], v[96:111]
    s_waitcnt lgkmcnt(0)
    v_add_f32 v25, v25, v37
    v_cvt_pk_bf16_f32 v34, v36, v37
    v_exp_f32 v39, v39
    v_add_f32 v25, v25, v38
    v_mfma_f32_32x32x16_bf16 v[112:127], a[156:159], v[56:59], v[112:127]
    v_exp_f32 v40, v40
    v_add_f32 v25, v25, v39
    v_cvt_pk_bf16_f32 v35, v38, v39
    v_mfma_f32_32x32x16_bf16 v[48:63], a[96:99], a[64:67], 0
    v_exp_f32 v41, v41
    v_add_f32 v25, v25, v40
    v_exp_f32 v42, v42
    v_mfma_f32_32x32x16_bf16 v[48:63], a[100:103], a[68:71], v[48:63]
    v_add_f32 v25, v25, v41
    v_cvt_pk_bf16_f32 v40, v40, v41
    v_exp_f32 v43, v43
    v_add_f32 v25, v25, v42
    v_mfma_f32_32x32x16_bf16 v[48:63], a[104:107], a[72:75], v[48:63]
    v_exp_f32 v44, v44
    v_add_f32 v25, v25, v43
    v_cvt_pk_bf16_f32 v41, v42, v43
    v_mfma_f32_32x32x16_bf16 v[48:63], a[108:111], a[76:79], v[48:63]
    v_exp_f32 v45, v45
    v_add_f32 v25, v25, v44
    v_exp_f32 v46, v46
    v_mfma_f32_32x32x16_bf16 v[48:63], a[112:115], a[80:83], v[48:63]
    v_add_f32 v25, v25, v45
    v_cvt_pk_bf16_f32 v42, v44, v45
    v_exp_f32 v47, v47
    v_add_f32 v25, v25, v46
    v_mfma_f32_32x32x16_bf16 v[48:63], a[116:119], a[84:87], v[48:63]
    v_add_f32 v25, v25, v47
    v_cvt_pk_bf16_f32 v43, v46, v47
    v_mfma_f32_32x32x16_bf16 v[48:63], a[120:123], a[88:91], v[48:63]
    s_waitcnt vmcnt(16)
    s_barrier
    v_mfma_f32_32x32x16_bf16 v[48:63], a[124:127], a[92:95], v[48:63]
    ds_read_b128 a[160:163], v12 offset:57344
    v_mfma_f32_32x32x16_bf16 v[128:143], a[128:131], v[32:35], v[128:143]
    ds_read_b128 a[164:167], v13 offset:57344
    v_mfma_f32_32x32x16_bf16 v[144:159], a[132:135], v[32:35], v[144:159]
    ds_read_b128 a[168:171], v14 offset:57344
    v_exp_f32 v48, v48
    v_exp_f32 v49, v49
    v_mfma_f32_32x32x16_bf16 v[160:175], a[136:139], v[32:35], v[160:175]
    ds_read_b128 a[172:175], v15 offset:57344
    v_add_f32 v26, v26, v48
    v_exp_f32 v50, v50
    v_add_f32 v26, v26, v49
    v_mfma_f32_32x32x16_bf16 v[176:191], a[140:143], v[32:35], v[176:191]
    ds_read_b128 a[176:179], v12 offset:58368
    v_cvt_pk_bf16_f32 v48, v48, v49
    v_exp_f32 v51, v51
    v_add_f32 v26, v26, v50
    v_mfma_f32_32x32x16_bf16 v[128:143], a[144:147], v[40:43], v[128:143]
    ds_read_b128 a[180:183], v13 offset:58368
    v_exp_f32 v52, v52
    v_add_f32 v26, v26, v51
    v_cvt_pk_bf16_f32 v49, v50, v51
    v_mfma_f32_32x32x16_bf16 v[144:159], a[148:151], v[40:43], v[144:159]
    ds_read_b128 a[184:187], v14 offset:58368
    v_exp_f32 v53, v53
    v_add_f32 v26, v26, v52
    v_mfma_f32_32x32x16_bf16 v[160:175], a[152:155], v[40:43], v[160:175]
    ds_read_b128 a[188:191], v15 offset:58368
    v_exp_f32 v54, v54
    v_add_f32 v26, v26, v53
    v_cvt_pk_bf16_f32 v50, v52, v53
    v_mfma_f32_32x32x16_bf16 v[176:191], a[156:159], v[40:43], v[176:191]
    ds_read_b64_tr_b16 a[192:193], v16 offset:24576
    s_waitcnt lgkmcnt(6)
    v_exp_f32 v55, v55
    v_add_f32 v26, v26, v54
    v_mfma_f32_32x32x16_bf16 v[32:47], a[160:163], a[0:3], 0
    ds_read_b64_tr_b16 a[194:195], v16 offset:28672
    v_exp_f32 v56, v56
    v_add_f32 v26, v26, v55
    v_cvt_pk_bf16_f32 v51, v54, v55
    v_mfma_f32_32x32x16_bf16 v[32:47], a[164:167], a[4:7], v[32:47]
    ds_read_b64_tr_b16 a[196:197], v17 offset:24576
    v_exp_f32 v57, v57
    v_add_f32 v26, v26, v56
    v_mfma_f32_32x32x16_bf16 v[32:47], a[168:171], a[8:11], v[32:47]
    s_add_u32 m0, s52, 0
    s_waitcnt lgkmcnt(5)
    v_exp_f32 v58, v58
    v_add_f32 v26, v26, v57
    v_cvt_pk_bf16_f32 v56, v56, v57
    v_mfma_f32_32x32x16_bf16 v[32:47], a[172:175], a[12:15], v[32:47]
    buffer_load_dwordx4 v20, s[16:19], s45 offen offset:0 nt lds
    v_exp_f32 v59, v59
    v_add_f32 v26, v26, v58
    v_mfma_f32_32x32x16_bf16 v[32:47], a[176:179], a[16:19], v[32:47]
    ds_read_b64_tr_b16 a[198:199], v17 offset:28672
    v_exp_f32 v60, v60
    v_add_f32 v26, v26, v59
    v_cvt_pk_bf16_f32 v57, v58, v59
    v_mfma_f32_32x32x16_bf16 v[32:47], a[180:183], a[20:23], v[32:47]
    buffer_load_dwordx4 v20, s[16:19], s46 offen offset:1024 nt lds
    s_waitcnt lgkmcnt(3)
    v_exp_f32 v61, v61
    v_add_f32 v26, v26, v60
    v_mfma_f32_32x32x16_bf16 v[32:47], a[184:187], a[24:27], v[32:47]
    ds_read_b64_tr_b16 a[200:201], v16 offset:25600
    v_exp_f32 v62, v62
    v_add_f32 v26, v26, v61
    v_cvt_pk_bf16_f32 v58, v60, v61
    v_mfma_f32_32x32x16_bf16 v[32:47], a[188:191], a[28:31], v[32:47]
    buffer_load_dwordx4 v20, s[16:19], s47 offen offset:2048 nt lds
    v_exp_f32 v63, v63
    v_add_f32 v26, v26, v62
    v_add_f32 v26, v26, v63
    v_mfma_f32_32x32x16_bf16 v[192:207], a[128:131], v[48:51], v[192:207]
    ds_read_b64_tr_b16 a[202:203], v16 offset:29696
    v_cvt_pk_bf16_f32 v59, v62, v63
    v_mfma_f32_32x32x16_bf16 v[208:223], a[132:135], v[48:51], v[208:223]
    buffer_load_dwordx4 v20, s[16:19], s48 offen offset:3072 nt lds
    v_xor_b32 v20, 24576, v20
    v_exp_f32 v32, v32
    v_mfma_f32_32x32x16_bf16 v[224:239], a[136:139], v[48:51], v[224:239]
    ds_read_b64_tr_b16 a[204:205], v17 offset:25600
    v_exp_f32 v33, v33
    v_add_f32 v24, v24, v32
    v_mfma_f32_32x32x16_bf16 v[240:255], a[140:143], v[48:51], v[240:255]
    ds_read_b64_tr_b16 a[206:207], v17 offset:29696
    v_exp_f32 v34, v34
    v_add_f32 v24, v24, v33
    v_cvt_pk_bf16_f32 v32, v32, v33
    v_mfma_f32_32x32x16_bf16 v[192:207], a[144:147], v[56:59], v[192:207]
    ds_read_b64_tr_b16 a[208:209], v16 offset:26624
    v_exp_f32 v35, v35
    v_add_f32 v24, v24, v34
    v_mfma_f32_32x32x16_bf16 v[208:223], a[148:151], v[56:59], v[208:223]
    ds_read_b64_tr_b16 a[210:211], v16 offset:30720
    v_exp_f32 v36, v36
    v_add_f32 v24, v24, v35
    v_cvt_pk_bf16_f32 v33, v34, v35
    v_mfma_f32_32x32x16_bf16 v[224:239], a[152:155], v[56:59], v[224:239]
    ds_read_b64_tr_b16 a[212:213], v17 offset:26624
    v_exp_f32 v37, v37
    v_add_f32 v24, v24, v36
    v_mfma_f32_32x32x16_bf16 v[240:255], a[156:159], v[56:59], v[240:255]
    ds_read_b64_tr_b16 a[214:215], v17 offset:30720
    v_exp_f32 v38, v38
    v_add_f32 v24, v24, v37
    v_cvt_pk_bf16_f32 v34, v36, v37
    v_mfma_f32_32x32x16_bf16 v[48:63], a[160:163], a[32:35], 0
    ds_read_b64_tr_b16 a[216:217], v16 offset:27648
    v_exp_f32 v39, v39
    v_add_f32 v24, v24, v38
    v_mfma_f32_32x32x16_bf16 v[48:63], a[164:167], a[36:39], v[48:63]
    ds_read_b64_tr_b16 a[218:219], v16 offset:31744
    v_exp_f32 v40, v40
    v_add_f32 v24, v24, v39
    v_cvt_pk_bf16_f32 v35, v38, v39
    v_mfma_f32_32x32x16_bf16 v[48:63], a[168:171], a[40:43], v[48:63]
    v_exp_f32 v41, v41
    v_add_f32 v24, v24, v40
    v_exp_f32 v42, v42
    v_mfma_f32_32x32x16_bf16 v[48:63], a[172:175], a[44:47], v[48:63]
    ds_read_b64_tr_b16 a[220:221], v17 offset:27648
    v_add_f32 v24, v24, v41
    v_cvt_pk_bf16_f32 v40, v40, v41
    v_exp_f32 v43, v43
    v_mfma_f32_32x32x16_bf16 v[48:63], a[176:179], a[48:51], v[48:63]
    ds_read_b64_tr_b16 a[222:223], v17 offset:31744
    v_add_f32 v24, v24, v42
    v_exp_f32 v44, v44
    v_add_f32 v24, v24, v43
    v_mfma_f32_32x32x16_bf16 v[48:63], a[180:183], a[52:55], v[48:63]
    v_cvt_pk_bf16_f32 v41, v42, v43
    v_exp_f32 v45, v45
    v_add_f32 v24, v24, v44
    v_mfma_f32_32x32x16_bf16 v[48:63], a[184:187], a[56:59], v[48:63]
    v_exp_f32 v46, v46
    v_add_f32 v24, v24, v45
    v_cvt_pk_bf16_f32 v42, v44, v45
    v_mfma_f32_32x32x16_bf16 v[48:63], a[188:191], a[60:63], v[48:63]
    s_waitcnt lgkmcnt(2)
    v_exp_f32 v47, v47
    v_add_f32 v24, v24, v46
    v_add_f32 v24, v24, v47
    v_cvt_pk_bf16_f32 v43, v46, v47
    v_mfma_f32_32x32x16_bf16 v[64:79], a[192:195], v[32:35], v[64:79]
    v_mfma_f32_32x32x16_bf16 v[80:95], a[196:199], v[32:35], v[80:95]
    v_exp_f32 v48, v48
    v_exp_f32 v49, v49
    v_add_f32 v25, v25, v48
    v_mfma_f32_32x32x16_bf16 v[96:111], a[200:203], v[32:35], v[96:111]
    v_exp_f32 v50, v50
    v_add_f32 v25, v25, v49
    v_cvt_pk_bf16_f32 v48, v48, v49
    v_mfma_f32_32x32x16_bf16 v[112:127], a[204:207], v[32:35], v[112:127]
    v_exp_f32 v51, v51
    v_add_f32 v25, v25, v50
    v_exp_f32 v52, v52
    v_mfma_f32_32x32x16_bf16 v[64:79], a[208:211], v[40:43], v[64:79]
    v_add_f32 v25, v25, v51
    v_cvt_pk_bf16_f32 v49, v50, v51
    v_exp_f32 v53, v53
    v_add_f32 v25, v25, v52
    v_mfma_f32_32x32x16_bf16 v[80:95], a[212:215], v[40:43], v[80:95]
    v_exp_f32 v54, v54
    v_add_f32 v25, v25, v53
    v_cvt_pk_bf16_f32 v50, v52, v53
    v_mfma_f32_32x32x16_bf16 v[96:111], a[216:219], v[40:43], v[96:111]
    s_waitcnt lgkmcnt(0)
    v_exp_f32 v55, v55
    v_add_f32 v25, v25, v54
    v_exp_f32 v56, v56
    v_mfma_f32_32x32x16_bf16 v[112:127], a[220:223], v[40:43], v[112:127]
    v_add_f32 v25, v25, v55
    v_cvt_pk_bf16_f32 v51, v54, v55
    v_exp_f32 v57, v57
    v_add_f32 v25, v25, v56
    v_mfma_f32_32x32x16_bf16 v[32:47], a[160:163], a[64:67], 0
    v_exp_f32 v58, v58
    v_add_f32 v25, v25, v57
    v_cvt_pk_bf16_f32 v56, v56, v57
    v_mfma_f32_32x32x16_bf16 v[32:47], a[164:167], a[68:71], v[32:47]
    s_add_u32 m0, s52, 65536
    v_exp_f32 v59, v59
    v_add_f32 v25, v25, v58
    v_exp_f32 v60, v60
    v_mfma_f32_32x32x16_bf16 v[32:47], a[168:171], a[72:75], v[32:47]
    buffer_load_dwordx4 v21, s[20:23], s45 offen offset:0 nt lds
    v_add_f32 v25, v25, v59
    v_cvt_pk_bf16_f32 v57, v58, v59
    v_exp_f32 v61, v61
    v_mfma_f32_32x32x16_bf16 v[32:47], a[172:175], a[76:79], v[32:47]
    v_add_f32 v25, v25, v60
    v_exp_f32 v62, v62
    v_add_f32 v25, v25, v61
    v_cvt_pk_bf16_f32 v58, v60, v61
    v_mfma_f32_32x32x16_bf16 v[32:47], a[176:179], a[80:83], v[32:47]
    buffer_load_dwordx4 v21, s[20:23], s46 offen offset:1024 nt lds
    v_exp_f32 v63, v63
    v_add_f32 v25, v25, v62
    v_add_f32 v25, v25, v63
    v_mfma_f32_32x32x16_bf16 v[32:47], a[180:183], a[84:87], v[32:47]
    v_cvt_pk_bf16_f32 v59, v62, v63
    v_mfma_f32_32x32x16_bf16 v[32:47], a[184:187], a[88:91], v[32:47]
    s_waitcnt vmcnt(14)
    s_barrier
    v_mfma_f32_32x32x16_bf16 v[32:47], a[188:191], a[92:95], v[32:47]
    buffer_load_dwordx4 v21, s[20:23], s47 offen offset:2048 nt lds
    ds_read_b128 a[224:227], v12 offset:32768
    v_mfma_f32_32x32x16_bf16 v[128:143], a[192:195], v[48:51], v[128:143]
    ds_read_b128 a[228:231], v13 offset:32768
    v_mfma_f32_32x32x16_bf16 v[144:159], a[196:199], v[48:51], v[144:159]
    buffer_load_dwordx4 v21, s[20:23], s48 offen offset:3072 nt lds
    ds_read_b128 a[232:235], v14 offset:32768
    v_xor_b32 v21, 24576, v21
    v_mfma_f32_32x32x16_bf16 v[160:175], a[200:203], v[48:51], v[160:175]
    ds_read_b128 a[236:239], v15 offset:32768
    v_exp_f32 v32, v32
    v_exp_f32 v33, v33
    v_mfma_f32_32x32x16_bf16 v[176:191], a[204:207], v[48:51], v[176:191]
    ds_read_b128 a[240:243], v12 offset:33792
    v_add_f32 v26, v26, v32
    v_exp_f32 v34, v34
    v_add_f32 v26, v26, v33
    v_mfma_f32_32x32x16_bf16 v[128:143], a[208:211], v[56:59], v[128:143]
    ds_read_b128 a[244:247], v13 offset:33792
    v_cvt_pk_bf16_f32 v32, v32, v33
    v_exp_f32 v35, v35
    v_add_f32 v26, v26, v34
    v_mfma_f32_32x32x16_bf16 v[144:159], a[212:215], v[56:59], v[144:159]
    ds_read_b128 a[248:251], v14 offset:33792
    v_exp_f32 v36, v36
    v_add_f32 v26, v26, v35
    v_cvt_pk_bf16_f32 v33, v34, v35
    v_mfma_f32_32x32x16_bf16 v[160:175], a[216:219], v[56:59], v[160:175]
    ds_read_b128 a[252:255], v15 offset:33792
    v_exp_f32 v37, v37
    v_add_f32 v26, v26, v36
    v_mfma_f32_32x32x16_bf16 v[176:191], a[220:223], v[56:59], v[176:191]
    ds_read_b64_tr_b16 a[96:97], v16 offset:0
    s_waitcnt lgkmcnt(6)
    v_exp_f32 v38, v38
    v_add_f32 v26, v26, v37
    v_cvt_pk_bf16_f32 v34, v36, v37
    v_mfma_f32_32x32x16_bf16 v[48:63], a[224:227], a[0:3], 0
    ds_read_b64_tr_b16 a[98:99], v16 offset:4096
    v_exp_f32 v39, v39
    v_add_f32 v26, v26, v38
    v_mfma_f32_32x32x16_bf16 v[48:63], a[228:231], a[4:7], v[48:63]
    ds_read_b64_tr_b16 a[100:101], v17 offset:0
    v_exp_f32 v40, v40
    v_add_f32 v26, v26, v39
    v_cvt_pk_bf16_f32 v35, v38, v39
    v_mfma_f32_32x32x16_bf16 v[48:63], a[232:235], a[8:11], v[48:63]
    s_waitcnt lgkmcnt(5)
    v_exp_f32 v41, v41
    v_add_f32 v26, v26, v40
    v_exp_f32 v42, v42
    v_mfma_f32_32x32x16_bf16 v[48:63], a[236:239], a[12:15], v[48:63]
    ds_read_b64_tr_b16 a[102:103], v17 offset:4096
    v_add_f32 v26, v26, v41
    v_cvt_pk_bf16_f32 v40, v40, v41
    v_exp_f32 v43, v43
    v_mfma_f32_32x32x16_bf16 v[48:63], a[240:243], a[16:19], v[48:63]
    ds_read_b64_tr_b16 a[104:105], v16 offset:1024
    v_add_f32 v26, v26, v42
    v_exp_f32 v44, v44
    v_add_f32 v26, v26, v43
    v_mfma_f32_32x32x16_bf16 v[48:63], a[244:247], a[20:23], v[48:63]
    s_waitcnt lgkmcnt(4)
    v_cvt_pk_bf16_f32 v41, v42, v43
    v_exp_f32 v45, v45
    v_add_f32 v26, v26, v44
    v_mfma_f32_32x32x16_bf16 v[48:63], a[248:251], a[24:27], v[48:63]
    ds_read_b64_tr_b16 a[106:107], v16 offset:5120
    v_exp_f32 v46, v46
    v_add_f32 v26, v26, v45
    v_cvt_pk_bf16_f32 v42, v44, v45
    v_mfma_f32_32x32x16_bf16 v[48:63], a[252:255], a[28:31], v[48:63]
    ds_read_b64_tr_b16 a[108:109], v17 offset:1024
    v_exp_f32 v47, v47
    v_add_f32 v26, v26, v46
    v_add_f32 v26, v26, v47
    v_mfma_f32_32x32x16_bf16 v[192:207], a[192:195], v[32:35], v[192:207]
    v_cvt_pk_bf16_f32 v43, v46, v47
    v_mfma_f32_32x32x16_bf16 v[208:223], a[196:199], v[32:35], v[208:223]
    ds_read_b64_tr_b16 a[110:111], v17 offset:5120
    v_exp_f32 v48, v48
    v_exp_f32 v49, v49
    v_mfma_f32_32x32x16_bf16 v[224:239], a[200:203], v[32:35], v[224:239]
    ds_read_b64_tr_b16 a[112:113], v16 offset:2048
    v_add_f32 v24, v24, v48
    v_exp_f32 v50, v50
    v_add_f32 v24, v24, v49
    v_mfma_f32_32x32x16_bf16 v[240:255], a[204:207], v[32:35], v[240:255]
    ds_read_b64_tr_b16 a[114:115], v16 offset:6144
    v_cvt_pk_bf16_f32 v48, v48, v49
    v_exp_f32 v51, v51
    v_add_f32 v24, v24, v50
    v_mfma_f32_32x32x16_bf16 v[192:207], a[208:211], v[40:43], v[192:207]
    v_exp_f32 v52, v52
    v_add_f32 v24, v24, v51
    v_cvt_pk_bf16_f32 v49, v50, v51
    v_mfma_f32_32x32x16_bf16 v[208:223], a[212:215], v[40:43], v[208:223]
    ds_read_b64_tr_b16 a[116:117], v17 offset:2048
    v_exp_f32 v53, v53
    v_add_f32 v24, v24, v52
    v_mfma_f32_32x32x16_bf16 v[224:239], a[216:219], v[40:43], v[224:239]
    ds_read_b64_tr_b16 a[118:119], v17 offset:6144
    v_exp_f32 v54, v54
    v_add_f32 v24, v24, v53
    v_cvt_pk_bf16_f32 v50, v52, v53
    v_mfma_f32_32x32x16_bf16 v[240:255], a[220:223], v[40:43], v[240:255]
    v_exp_f32 v55, v55
    v_add_f32 v24, v24, v54
    v_exp_f32 v56, v56
    v_mfma_f32_32x32x16_bf16 v[32:47], a[224:227], a[32:35], 0
    ds_read_b64_tr_b16 a[120:121], v16 offset:3072
    v_add_f32 v24, v24, v55
    v_cvt_pk_bf16_f32 v51, v54, v55
    v_exp_f32 v57, v57
    v_mfma_f32_32x32x16_bf16 v[32:47], a[228:231], a[36:39], v[32:47]
    ds_read_b64_tr_b16 a[122:123], v16 offset:7168
    s_add_u32 m0, s52, 49152
    v_add_f32 v24, v24, v56
    v_exp_f32 v58, v58
    v_add_f32 v24, v24, v57
    v_mfma_f32_32x32x16_bf16 v[32:47], a[232:235], a[40:43], v[32:47]
    buffer_load_dwordx4 v20, s[16:19], s45 offen offset:0 nt lds
    v_cvt_pk_bf16_f32 v56, v56, v57
    v_exp_f32 v59, v59
    v_add_f32 v24, v24, v58
    v_mfma_f32_32x32x16_bf16 v[32:47], a[236:239], a[44:47], v[32:47]
    ds_read_b64_tr_b16 a[124:125], v17 offset:3072
    v_exp_f32 v60, v60
    v_add_f32 v24, v24, v59
    v_cvt_pk_bf16_f32 v57, v58, v59
    v_mfma_f32_32x32x16_bf16 v[32:47], a[240:243], a[48:51], v[32:47]
    buffer_load_dwordx4 v20, s[16:19], s46 offen offset:1024 nt lds
    v_exp_f32 v61, v61
    v_add_f32 v24, v24, v60
    v_mfma_f32_32x32x16_bf16 v[32:47], a[244:247], a[52:55], v[32:47]
    ds_read_b64_tr_b16 a[126:127], v17 offset:7168
    v_exp_f32 v62, v62
    v_add_f32 v24, v24, v61
    v_cvt_pk_bf16_f32 v58, v60, v61
    v_mfma_f32_32x32x16_bf16 v[32:47], a[248:251], a[56:59], v[32:47]
    buffer_load_dwordx4 v20, s[16:19], s47 offen offset:2048 nt lds
    v_exp_f32 v63, v63
    v_add_f32 v24, v24, v62
    v_add_f32 v24, v24, v63
    v_mfma_f32_32x32x16_bf16 v[32:47], a[252:255], a[60:63], v[32:47]
    s_waitcnt lgkmcnt(2)
    v_cvt_pk_bf16_f32 v59, v62, v63
    v_mfma_f32_32x32x16_bf16 v[64:79], a[96:99], v[48:51], v[64:79]
    buffer_load_dwordx4 v20, s[16:19], s48 offen offset:3072 nt lds
    v_xor_b32 v20, 8192, v20
    v_mfma_f32_32x32x16_bf16 v[80:95], a[100:103], v[48:51], v[80:95]
    v_exp_f32 v32, v32
    v_exp_f32 v33, v33
    v_add_f32 v25, v25, v32
    v_mfma_f32_32x32x16_bf16 v[96:111], a[104:107], v[48:51], v[96:111]
    v_exp_f32 v34, v34
    v_add_f32 v25, v25, v33
    v_cvt_pk_bf16_f32 v32, v32, v33
    v_mfma_f32_32x32x16_bf16 v[112:127], a[108:111], v[48:51], v[112:127]
    v_exp_f32 v35, v35
    v_add_f32 v25, v25, v34
    v_exp_f32 v36, v36
    v_mfma_f32_32x32x16_bf16 v[64:79], a[112:115], v[56:59], v[64:79]
    v_add_f32 v25, v25, v35
    v_cvt_pk_bf16_f32 v33, v34, v35
    v_exp_f32 v37, v37
    v_add_f32 v25, v25, v36
    v_mfma_f32_32x32x16_bf16 v[80:95], a[116:119], v[56:59], v[80:95]
    v_exp_f32 v38, v38
    v_add_f32 v25, v25, v37
    v_cvt_pk_bf16_f32 v34, v36, v37
    v_mfma_f32_32x32x16_bf16 v[96:111], a[120:123], v[56:59], v[96:111]
    s_waitcnt lgkmcnt(0)
    v_exp_f32 v39, v39
    v_add_f32 v25, v25, v38
    v_exp_f32 v40, v40
    v_mfma_f32_32x32x16_bf16 v[112:127], a[124:127], v[56:59], v[112:127]
    v_add_f32 v25, v25, v39
    v_cvt_pk_bf16_f32 v35, v38, v39
    v_exp_f32 v41, v41
    v_add_f32 v25, v25, v40
    v_mfma_f32_32x32x16_bf16 v[48:63], a[224:227], a[64:67], 0
    v_exp_f32 v42, v42
    v_add_f32 v25, v25, v41
    v_cvt_pk_bf16_f32 v40, v40, v41
    v_mfma_f32_32x32x16_bf16 v[48:63], a[228:231], a[68:71], v[48:63]
    v_exp_f32 v43, v43
    v_add_f32 v25, v25, v42
    v_exp_f32 v44, v44
    v_mfma_f32_32x32x16_bf16 v[48:63], a[232:235], a[72:75], v[48:63]
    v_add_f32 v25, v25, v43
    v_cvt_pk_bf16_f32 v41, v42, v43
    v_exp_f32 v45, v45
    v_add_f32 v25, v25, v44
    v_mfma_f32_32x32x16_bf16 v[48:63], a[236:239], a[76:79], v[48:63]
    v_exp_f32 v46, v46
    v_add_f32 v25, v25, v45
    v_cvt_pk_bf16_f32 v42, v44, v45
    v_mfma_f32_32x32x16_bf16 v[48:63], a[240:243], a[80:83], v[48:63]
    v_exp_f32 v47, v47
    v_add_f32 v25, v25, v46
    v_add_f32 v25, v25, v47
    v_cvt_pk_bf16_f32 v43, v46, v47
    v_mfma_f32_32x32x16_bf16 v[48:63], a[244:247], a[84:87], v[48:63]
    s_cmp_lg_u32 s38, 0
    s_cbranch_scc1 L_w0_2
    s_mov_b64 exec, 1
    global_atomic_add v28, v11, s[36:37] sc1
    s_mov_b64 exec, -1
L_w0_2:
    v_mfma_f32_32x32x16_bf16 v[48:63], a[248:251], a[88:91], v[48:63]
    s_waitcnt vmcnt(12)
    s_barrier
    v_mfma_f32_32x32x16_bf16 v[48:63], a[252:255], a[92:95], v[48:63]
    ds_read_b128 a[128:131], v12 offset:8192
    v_mfma_f32_32x32x16_bf16 v[128:143], a[96:99], v[32:35], v[128:143]
    ds_read_b128 a[132:135], v13 offset:8192
    v_mfma_f32_32x32x16_bf16 v[144:159], a[100:103], v[32:35], v[144:159]
    ds_read_b128 a[136:139], v14 offset:8192
    v_exp_f32 v48, v48
    v_exp_f32 v49, v49
    v_mfma_f32_32x32x16_bf16 v[160:175], a[104:107], v[32:35], v[160:175]
    ds_read_b128 a[140:143], v15 offset:8192
    v_add_f32 v26, v26, v48
    v_exp_f32 v50, v50
    v_add_f32 v26, v26, v49
    v_mfma_f32_32x32x16_bf16 v[176:191], a[108:111], v[32:35], v[176:191]
    ds_read_b128 a[144:147], v12 offset:9216
    v_cvt_pk_bf16_f32 v48, v48, v49
    v_exp_f32 v51, v51
    v_add_f32 v26, v26, v50
    v_mfma_f32_32x32x16_bf16 v[128:143], a[112:115], v[40:43], v[128:143]
    ds_read_b128 a[148:151], v13 offset:9216
    v_exp_f32 v52, v52
    v_add_f32 v26, v26, v51
    v_cvt_pk_bf16_f32 v49, v50, v51
    v_mfma_f32_32x32x16_bf16 v[144:159], a[116:119], v[40:43], v[144:159]
    ds_read_b128 a[152:155], v14 offset:9216
    v_exp_f32 v53, v53
    v_add_f32 v26, v26, v52
    v_mfma_f32_32x32x16_bf16 v[160:175], a[120:123], v[40:43], v[160:175]
    ds_read_b128 a[156:159], v15 offset:9216
    v_exp_f32 v54, v54
    v_add_f32 v26, v26, v53
    v_cvt_pk_bf16_f32 v50, v52, v53
    v_mfma_f32_32x32x16_bf16 v[176:191], a[124:127], v[40:43], v[176:191]
    ds_read_b64_tr_b16 a[160:161], v16 offset:8192
    s_waitcnt lgkmcnt(6)
    v_exp_f32 v55, v55
    v_add_f32 v26, v26, v54
    v_mfma_f32_32x32x16_bf16 v[32:47], a[128:131], a[0:3], 0
    ds_read_b64_tr_b16 a[162:163], v16 offset:12288
    s_add_u32 m0, s52, 73728
    v_exp_f32 v56, v56
    v_add_f32 v26, v26, v55
    v_cvt_pk_bf16_f32 v51, v54, v55
    v_mfma_f32_32x32x16_bf16 v[32:47], a[132:135], a[4:7], v[32:47]
    buffer_load_dwordx4 v21, s[20:23], s45 offen offset:0 nt lds
    v_exp_f32 v57, v57
    v_add_f32 v26, v26, v56
    v_mfma_f32_32x32x16_bf16 v[32:47], a[136:139], a[8:11], v[32:47]
    ds_read_b64_tr_b16 a[164:165], v17 offset:8192
    s_waitcnt lgkmcnt(5)
    v_exp_f32 v58, v58
    v_add_f32 v26, v26, v57
    v_cvt_pk_bf16_f32 v56, v56, v57
    v_mfma_f32_32x32x16_bf16 v[32:47], a[140:143], a[12:15], v[32:47]
    buffer_load_dwordx4 v21, s[20:23], s46 offen offset:1024 nt lds
    v_exp_f32 v59, v59
    v_add_f32 v26, v26, v58
    v_mfma_f32_32x32x16_bf16 v[32:47], a[144:147], a[16:19], v[32:47]
    ds_read_b64_tr_b16 a[166:167], v17 offset:12288
    v_exp_f32 v60, v60
    v_add_f32 v26, v26, v59
    v_cvt_pk_bf16_f32 v57, v58, v59
    v_mfma_f32_32x32x16_bf16 v[32:47], a[148:151], a[20:23], v[32:47]
    buffer_load_dwordx4 v21, s[20:23], s47 offen offset:2048 nt lds
    s_waitcnt lgkmcnt(3)
    v_exp_f32 v61, v61
    v_add_f32 v26, v26, v60
    v_mfma_f32_32x32x16_bf16 v[32:47], a[152:155], a[24:27], v[32:47]
    ds_read_b64_tr_b16 a[168:169], v16 offset:9216
    v_exp_f32 v62, v62
    v_add_f32 v26, v26, v61
    v_cvt_pk_bf16_f32 v58, v60, v61
    v_mfma_f32_32x32x16_bf16 v[32:47], a[156:159], a[28:31], v[32:47]
    buffer_load_dwordx4 v21, s[20:23], s48 offen offset:3072 nt lds
    v_xor_b32 v21, 8192, v21
    v_exp_f32 v63, v63
    v_add_f32 v26, v26, v62
    v_mfma_f32_32x32x16_bf16 v[192:207], a[96:99], v[48:51], v[192:207]
    ds_read_b64_tr_b16 a[170:171], v16 offset:13312
    v_add_f32 v26, v26, v63
    v_cvt_pk_bf16_f32 v59, v62, v63
    v_mfma_f32_32x32x16_bf16 v[208:223], a[100:103], v[48:51], v[208:223]
    ds_read_b64_tr_b16 a[172:173], v17 offset:9216
    v_exp_f32 v32, v32
    v_exp_f32 v33, v33
    v_mfma_f32_32x32x16_bf16 v[224:239], a[104:107], v[48:51], v[224:239]
    ds_read_b64_tr_b16 a[174:175], v17 offset:13312
    v_add_f32 v24, v24, v32
    v_exp_f32 v34, v34
    v_add_f32 v24, v24, v33
    v_mfma_f32_32x32x16_bf16 v[240:255], a[108:111], v[48:51], v[240:255]
    ds_read_b64_tr_b16 a[176:177], v16 offset:10240
    v_cvt_pk_bf16_f32 v32, v32, v33
    v_exp_f32 v35, v35
    v_add_f32 v24, v24, v34
    v_mfma_f32_32x32x16_bf16 v[192:207], a[112:115], v[56:59], v[192:207]
    ds_read_b64_tr_b16 a[178:179], v16 offset:14336
    v_exp_f32 v36, v36
    v_add_f32 v24, v24, v35
    v_cvt_pk_bf16_f32 v33, v34, v35
    v_mfma_f32_32x32x16_bf16 v[208:223], a[116:119], v[56:59], v[208:223]
    ds_read_b64_tr_b16 a[180:181], v17 offset:10240
    v_exp_f32 v37, v37
    v_add_f32 v24, v24, v36
    v_mfma_f32_32x32x16_bf16 v[224:239], a[120:123], v[56:59], v[224:239]
    ds_read_b64_tr_b16 a[182:183], v17 offset:14336
    v_exp_f32 v38, v38
    v_add_f32 v24, v24, v37
    v_cvt_pk_bf16_f32 v34, v36, v37
    v_mfma_f32_32x32x16_bf16 v[240:255], a[124:127], v[56:59], v[240:255]
    v_exp_f32 v39, v39
    v_add_f32 v24, v24, v38
    v_exp_f32 v40, v40
    v_mfma_f32_32x32x16_bf16 v[48:63], a[128:131], a[32:35], 0
    ds_read_b64_tr_b16 a[184:185], v16 offset:11264
    v_add_f32 v24, v24, v39
    v_cvt_pk_bf16_f32 v35, v38, v39
    v_exp_f32 v41, v41
    v_mfma_f32_32x32x16_bf16 v[48:63], a[132:135], a[36:39], v[48:63]
    ds_read_b64_tr_b16 a[186:187], v16 offset:15360
    v_add_f32 v24, v24, v40
    v_exp_f32 v42, v42
    v_add_f32 v24, v24, v41
    v_mfma_f32_32x32x16_bf16 v[48:63], a[136:139], a[40:43], v[48:63]
    v_cvt_pk_bf16_f32 v40, v40, v41
    v_exp_f32 v43, v43
    v_add_f32 v24, v24, v42
    v_mfma_f32_32x32x16_bf16 v[48:63], a[140:143], a[44:47], v[48:63]
    ds_read_b64_tr_b16 a[188:189], v17 offset:11264
    v_exp_f32 v44, v44
    v_add_f32 v24, v24, v43
    v_cvt_pk_bf16_f32 v41, v42, v43
    v_mfma_f32_32x32x16_bf16 v[48:63], a[144:147], a[48:51], v[48:63]
    ds_read_b64_tr_b16 a[190:191], v17 offset:15360
    v_exp_f32 v45, v45
    v_add_f32 v24, v24, v44
    v_mfma_f32_32x32x16_bf16 v[48:63], a[148:151], a[52:55], v[48:63]
    v_exp_f32 v46, v46
    v_add_f32 v24, v24, v45
    v_cvt_pk_bf16_f32 v42, v44, v45
    v_mfma_f32_32x32x16_bf16 v[48:63], a[152:155], a[56:59], v[48:63]
    v_exp_f32 v47, v47
    v_add_f32 v24, v24, v46
    v_add_f32 v24, v24, v47
    v_cvt_pk_bf16_f32 v43, v46, v47
    v_mfma_f32_32x32x16_bf16 v[48:63], a[156:159], a[60:63], v[48:63]
    s_waitcnt lgkmcnt(3)
    v_mfma_f32_32x32x16_bf16 v[64:79], a[160:163], v[32:35], v[64:79]
    v_mfma_f32_32x32x16_bf16 v[80:95], a[164:167], v[32:35], v[80:95]
    v_exp_f32 v48, v48
    v_exp_f32 v49, v49
    v_add_f32 v25, v25, v48
    v_mfma_f32_32x32x16_bf16 v[96:111], a[168:171], v[32:35], v[96:111]
    v_exp_f32 v50, v50
    v_add_f32 v25, v25, v49
    v_cvt_pk_bf16_f32 v48, v48, v49
    v_mfma_f32_32x32x16_bf16 v[112:127], a[172:175], v[32:35], v[112:127]
    v_exp_f32 v51, v51
    v_add_f32 v25, v25, v50
    v_exp_f32 v52, v52
    v_mfma_f32_32x32x16_bf16 v[64:79], a[176:179], v[40:43], v[64:79]
    v_add_f32 v25, v25, v51
    v_cvt_pk_bf16_f32 v49, v50, v51
    v_exp_f32 v53, v53
    v_add_f32 v25, v25, v52
    v_mfma_f32_32x32x16_bf16 v[80:95], a[180:183], v[40:43], v[80:95]
    s_waitcnt lgkmcnt(0)
    v_exp_f32 v54, v54
    v_add_f32 v25, v25, v53
    v_cvt_pk_bf16_f32 v50, v52, v53
    v_mfma_f32_32x32x16_bf16 v[96:111], a[184:187], v[40:43], v[96:111]
    v_exp_f32 v55, v55
    v_add_f32 v25, v25, v54
    v_exp_f32 v56, v56
    v_mfma_f32_32x32x16_bf16 v[112:127], a[188:191], v[40:43], v[112:127]
    s_add_u32 m0, s52, 57344
    v_add_f32 v25, v25, v55
    v_cvt_pk_bf16_f32 v51, v54, v55
    v_exp_f32 v57, v57
    v_add_f32 v25, v25, v56
    v_mfma_f32_32x32x16_bf16 v[32:47], a[128:131], a[64:67], 0
    buffer_load_dwordx4 v20, s[16:19], s45 offen offset:0 nt lds
    v_exp_f32 v58, v58
    v_add_f32 v25, v25, v57
    v_cvt_pk_bf16_f32 v56, v56, v57
    v_mfma_f32_32x32x16_bf16 v[32:47], a[132:135], a[68:71], v[32:47]
    v_exp_f32 v59, v59
    v_add_f32 v25, v25, v58
    v_exp_f32 v60, v60
    v_mfma_f32_32x32x16_bf16 v[32:47], a[136:139], a[72:75], v[32:47]
    buffer_load_dwordx4 v20, s[16:19], s46 offen offset:1024 nt lds
    v_add_f32 v25, v25, v59
    v_cvt_pk_bf16_f32 v57, v58, v59
    v_exp_f32 v61, v61
    v_mfma_f32_32x32x16_bf16 v[32:47], a[140:143], a[76:79], v[32:47]
    v_add_f32 v25, v25, v60
    v_exp_f32 v62, v62
    v_add_f32 v25, v25, v61
    v_cvt_pk_bf16_f32 v58, v60, v61
    v_mfma_f32_32x32x16_bf16 v[32:47], a[144:147], a[80:83], v[32:47]
    buffer_load_dwordx4 v20, s[16:19], s47 offen offset:2048 nt lds
    v_exp_f32 v63, v63
    v_add_f32 v25, v25, v62
    v_add_f32 v25, v25, v63
    v_mfma_f32_32x32x16_bf16 v[32:47], a[148:151], a[84:87], v[32:47]
    v_cvt_pk_bf16_f32 v59, v62, v63
    v_mfma_f32_32x32x16_bf16 v[32:47], a[152:155], a[88:91], v[32:47]
    s_waitcnt vmcnt(11)
    s_barrier
    v_mfma_f32_32x32x16_bf16 v[32:47], a[156:159], a[92:95], v[32:47]
    buffer_load_dwordx4 v20, s[16:19], s48 offen offset:3072 nt lds
    ds_read_b128 a[192:195], v12 offset:0
    v_xor_b32 v20, 57344, v20
    v_mfma_f32_32x32x16_bf16 v[128:143], a[160:163], v[48:51], v[128:143]
    ds_read_b128 a[196:199], v13 offset:0
    v_mfma_f32_32x32x16_bf16 v[144:159], a[164:167], v[48:51], v[144:159]
    ds_read_b128 a[200:203], v14 offset:0
    v_exp_f32 v32, v32
    v_exp_f32 v33, v33
    v_mfma_f32_32x32x16_bf16 v[160:175], a[168:171], v[48:51], v[160:175]
    ds_read_b128 a[204:207], v15 offset:0
    v_add_f32 v26, v26, v32
    v_exp_f32 v34, v34
    v_add_f32 v26, v26, v33
    v_mfma_f32_32x32x16_bf16 v[176:191], a[172:175], v[48:51], v[176:191]
    ds_read_b128 a[208:211], v12 offset:1024
    v_cvt_pk_bf16_f32 v32, v32, v33
    v_exp_f32 v35, v35
    v_add_f32 v26, v26, v34
    v_mfma_f32_32x32x16_bf16 v[128:143], a[176:179], v[56:59], v[128:143]
    ds_read_b128 a[212:215], v13 offset:1024
    v_exp_f32 v36, v36
    v_add_f32 v26, v26, v35
    v_cvt_pk_bf16_f32 v33, v34, v35
    v_mfma_f32_32x32x16_bf16 v[144:159], a[180:183], v[56:59], v[144:159]
    ds_read_b128 a[216:219], v14 offset:1024
    v_exp_f32 v37, v37
    v_add_f32 v26, v26, v36
    v_mfma_f32_32x32x16_bf16 v[160:175], a[184:187], v[56:59], v[160:175]
    ds_read_b128 a[220:223], v15 offset:1024
    v_exp_f32 v38, v38
    v_add_f32 v26, v26, v37
    v_cvt_pk_bf16_f32 v34, v36, v37
    v_mfma_f32_32x32x16_bf16 v[176:191], a[188:191], v[56:59], v[176:191]
    ds_read_b64_tr_b16 a[224:225], v16 offset:49152
    s_waitcnt lgkmcnt(6)
    v_exp_f32 v39, v39
    v_add_f32 v26, v26, v38
    v_mfma_f32_32x32x16_bf16 v[48:63], a[192:195], a[0:3], 0
    ds_read_b64_tr_b16 a[226:227], v16 offset:53248
    v_exp_f32 v40, v40
    v_add_f32 v26, v26, v39
    v_cvt_pk_bf16_f32 v35, v38, v39
    v_mfma_f32_32x32x16_bf16 v[48:63], a[196:199], a[4:7], v[48:63]
    ds_read_b64_tr_b16 a[228:229], v17 offset:49152
    v_exp_f32 v41, v41
    v_add_f32 v26, v26, v40
    v_mfma_f32_32x32x16_bf16 v[48:63], a[200:203], a[8:11], v[48:63]
    s_waitcnt lgkmcnt(5)
    v_exp_f32 v42, v42
    v_add_f32 v26, v26, v41
    v_cvt_pk_bf16_f32 v40, v40, v41
    v_mfma_f32_32x32x16_bf16 v[48:63], a[204:207], a[12:15], v[48:63]
    ds_read_b64_tr_b16 a[230:231], v17 offset:53248
    v_exp_f32 v43, v43
    v_add_f32 v26, v26, v42
    v_mfma_f32_32x32x16_bf16 v[48:63], a[208:211], a[16:19], v[48:63]
    ds_read_b64_tr_b16 a[232:233], v16 offset:50176
    v_exp_f32 v44, v44
    v_add_f32 v26, v26, v43
    v_cvt_pk_bf16_f32 v41, v42, v43
    v_mfma_f32_32x32x16_bf16 v[48:63], a[212:215], a[20:23], v[48:63]
    s_waitcnt lgkmcnt(4)
    v_exp_f32 v45, v45
    v_add_f32 v26, v26, v44
    v_exp_f32 v46, v46
    v_mfma_f32_32x32x16_bf16 v[48:63], a[216:219], a[24:27], v[48:63]
    ds_read_b64_tr_b16 a[234:235], v16 offset:54272
    v_add_f32 v26, v26, v45
    v_cvt_pk_bf16_f32 v42, v44, v45
    v_exp_f32 v47, v47
    v_mfma_f32_32x32x16_bf16 v[48:63], a[220:223], a[28:31], v[48:63]
    ds_read_b64_tr_b16 a[236:237], v17 offset:50176
    v_add_f32 v26, v26, v46
    v_add_f32 v26, v26, v47
    v_cvt_pk_bf16_f32 v43, v46, v47
    v_mfma_f32_32x32x16_bf16 v[192:207], a[160:163], v[32:35], v[192:207]
    v_mfma_f32_32x32x16_bf16 v[208:223], a[164:167], v[32:35], v[208:223]
    ds_read_b64_tr_b16 a[238:239], v17 offset:54272
    v_exp_f32 v48, v48
    v_exp_f32 v49, v49
    v_mfma_f32_32x32x16_bf16 v[224:239], a[168:171], v[32:35], v[224:239]
    ds_read_b64_tr_b16 a[240:241], v16 offset:51200
    v_add_f32 v24, v24, v48
    v_exp_f32 v50, v50
    v_add_f32 v24, v24, v49
    v_mfma_f32_32x32x16_bf16 v[240:255], a[172:175], v[32:35], v[240:255]
    ds_read_b64_tr_b16 a[242:243], v16 offset:55296
    v_cvt_pk_bf16_f32 v48, v48, v49
    v_exp_f32 v51, v51
    v_add_f32 v24, v24, v50
    v_mfma_f32_32x32x16_bf16 v[192:207], a[176:179], v[40:43], v[192:207]
    v_exp_f32 v52, v52
    v_add_f32 v24, v24, v51
    v_cvt_pk_bf16_f32 v49, v50, v51
    v_mfma_f32_32x32x16_bf16 v[208:223], a[180:183], v[40:43], v[208:223]
    ds_read_b64_tr_b16 a[244:245], v17 offset:51200
    v_exp_f32 v53, v53
    v_add_f32 v24, v24, v52
    v_mfma_f32_32x32x16_bf16 v[224:239], a[184:187], v[40:43], v[224:239]
    ds_read_b64_tr_b16 a[246:247], v17 offset:55296
    s_add_u32 m0, s52, 40960
    v_exp_f32 v54, v54
    v_add_f32 v24, v24, v53
    v_cvt_pk_bf16_f32 v50, v52, v53
    v_mfma_f32_32x32x16_bf16 v[240:255], a[188:191], v[40:43], v[240:255]
    buffer_load_dwordx4 v21, s[20:23], s45 offen offset:0 nt lds
    v_exp_f32 v55, v55
    v_add_f32 v24, v24, v54
    v_mfma_f32_32x32x16_bf16 v[32:47], a[192:195], a[32:35], 0
    ds_read_b64_tr_b16 a[248:249], v16 offset:52224
    v_exp_f32 v56, v56
    v_add_f32 v24, v24, v55
    v_cvt_pk_bf16_f32 v51, v54, v55
    v_mfma_f32_32x32x16_bf16 v[32:47], a[196:199], a[36:39], v[32:47]
    buffer_load_dwordx4 v21, s[20:23], s46 offen offset:1024 nt lds
    ds_read_b64_tr_b16 a[250:251], v16 offset:56320
    v_exp_f32 v57, v57
    v_mfma_f32_32x32x16_bf16 v[32:47], a[200:203], a[40:43], v[32:47]
    v_add_f32 v24, v24, v56
    v_exp_f32 v58, v58
    v_add_f32 v24, v24, v57
    v_cvt_pk_bf16_f32 v56, v56, v57
    v_mfma_f32_32x32x16_bf16 v[32:47], a[204:207], a[44:47], v[32:47]
    buffer_load_dwordx4 v21, s[20:23], s47 offen offset:2048 nt lds
    ds_read_b64_tr_b16 a[252:253], v17 offset:52224
    v_exp_f32 v59, v59
    v_mfma_f32_32x32x16_bf16 v[32:47], a[208:211], a[48:51], v[32:47]
    ds_read_b64_tr_b16 a[254:255], v17 offset:56320
    v_add_f32 v24, v24, v58
    v_exp_f32 v60, v60
    v_add_f32 v24, v24, v59
    v_mfma_f32_32x32x16_bf16 v[32:47], a[212:215], a[52:55], v[32:47]
    buffer_load_dwordx4 v21, s[20:23], s48 offen offset:3072 nt lds
    v_xor_b32 v21, 57344, v21
    v_cvt_pk_bf16_f32 v57, v58, v59
    v_exp_f32 v61, v61
    v_mfma_f32_32x32x16_bf16 v[32:47], a[216:219], a[56:59], v[32:47]
    v_add_f32 v24, v24, v60
    v_exp_f32 v62, v62
    v_add_f32 v24, v24, v61
    v_cvt_pk_bf16_f32 v58, v60, v61
    v_mfma_f32_32x32x16_bf16 v[32:47], a[220:223], a[60:63], v[32:47]
    s_waitcnt lgkmcnt(2)
    v_exp_f32 v63, v63
    v_add_f32 v24, v24, v62
    v_add_f32 v24, v24, v63
    v_cvt_pk_bf16_f32 v59, v62, v63
    v_mfma_f32_32x32x16_bf16 v[64:79], a[224:227], v[48:51], v[64:79]
    v_mfma_f32_32x32x16_bf16 v[80:95], a[228:231], v[48:51], v[80:95]
    v_exp_f32 v32, v32
    v_exp_f32 v33, v33
    v_add_f32 v25, v25, v32
    v_mfma_f32_32x32x16_bf16 v[96:111], a[232:235], v[48:51], v[96:111]
    v_exp_f32 v34, v34
    v_add_f32 v25, v25, v33
    v_cvt_pk_bf16_f32 v32, v32, v33
    v_mfma_f32_32x32x16_bf16 v[112:127], a[236:239], v[48:51], v[112:127]
    v_exp_f32 v35, v35
    v_add_f32 v25, v25, v34
    v_exp_f32 v36, v36
    v_mfma_f32_32x32x16_bf16 v[64:79], a[240:243], v[56:59], v[64:79]
    v_add_f32 v25, v25, v35
    v_cvt_pk_bf16_f32 v33, v34, v35
    v_exp_f32 v37, v37
    v_add_f32 v25, v25, v36
    v_mfma_f32_32x32x16_bf16 v[80:95], a[244:247], v[56:59], v[80:95]
    v_exp_f32 v38, v38
    v_add_f32 v25, v25, v37
    v_cvt_pk_bf16_f32 v34, v36, v37
    v_mfma_f32_32x32x16_bf16 v[96:111], a[248:251], v[56:59], v[96:111]
    s_waitcnt lgkmcnt(0)
    v_exp_f32 v39, v39
    v_add_f32 v25, v25, v38
    v_exp_f32 v40, v40
    v_mfma_f32_32x32x16_bf16 v[112:127], a[252:255], v[56:59], v[112:127]
    v_add_f32 v25, v25, v39
    v_cvt_pk_bf16_f32 v35, v38, v39
    v_exp_f32 v41, v41
    v_add_f32 v25, v25, v40
    v_mfma_f32_32x32x16_bf16 v[48:63], a[192:195], a[64:67], 0
    v_exp_f32 v42, v42
    v_add_f32 v25, v25, v41
    v_cvt_pk_bf16_f32 v40, v40, v41
    v_mfma_f32_32x32x16_bf16 v[48:63], a[196:199], a[68:71], v[48:63]
    v_exp_f32 v43, v43
    v_add_f32 v25, v25, v42
    v_exp_f32 v44, v44
    v_mfma_f32_32x32x16_bf16 v[48:63], a[200:203], a[72:75], v[48:63]
    v_add_f32 v25, v25, v43
    v_cvt_pk_bf16_f32 v41, v42, v43
    v_exp_f32 v45, v45
    v_add_f32 v25, v25, v44
    v_mfma_f32_32x32x16_bf16 v[48:63], a[204:207], a[76:79], v[48:63]
    v_exp_f32 v46, v46
    v_add_f32 v25, v25, v45
    v_cvt_pk_bf16_f32 v42, v44, v45
    v_mfma_f32_32x32x16_bf16 v[48:63], a[208:211], a[80:83], v[48:63]
    v_exp_f32 v47, v47
    v_add_f32 v25, v25, v46
    v_add_f32 v25, v25, v47
    v_cvt_pk_bf16_f32 v43, v46, v47
    v_mfma_f32_32x32x16_bf16 v[48:63], a[212:215], a[84:87], v[48:63]
    v_mfma_f32_32x32x16_bf16 v[48:63], a[216:219], a[88:91], v[48:63]
    s_waitcnt vmcnt(8)
    s_barrier
    v_mfma_f32_32x32x16_bf16 v[48:63], a[220:223], a[92:95], v[48:63]
    ds_read_b128 a[96:99], v12 offset:49152
    v_mfma_f32_32x32x16_bf16 v[128:143], a[224:227], v[32:35], v[128:143]
    ds_read_b128 a[100:103], v13 offset:49152
    v_mfma_f32_32x32x16_bf16 v[144:159], a[228:231], v[32:35], v[144:159]
    ds_read_b128 a[104:107], v14 offset:49152
    v_exp_f32 v48, v48
    v_exp_f32 v49, v49
    v_mfma_f32_32x32x16_bf16 v[160:175], a[232:235], v[32:35], v[160:175]
    ds_read_b128 a[108:111], v15 offset:49152
    v_add_f32 v26, v26, v48
    v_exp_f32 v50, v50
    v_add_f32 v26, v26, v49
    v_mfma_f32_32x32x16_bf16 v[176:191], a[236:239], v[32:35], v[176:191]
    ds_read_b128 a[112:115], v12 offset:50176
    v_cvt_pk_bf16_f32 v48, v48, v49
    v_exp_f32 v51, v51
    v_add_f32 v26, v26, v50
    v_mfma_f32_32x32x16_bf16 v[128:143], a[240:243], v[40:43], v[128:143]
    ds_read_b128 a[116:119], v13 offset:50176
    v_exp_f32 v52, v52
    v_add_f32 v26, v26, v51
    v_cvt_pk_bf16_f32 v49, v50, v51
    v_mfma_f32_32x32x16_bf16 v[144:159], a[244:247], v[40:43], v[144:159]
    ds_read_b128 a[120:123], v14 offset:50176
    v_exp_f32 v53, v53
    v_add_f32 v26, v26, v52
    v_mfma_f32_32x32x16_bf16 v[160:175], a[248:251], v[40:43], v[160:175]
    ds_read_b128 a[124:127], v15 offset:50176
    s_add_u32 m0, s52, 32768
    v_exp_f32 v54, v54
    v_add_f32 v26, v26, v53
    v_cvt_pk_bf16_f32 v50, v52, v53
    v_mfma_f32_32x32x16_bf16 v[176:191], a[252:255], v[40:43], v[176:191]
    buffer_load_dwordx4 v20, s[16:19], s45 offen offset:0 nt lds
    s_waitcnt lgkmcnt(5)
    v_exp_f32 v55, v55
    v_add_f32 v26, v26, v54
    v_mfma_f32_32x32x16_bf16 v[32:47], a[96:99], a[0:3], 0
    ds_read_b64_tr_b16 a[128:129], v16 offset:57344
    v_exp_f32 v56, v56
    v_add_f32 v26, v26, v55
    v_cvt_pk_bf16_f32 v51, v54, v55
    v_mfma_f32_32x32x16_bf16 v[32:47], a[100:103], a[4:7], v[32:47]
    buffer_load_dwordx4 v20, s[16:19], s46 offen offset:1024 nt lds
    v_exp_f32 v57, v57
    v_add_f32 v26, v26, v56
    v_mfma_f32_32x32x16_bf16 v[32:47], a[104:107], a[8:11], v[32:47]
    ds_read_b64_tr_b16 a[130:131], v16 offset:61440
    s_waitcnt lgkmcnt(4)
    v_exp_f32 v58, v58
    v_add_f32 v26, v26, v57
    v_cvt_pk_bf16_f32 v56, v56, v57
    v_mfma_f32_32x32x16_bf16 v[32:47], a[108:111], a[12:15], v[32:47]
    buffer_load_dwordx4 v20, s[16:19], s47 offen offset:2048 nt lds
    v_exp_f32 v59, v59
    v_add_f32 v26, v26, v58
    v_mfma_f32_32x32x16_bf16 v[32:47], a[112:115], a[16:19], v[32:47]
    ds_read_b64_tr_b16 a[132:133], v17 offset:57344
    v_exp_f32 v60, v60
    v_add_f32 v26, v26, v59
    v_cvt_pk_bf16_f32 v57, v58, v59
    v_mfma_f32_32x32x16_bf16 v[32:47], a[116:119], a[20:23], v[32:47]
    buffer_load_dwordx4 v20, s[16:19], s48 offen offset:3072 nt lds
    s_waitcnt lgkmcnt(3)
    v_xor_b32 v20, 8192, v20
    v_exp_f32 v61, v61
    v_add_f32 v26, v26, v60
    v_mfma_f32_32x32x16_bf16 v[32:47], a[120:123], a[24:27], v[32:47]
    ds_read_b64_tr_b16 a[134:135], v17 offset:61440
    v_exp_f32 v62, v62
    v_add_f32 v26, v26, v61
    v_cvt_pk_bf16_f32 v58, v60, v61
    v_mfma_f32_32x32x16_bf16 v[32:47], a[124:127], a[28:31], v[32:47]
    ds_read_b64_tr_b16 a[136:137], v16 offset:58368
    v_exp_f32 v63, v63
    v_add_f32 v26, v26, v62
    v_add_f32 v26, v26, v63
    v_mfma_f32_32x32x16_bf16 v[192:207], a[224:227], v[48:51], v[192:207]
    ds_read_b64_tr_b16 a[138:139], v16 offset:62464
    v_cvt_pk_bf16_f32 v59, v62, v63
    v_mfma_f32_32x32x16_bf16 v[208:223], a[228:231], v[48:51], v[208:223]
    ds_read_b64_tr_b16 a[140:141], v17 offset:58368
    v_exp_f32 v32, v32
    v_exp_f32 v33, v33
    v_mfma_f32_32x32x16_bf16 v[224:239], a[232:235], v[48:51], v[224:239]
    ds_read_b64_tr_b16 a[142:143], v17 offset:62464
    v_add_f32 v24, v24, v32
    v_exp_f32 v34, v34
    v_add_f32 v24, v24, v33
    v_mfma_f32_32x32x16_bf16 v[240:255], a[236:239], v[48:51], v[240:255]
    ds_read_b64_tr_b16 a[144:145], v16 offset:59392
    v_cvt_pk_bf16_f32 v32, v32, v33
    v_exp_f32 v35, v35
    v_add_f32 v24, v24, v34
    v_mfma_f32_32x32x16_bf16 v[192:207], a[240:243], v[56:59], v[192:207]
    ds_read_b64_tr_b16 a[146:147], v16 offset:63488
    v_exp_f32 v36, v36
    v_add_f32 v24, v24, v35
    v_cvt_pk_bf16_f32 v33, v34, v35
    v_mfma_f32_32x32x16_bf16 v[208:223], a[244:247], v[56:59], v[208:223]
    ds_read_b64_tr_b16 a[148:149], v17 offset:59392
    v_exp_f32 v37, v37
    v_add_f32 v24, v24, v36
    v_mfma_f32_32x32x16_bf16 v[224:239], a[248:251], v[56:59], v[224:239]
    ds_read_b64_tr_b16 a[150:151], v17 offset:63488
    v_exp_f32 v38, v38
    v_add_f32 v24, v24, v37
    v_cvt_pk_bf16_f32 v34, v36, v37
    v_mfma_f32_32x32x16_bf16 v[240:255], a[252:255], v[56:59], v[240:255]
    v_exp_f32 v39, v39
    v_add_f32 v24, v24, v38
    v_exp_f32 v40, v40
    v_mfma_f32_32x32x16_bf16 v[48:63], a[96:99], a[32:35], 0
    ds_read_b64_tr_b16 a[152:153], v16 offset:60416
    v_add_f32 v24, v24, v39
    v_cvt_pk_bf16_f32 v35, v38, v39
    v_exp_f32 v41, v41
    v_mfma_f32_32x32x16_bf16 v[48:63], a[100:103], a[36:39], v[48:63]
    ds_read_b64_tr_b16 a[154:155], v16 offset:64512
    v_add_f32 v24, v24, v40
    v_exp_f32 v42, v42
    v_add_f32 v24, v24, v41
    v_mfma_f32_32x32x16_bf16 v[48:63], a[104:107], a[40:43], v[48:63]
    v_cvt_pk_bf16_f32 v40, v40, v41
    v_exp_f32 v43, v43
    v_add_f32 v24, v24, v42
    v_mfma_f32_32x32x16_bf16 v[48:63], a[108:111], a[44:47], v[48:63]
    ds_read_b64_tr_b16 a[156:157], v17 offset:60416
    v_exp_f32 v44, v44
    v_add_f32 v24, v24, v43
    v_cvt_pk_bf16_f32 v41, v42, v43
    v_mfma_f32_32x32x16_bf16 v[48:63], a[112:115], a[48:51], v[48:63]
    ds_read_b64_tr_b16 a[158:159], v17 offset:64512
    v_exp_f32 v45, v45
    v_add_f32 v24, v24, v44
    v_mfma_f32_32x32x16_bf16 v[48:63], a[116:119], a[52:55], v[48:63]
    v_exp_f32 v46, v46
    v_add_f32 v24, v24, v45
    v_cvt_pk_bf16_f32 v42, v44, v45
    v_mfma_f32_32x32x16_bf16 v[48:63], a[120:123], a[56:59], v[48:63]
    v_exp_f32 v47, v47
    v_add_f32 v24, v24, v46
    v_add_f32 v24, v24, v47
    v_cvt_pk_bf16_f32 v43, v46, v47
    v_mfma_f32_32x32x16_bf16 v[48:63], a[124:127], a[60:63], v[48:63]
    s_waitcnt lgkmcnt(3)
    v_mfma_f32_32x32x16_bf16 v[64:79], a[128:131], v[32:35], v[64:79]
    v_mfma_f32_32x32x16_bf16 v[80:95], a[132:135], v[32:35], v[80:95]
    v_exp_f32 v48, v48
    v_exp_f32 v49, v49
    v_add_f32 v25, v25, v48
    v_mfma_f32_32x32x16_bf16 v[96:111], a[136:139], v[32:35], v[96:111]
    v_exp_f32 v50, v50
    v_add_f32 v25, v25, v49
    v_cvt_pk_bf16_f32 v48, v48, v49
    v_mfma_f32_32x32x16_bf16 v[112:127], a[140:143], v[32:35], v[112:127]
    v_exp_f32 v51, v51
    v_add_f32 v25, v25, v50
    v_exp_f32 v52, v52
    v_mfma_f32_32x32x16_bf16 v[64:79], a[144:147], v[40:43], v[64:79]
    v_add_f32 v25, v25, v51
    v_cvt_pk_bf16_f32 v49, v50, v51
    v_exp_f32 v53, v53
    v_add_f32 v25, v25, v52
    v_mfma_f32_32x32x16_bf16 v[80:95], a[148:151], v[40:43], v[80:95]
    s_add_u32 m0, s52, 16384
    s_waitcnt lgkmcnt(0)
    v_exp_f32 v54, v54
    v_add_f32 v25, v25, v53
    v_cvt_pk_bf16_f32 v50, v52, v53
    v_mfma_f32_32x32x16_bf16 v[96:111], a[152:155], v[40:43], v[96:111]
    buffer_load_dwordx4 v21, s[20:23], s45 offen offset:0 nt lds
    v_exp_f32 v55, v55
    v_add_f32 v25, v25, v54
    v_mfma_f32_32x32x16_bf16 v[112:127], a[156:159], v[40:43], v[112:127]
    v_exp_f32 v56, v56
    v_add_f32 v25, v25, v55
    v_cvt_pk_bf16_f32 v51, v54, v55
    v_mfma_f32_32x32x16_bf16 v[32:47], a[96:99], a[64:67], 0
    buffer_load_dwordx4 v21, s[20:23], s46 offen offset:1024 nt lds
    v_exp_f32 v57, v57
    v_add_f32 v25, v25, v56
    v_mfma_f32_32x32x16_bf16 v[32:47], a[100:103], a[68:71], v[32:47]
    v_exp_f32 v58, v58
    v_add_f32 v25, v25, v57
    v_cvt_pk_bf16_f32 v56, v56, v57
    v_mfma_f32_32x32x16_bf16 v[32:47], a[104:107], a[72:75], v[32:47]
    buffer_load_dwordx4 v21, s[20:23], s47 offen offset:2048 nt lds
    v_exp_f32 v59, v59
    v_add_f32 v25, v25, v58
    v_mfma_f32_32x32x16_bf16 v[32:47], a[108:111], a[76:79], v[32:47]
    v_exp_f32 v60, v60
    v_add_f32 v25, v25, v59
    v_cvt_pk_bf16_f32 v57, v58, v59
    v_mfma_f32_32x32x16_bf16 v[32:47], a[112:115], a[80:83], v[32:47]
    buffer_load_dwordx4 v21, s[20:23], s48 offen offset:3072 nt lds
    v_xor_b32 v21, 8192, v21
    v_exp_f32 v61, v61
    v_add_f32 v25, v25, v60
    v_mfma_f32_32x32x16_bf16 v[32:47], a[116:119], a[84:87], v[32:47]
    v_exp_f32 v62, v62
    v_add_f32 v25, v25, v61
    v_cvt_pk_bf16_f32 v58, v60, v61
    v_mfma_f32_32x32x16_bf16 v[32:47], a[120:123], a[88:91], v[32:47]
    s_waitcnt vmcnt(8)
    s_barrier
    v_mfma_f32_32x32x16_bf16 v[32:47], a[124:127], a[92:95], v[32:47]
    ds_read_b128 a[160:163], v12 offset:57344
    v_exp_f32 v63, v63
    v_add_f32 v25, v25, v62
    v_add_f32 v25, v25, v63
    v_mfma_f32_32x32x16_bf16 v[128:143], a[128:131], v[48:51], v[128:143]
    ds_read_b128 a[164:167], v13 offset:57344
    v_cvt_pk_bf16_f32 v59, v62, v63
    v_mfma_f32_32x32x16_bf16 v[144:159], a[132:135], v[48:51], v[144:159]
    ds_read_b128 a[168:171], v14 offset:57344
    v_exp_f32 v32, v32
    v_exp_f32 v33, v33
    v_mfma_f32_32x32x16_bf16 v[160:175], a[136:139], v[48:51], v[160:175]
    ds_read_b128 a[172:175], v15 offset:57344
    v_add_f32 v26, v26, v32
    v_exp_f32 v34, v34
    v_add_f32 v26, v26, v33
    v_mfma_f32_32x32x16_bf16 v[176:191], a[140:143], v[48:51], v[176:191]
    ds_read_b128 a[176:179], v12 offset:58368
    v_cvt_pk_bf16_f32 v32, v32, v33
    v_exp_f32 v35, v35
    v_add_f32 v26, v26, v34
    v_mfma_f32_32x32x16_bf16 v[128:143], a[144:147], v[56:59], v[128:143]
    ds_read_b128 a[180:183], v13 offset:58368
    v_exp_f32 v36, v36
    v_add_f32 v26, v26, v35
    v_cvt_pk_bf16_f32 v33, v34, v35
    v_mfma_f32_32x32x16_bf16 v[144:159], a[148:151], v[56:59], v[144:159]
    ds_read_b128 a[184:187], v14 offset:58368
    v_exp_f32 v37, v37
    v_add_f32 v26, v26, v36
    v_mfma_f32_32x32x16_bf16 v[160:175], a[152:155], v[56:59], v[160:175]
    ds_read_b128 a[188:191], v15 offset:58368
    v_exp_f32 v38, v38
    v_add_f32 v26, v26, v37
    v_cvt_pk_bf16_f32 v34, v36, v37
    v_mfma_f32_32x32x16_bf16 v[176:191], a[156:159], v[56:59], v[176:191]
    ds_read_b64_tr_b16 a[192:193], v16 offset:24576
    s_waitcnt lgkmcnt(6)
    v_exp_f32 v39, v39
    v_add_f32 v26, v26, v38
    v_mfma_f32_32x32x16_bf16 v[48:63], a[160:163], a[0:3], 0
    ds_read_b64_tr_b16 a[194:195], v16 offset:28672
    v_exp_f32 v40, v40
    v_add_f32 v26, v26, v39
    v_cvt_pk_bf16_f32 v35, v38, v39
    v_mfma_f32_32x32x16_bf16 v[48:63], a[164:167], a[4:7], v[48:63]
    ds_read_b64_tr_b16 a[196:197], v17 offset:24576
    v_exp_f32 v41, v41
    v_add_f32 v26, v26, v40
    v_mfma_f32_32x32x16_bf16 v[48:63], a[168:171], a[8:11], v[48:63]
    s_waitcnt lgkmcnt(5)
    v_exp_f32 v42, v42
    v_add_f32 v26, v26, v41
    v_cvt_pk_bf16_f32 v40, v40, v41
    v_mfma_f32_32x32x16_bf16 v[48:63], a[172:175], a[12:15], v[48:63]
    ds_read_b64_tr_b16 a[198:199], v17 offset:28672
    v_exp_f32 v43, v43
    v_add_f32 v26, v26, v42
    v_mfma_f32_32x32x16_bf16 v[48:63], a[176:179], a[16:19], v[48:63]
    ds_read_b64_tr_b16 a[200:201], v16 offset:25600
    v_exp_f32 v44, v44
    v_add_f32 v26, v26, v43
    v_cvt_pk_bf16_f32 v41, v42, v43
    v_mfma_f32_32x32x16_bf16 v[48:63], a[180:183], a[20:23], v[48:63]
    s_waitcnt lgkmcnt(4)
    v_exp_f32 v45, v45
    v_add_f32 v26, v26, v44
    v_exp_f32 v46, v46
    v_mfma_f32_32x32x16_bf16 v[48:63], a[184:187], a[24:27], v[48:63]
    ds_read_b64_tr_b16 a[202:203], v16 offset:29696
    v_add_f32 v26, v26, v45
    v_cvt_pk_bf16_f32 v42, v44, v45
    v_exp_f32 v47, v47
    v_mfma_f32_32x32x16_bf16 v[48:63], a[188:191], a[28:31], v[48:63]
    ds_read_b64_tr_b16 a[204:205], v17 offset:25600
    v_add_f32 v26, v26, v46
    v_add_f32 v26, v26, v47
    v_cvt_pk_bf16_f32 v43, v46, v47
    v_mfma_f32_32x32x16_bf16 v[192:207], a[128:131], v[32:35], v[192:207]
    v_mfma_f32_32x32x16_bf16 v[208:223], a[132:135], v[32:35], v[208:223]
    ds_read_b64_tr_b16 a[206:207], v17 offset:29696
    v_exp_f32 v48, v48
    v_exp_f32 v49, v49
    v_mfma_f32_32x32x16_bf16 v[224:239], a[136:139], v[32:35], v[224:239]
    ds_read_b64_tr_b16 a[208:209], v16 offset:26624
    v_add_f32 v24, v24, v48
    v_exp_f32 v50, v50
    v_add_f32 v24, v24, v49
    v_mfma_f32_32x32x16_bf16 v[240:255], a[140:143], v[32:35], v[240:255]
    ds_read_b64_tr_b16 a[210:211], v16 offset:30720
    v_cvt_pk_bf16_f32 v48, v48, v49
    v_exp_f32 v51, v51
    v_add_f32 v24, v24, v50
    v_mfma_f32_32x32x16_bf16 v[192:207], a[144:147], v[40:43], v[192:207]
    s_add_u32 m0, s52, 8192
    v_exp_f32 v52, v52
    v_add_f32 v24, v24, v51
    v_cvt_pk_bf16_f32 v49, v50, v51
    v_mfma_f32_32x32x16_bf16 v[208:223], a[148:151], v[40:43], v[208:223]
    buffer_load_dwordx4 v20, s[16:19], s45 offen offset:0 nt lds
    ds_read_b64_tr_b16 a[212:213], v17 offset:26624
    v_exp_f32 v53, v53
    v_mfma_f32_32x32x16_bf16 v[224:239], a[152:155], v[40:43], v[224:239]
    ds_read_b64_tr_b16 a[214:215], v17 offset:30720
    v_add_f32 v24, v24, v52
    v_exp_f32 v54, v54
    v_add_f32 v24, v24, v53
    v_mfma_f32_32x32x16_bf16 v[240:255], a[156:159], v[40:43], v[240:255]
    buffer_load_dwordx4 v20, s[16:19], s46 offen offset:1024 nt lds
    v_cvt_pk_bf16_f32 v50, v52, v53
    v_exp_f32 v55, v55
    v_add_f32 v24, v24, v54
    v_mfma_f32_32x32x16_bf16 v[32:47], a[160:163], a[32:35], 0
    ds_read_b64_tr_b16 a[216:217], v16 offset:27648
    v_exp_f32 v56, v56
    v_add_f32 v24, v24, v55
    v_cvt_pk_bf16_f32 v51, v54, v55
    v_mfma_f32_32x32x16_bf16 v[32:47], a[164:167], a[36:39], v[32:47]
    buffer_load_dwordx4 v20, s[16:19], s47 offen offset:2048 nt lds
    v_exp_f32 v57, v57
    v_add_f32 v24, v24, v56
    v_mfma_f32_32x32x16_bf16 v[32:47], a[168:171], a[40:43], v[32:47]
    ds_read_b64_tr_b16 a[218:219], v16 offset:31744
    v_exp_f32 v58, v58
    v_add_f32 v24, v24, v57
    v_cvt_pk_bf16_f32 v56, v56, v57
    v_mfma_f32_32x32x16_bf16 v[32:47], a[172:175], a[44:47], v[32:47]
    buffer_load_dwordx4 v20, s[16:19], s48 offen offset:3072 nt lds
    v_xor_b32 v20, 24576, v20
    v_exp_f32 v59, v59
    v_add_f32 v24, v24, v58
    v_mfma_f32_32x32x16_bf16 v[32:47], a[176:179], a[48:51], v[32:47]
    ds_read_b64_tr_b16 a[220:221], v17 offset:27648
    v_exp_f32 v60, v60
    v_add_f32 v24, v24, v59
    v_cvt_pk_bf16_f32 v57, v58, v59
    v_mfma_f32_32x32x16_bf16 v[32:47], a[180:183], a[52:55], v[32:47]
    ds_read_b64_tr_b16 a[222:223], v17 offset:31744
    v_exp_f32 v61, v61
    v_add_f32 v24, v24, v60
    v_mfma_f32_32x32x16_bf16 v[32:47], a[184:187], a[56:59], v[32:47]
    v_exp_f32 v62, v62
    v_add_f32 v24, v24, v61
    v_cvt_pk_bf16_f32 v58, v60, v61
    v_mfma_f32_32x32x16_bf16 v[32:47], a[188:191], a[60:63], v[32:47]
    s_waitcnt lgkmcnt(3)
    v_exp_f32 v63, v63
    v_add_f32 v24, v24, v62
    v_add_f32 v24, v24, v63
    v_cvt_pk_bf16_f32 v59, v62, v63
    v_mfma_f32_32x32x16_bf16 v[64:79], a[192:195], v[48:51], v[64:79]
    v_mfma_f32_32x32x16_bf16 v[80:95], a[196:199], v[48:51], v[80:95]
    v_exp_f32 v32, v32
    v_exp_f32 v33, v33
    v_add_f32 v25, v25, v32
    v_mfma_f32_32x32x16_bf16 v[96:111], a[200:203], v[48:51], v[96:111]
    v_exp_f32 v34, v34
    v_add_f32 v25, v25, v33
    v_cvt_pk_bf16_f32 v32, v32, v33
    v_mfma_f32_32x32x16_bf16 v[112:127], a[204:207], v[48:51], v[112:127]
    v_exp_f32 v35, v35
    v_add_f32 v25, v25, v34
    v_exp_f32 v36, v36
    v_mfma_f32_32x32x16_bf16 v[64:79], a[208:211], v[56:59], v[64:79]
    v_add_f32 v25, v25, v35
    v_cvt_pk_bf16_f32 v33, v34, v35
    v_exp_f32 v37, v37
    v_add_f32 v25, v25, v36
    v_mfma_f32_32x32x16_bf16 v[80:95], a[212:215], v[56:59], v[80:95]
    s_waitcnt lgkmcnt(0)
    v_exp_f32 v38, v38
    v_add_f32 v25, v25, v37
    v_cvt_pk_bf16_f32 v34, v36, v37
    v_mfma_f32_32x32x16_bf16 v[96:111], a[216:219], v[56:59], v[96:111]
    v_exp_f32 v39, v39
    v_add_f32 v25, v25, v38
    v_exp_f32 v40, v40
    v_mfma_f32_32x32x16_bf16 v[112:127], a[220:223], v[56:59], v[112:127]
    v_add_f32 v25, v25, v39
    v_cvt_pk_bf16_f32 v35, v38, v39
    v_exp_f32 v41, v41
    v_add_f32 v25, v25, v40
    v_mfma_f32_32x32x16_bf16 v[48:63], a[160:163], a[64:67], 0
    v_exp_f32 v42, v42
    v_add_f32 v25, v25, v41
    v_cvt_pk_bf16_f32 v40, v40, v41
    v_mfma_f32_32x32x16_bf16 v[48:63], a[164:167], a[68:71], v[48:63]
    v_exp_f32 v43, v43
    v_add_f32 v25, v25, v42
    v_exp_f32 v44, v44
    v_mfma_f32_32x32x16_bf16 v[48:63], a[168:171], a[72:75], v[48:63]
    v_add_f32 v25, v25, v43
    v_cvt_pk_bf16_f32 v41, v42, v43
    v_exp_f32 v45, v45
    v_add_f32 v25, v25, v44
    v_mfma_f32_32x32x16_bf16 v[48:63], a[172:175], a[76:79], v[48:63]
    v_exp_f32 v46, v46
    v_add_f32 v25, v25, v45
    v_cvt_pk_bf16_f32 v42, v44, v45
    v_mfma_f32_32x32x16_bf16 v[48:63], a[176:179], a[80:83], v[48:63]
    v_exp_f32 v47, v47
    v_add_f32 v25, v25, v46
    v_add_f32 v25, v25, v47
    v_cvt_pk_bf16_f32 v43, v46, v47
    v_mfma_f32_32x32x16_bf16 v[48:63], a[180:183], a[84:87], v[48:63]
    v_mfma_f32_32x32x16_bf16 v[48:63], a[184:187], a[88:91], v[48:63]
    s_waitcnt vmcnt(4)
    s_barrier
    v_mfma_f32_32x32x16_bf16 v[48:63], a[188:191], a[92:95], v[48:63]
    ds_read_b128 a[224:227], v12 offset:32768
    v_mfma_f32_32x32x16_bf16 v[128:143], a[192:195], v[32:35], v[128:143]
    ds_read_b128 a[228:231], v13 offset:32768
    v_mfma_f32_32x32x16_bf16 v[144:159], a[196:199], v[32:35], v[144:159]
    ds_read_b128 a[232:235], v14 offset:32768
    v_exp_f32 v48, v48
    v_exp_f32 v49, v49
    v_mfma_f32_32x32x16_bf16 v[160:175], a[200:203], v[32:35], v[160:175]
    ds_read_b128 a[236:239], v15 offset:32768
    v_add_f32 v26, v26, v48
    v_exp_f32 v50, v50
    v_add_f32 v26, v26, v49
    v_mfma_f32_32x32x16_bf16 v[176:191], a[204:207], v[32:35], v[176:191]
    ds_read_b128 a[240:243], v12 offset:33792
    s_add_u32 m0, s52, 24576
    v_cvt_pk_bf16_f32 v48, v48, v49
    v_exp_f32 v51, v51
    v_add_f32 v26, v26, v50
    v_mfma_f32_32x32x16_bf16 v[128:143], a[208:211], v[40:43], v[128:143]
    buffer_load_dwordx4 v21, s[20:23], s45 offen offset:0 nt lds
    ds_read_b128 a[244:247], v13 offset:33792
    v_exp_f32 v52, v52
    v_mfma_f32_32x32x16_bf16 v[144:159], a[212:215], v[40:43], v[144:159]
    ds_read_b128 a[248:251], v14 offset:33792
    v_add_f32 v26, v26, v51
    v_cvt_pk_bf16_f32 v49, v50, v51
    v_exp_f32 v53, v53
    v_mfma_f32_32x32x16_bf16 v[160:175], a[216:219], v[40:43], v[160:175]
    buffer_load_dwordx4 v21, s[20:23], s46 offen offset:1024 nt lds
    ds_read_b128 a[252:255], v15 offset:33792
    v_add_f32 v26, v26, v52
    v_mfma_f32_32x32x16_bf16 v[176:191], a[220:223], v[40:43], v[176:191]
    ds_read_b64_tr_b16 a[96:97], v16 offset:0
    s_waitcnt lgkmcnt(6)
    v_exp_f32 v54, v54
    v_add_f32 v26, v26, v53
    v_cvt_pk_bf16_f32 v50, v52, v53
    v_mfma_f32_32x32x16_bf16 v[32:47], a[224:227], a[0:3], 0
    buffer_load_dwordx4 v21, s[20:23], s47 offen offset:2048 nt lds
    v_exp_f32 v55, v55
    v_add_f32 v26, v26, v54
    v_mfma_f32_32x32x16_bf16 v[32:47], a[228:231], a[4:7], v[32:47]
    ds_read_b64_tr_b16 a[98:99], v16 offset:4096
    v_exp_f32 v56, v56
    v_add_f32 v26, v26, v55
    v_cvt_pk_bf16_f32 v51, v54, v55
    v_mfma_f32_32x32x16_bf16 v[32:47], a[232:235], a[8:11], v[32:47]
    buffer_load_dwordx4 v21, s[20:23], s48 offen offset:3072 nt lds
    s_waitcnt lgkmcnt(4)
    v_xor_b32 v21, 24576, v21
    v_exp_f32 v57, v57
    v_add_f32 v26, v26, v56
    v_mfma_f32_32x32x16_bf16 v[32:47], a[236:239], a[12:15], v[32:47]
    ds_read_b64_tr_b16 a[100:101], v17 offset:0
    v_exp_f32 v58, v58
    v_add_f32 v26, v26, v57
    v_cvt_pk_bf16_f32 v56, v56, v57
    v_mfma_f32_32x32x16_bf16 v[32:47], a[240:243], a[16:19], v[32:47]
    ds_read_b64_tr_b16 a[102:103], v17 offset:4096
    v_exp_f32 v59, v59
    v_add_f32 v26, v26, v58
    v_mfma_f32_32x32x16_bf16 v[32:47], a[244:247], a[20:23], v[32:47]
    ds_read_b64_tr_b16 a[104:105], v16 offset:1024
    s_waitcnt lgkmcnt(4)
    v_exp_f32 v60, v60
    v_add_f32 v26, v26, v59
    v_cvt_pk_bf16_f32 v57, v58, v59
    v_mfma_f32_32x32x16_bf16 v[32:47], a[248:251], a[24:27], v[32:47]
    ds_read_b64_tr_b16 a[106:107], v16 offset:5120
    v_exp_f32 v61, v61
    v_add_f32 v26, v26, v60
    v_mfma_f32_32x32x16_bf16 v[32:47], a[252:255], a[28:31], v[32:47]
    ds_read_b64_tr_b16 a[108:109], v17 offset:1024
    v_exp_f32 v62, v62
    v_add_f32 v26, v26, v61
    v_cvt_pk_bf16_f32 v58, v60, v61
    v_mfma_f32_32x32x16_bf16 v[192:207], a[192:195], v[48:51], v[192:207]
    v_exp_f32 v63, v63
    v_add_f32 v26, v26, v62
    v_add_f32 v26, v26, v63
    v_cvt_pk_bf16_f32 v59, v62, v63
    v_mfma_f32_32x32x16_bf16 v[208:223], a[196:199], v[48:51], v[208:223]
    ds_read_b64_tr_b16 a[110:111], v17 offset:5120
    v_exp_f32 v32, v32
    v_exp_f32 v33, v33
    v_mfma_f32_32x32x16_bf16 v[224:239], a[200:203], v[48:51], v[224:239]
    ds_read_b64_tr_b16 a[112:113], v16 offset:2048
    v_add_f32 v24, v24, v32
    v_exp_f32 v34, v34
    v_add_f32 v24, v24, v33
    v_mfma_f32_32x32x16_bf16 v[240:255], a[204:207], v[48:51], v[240:255]
    ds_read_b64_tr_b16 a[114:115], v16 offset:6144
    v_cvt_pk_bf16_f32 v32, v32, v33
    v_exp_f32 v35, v35
    v_add_f32 v24, v24, v34
    v_mfma_f32_32x32x16_bf16 v[192:207], a[208:211], v[56:59], v[192:207]
    v_exp_f32 v36, v36
    v_add_f32 v24, v24, v35
    v_cvt_pk_bf16_f32 v33, v34, v35
    v_mfma_f32_32x32x16_bf16 v[208:223], a[212:215], v[56:59], v[208:223]
    ds_read_b64_tr_b16 a[116:117], v17 offset:2048
    v_exp_f32 v37, v37
    v_add_f32 v24, v24, v36
    v_mfma_f32_32x32x16_bf16 v[224:239], a[216:219], v[56:59], v[224:239]
    ds_read_b64_tr_b16 a[118:119], v17 offset:6144
    v_exp_f32 v38, v38
    v_add_f32 v24, v24, v37
    v_cvt_pk_bf16_f32 v34, v36, v37
    v_mfma_f32_32x32x16_bf16 v[240:255], a[220:223], v[56:59], v[240:255]
    v_exp_f32 v39, v39
    v_add_f32 v24, v24, v38
    v_exp_f32 v40, v40
    v_mfma_f32_32x32x16_bf16 v[48:63], a[224:227], a[32:35], 0
    ds_read_b64_tr_b16 a[120:121], v16 offset:3072
    v_add_f32 v24, v24, v39
    v_cvt_pk_bf16_f32 v35, v38, v39
    v_exp_f32 v41, v41
    v_mfma_f32_32x32x16_bf16 v[48:63], a[228:231], a[36:39], v[48:63]
    ds_read_b64_tr_b16 a[122:123], v16 offset:7168
    v_add_f32 v24, v24, v40
    v_exp_f32 v42, v42
    v_add_f32 v24, v24, v41
    v_mfma_f32_32x32x16_bf16 v[48:63], a[232:235], a[40:43], v[48:63]
    v_cvt_pk_bf16_f32 v40, v40, v41
    v_exp_f32 v43, v43
    v_add_f32 v24, v24, v42
    v_mfma_f32_32x32x16_bf16 v[48:63], a[236:239], a[44:47], v[48:63]
    ds_read_b64_tr_b16 a[124:125], v17 offset:3072
    v_exp_f32 v44, v44
    v_add_f32 v24, v24, v43
    v_cvt_pk_bf16_f32 v41, v42, v43
    v_mfma_f32_32x32x16_bf16 v[48:63], a[240:243], a[48:51], v[48:63]
    ds_read_b64_tr_b16 a[126:127], v17 offset:7168
    v_exp_f32 v45, v45
    v_add_f32 v24, v24, v44
    v_mfma_f32_32x32x16_bf16 v[48:63], a[244:247], a[52:55], v[48:63]
    v_exp_f32 v46, v46
    v_add_f32 v24, v24, v45
    v_cvt_pk_bf16_f32 v42, v44, v45
    v_mfma_f32_32x32x16_bf16 v[48:63], a[248:251], a[56:59], v[48:63]
    v_exp_f32 v47, v47
    v_add_f32 v24, v24, v46
    v_add_f32 v24, v24, v47
    v_cvt_pk_bf16_f32 v43, v46, v47
    v_mfma_f32_32x32x16_bf16 v[48:63], a[252:255], a[60:63], v[48:63]
    s_waitcnt lgkmcnt(3)
    v_mfma_f32_32x32x16_bf16 v[64:79], a[96:99], v[32:35], v[64:79]
    v_mfma_f32_32x32x16_bf16 v[80:95], a[100:103], v[32:35], v[80:95]
    v_exp_f32 v48, v48
    v_exp_f32 v49, v49
    v_add_f32 v25, v25, v48
    v_mfma_f32_32x32x16_bf16 v[96:111], a[104:107], v[32:35], v[96:111]
    v_exp_f32 v50, v50
    v_add_f32 v25, v25, v49
    v_cvt_pk_bf16_f32 v48, v48, v49
    v_mfma_f32_32x32x16_bf16 v[112:127], a[108:111], v[32:35], v[112:127]
    s_add_u32 m0, s52, 0
    v_exp_f32 v51, v51
    v_add_f32 v25, v25, v50
    v_exp_f32 v52, v52
    v_mfma_f32_32x32x16_bf16 v[64:79], a[112:115], v[40:43], v[64:79]
    buffer_load_dwordx4 v20, s[16:19], s45 offen offset:0 nt lds
    v_add_f32 v25, v25, v51
    v_cvt_pk_bf16_f32 v49, v50, v51
    v_exp_f32 v53, v53
    v_mfma_f32_32x32x16_bf16 v[80:95], a[116:119], v[40:43], v[80:95]
    s_waitcnt lgkmcnt(0)
    v_add_f32 v25, v25, v52
    v_exp_f32 v54, v54
    v_add_f32 v25, v25, v53
    v_cvt_pk_bf16_f32 v50, v52, v53
    v_mfma_f32_32x32x16_bf16 v[96:111], a[120:123], v[40:43], v[96:111]
    buffer_load_dwordx4 v20, s[16:19], s46 offen offset:1024 nt lds
    v_exp_f32 v55, v55
    v_add_f32 v25, v25, v54
    v_mfma_f32_32x32x16_bf16 v[112:127], a[124:127], v[40:43], v[112:127]
    v_exp_f32 v56, v56
    v_add_f32 v25, v25, v55
    v_cvt_pk_bf16_f32 v51, v54, v55
    v_mfma_f32_32x32x16_bf16 v[32:47], a[224:227], a[64:67], 0
    buffer_load_dwordx4 v20, s[16:19], s47 offen offset:2048 nt lds
    v_exp_f32 v57, v57
    v_add_f32 v25, v25, v56
    v_mfma_f32_32x32x16_bf16 v[32:47], a[228:231], a[68:71], v[32:47]
    v_exp_f32 v58, v58
    v_add_f32 v25, v25, v57
    v_cvt_pk_bf16_f32 v56, v56, v57
    v_mfma_f32_32x32x16_bf16 v[32:47], a[232:235], a[72:75], v[32:47]
    buffer_load_dwordx4 v20, s[16:19], s48 offen offset:3072 nt lds
    v_xor_b32 v20, 8192, v20
    v_exp_f32 v59, v59
    v_add_f32 v25, v25, v58
    v_mfma_f32_32x32x16_bf16 v[32:47], a[236:239], a[76:79], v[32:47]
    v_exp_f32 v60, v60
    v_add_f32 v25, v25, v59
    v_cvt_pk_bf16_f32 v57, v58, v59
    v_mfma_f32_32x32x16_bf16 v[32:47], a[240:243], a[80:83], v[32:47]
    v_exp_f32 v61, v61
    v_add_f32 v25, v25, v60
    v_exp_f32 v62, v62
    v_mfma_f32_32x32x16_bf16 v[32:47], a[244:247], a[84:87], v[32:47]
    v_add_f32 v25, v25, v61
    v_cvt_pk_bf16_f32 v58, v60, v61
    v_exp_f32 v63, v63
    v_add_f32 v25, v25, v62
    v_mfma_f32_32x32x16_bf16 v[32:47], a[248:251], a[88:91], v[32:47]
    s_waitcnt vmcnt(4)
    s_barrier
    v_mfma_f32_32x32x16_bf16 v[32:47], a[252:255], a[92:95], v[32:47]
    ds_read_b128 a[128:131], v12 offset:8192
    v_add_f32 v25, v25, v63
    v_cvt_pk_bf16_f32 v59, v62, v63
    v_mfma_f32_32x32x16_bf16 v[128:143], a[96:99], v[48:51], v[128:143]
    ds_read_b128 a[132:135], v13 offset:8192
    v_mfma_f32_32x32x16_bf16 v[144:159], a[100:103], v[48:51], v[144:159]
    ds_read_b128 a[136:139], v14 offset:8192
    v_exp_f32 v32, v32
    v_exp_f32 v33, v33
    v_mfma_f32_32x32x16_bf16 v[160:175], a[104:107], v[48:51], v[160:175]
    ds_read_b128 a[140:143], v15 offset:8192
    v_add_f32 v26, v26, v32
    v_exp_f32 v34, v34
    v_add_f32 v26, v26, v33
    v_mfma_f32_32x32x16_bf16 v[176:191], a[108:111], v[48:51], v[176:191]
    ds_read_b128 a[144:147], v12 offset:9216
    v_cvt_pk_bf16_f32 v32, v32, v33
    v_exp_f32 v35, v35
    v_add_f32 v26, v26, v34
    v_mfma_f32_32x32x16_bf16 v[128:143], a[112:115], v[56:59], v[128:143]
    ds_read_b128 a[148:151], v13 offset:9216
    v_exp_f32 v36, v36
    v_add_f32 v26, v26, v35
    v_cvt_pk_bf16_f32 v33, v34, v35
    v_mfma_f32_32x32x16_bf16 v[144:159], a[116:119], v[56:59], v[144:159]
    ds_read_b128 a[152:155], v14 offset:9216
    v_exp_f32 v37, v37
    v_add_f32 v26, v26, v36
    v_mfma_f32_32x32x16_bf16 v[160:175], a[120:123], v[56:59], v[160:175]
    ds_read_b128 a[156:159], v15 offset:9216
    v_exp_f32 v38, v38
    v_add_f32 v26, v26, v37
    v_cvt_pk_bf16_f32 v34, v36, v37
    v_mfma_f32_32x32x16_bf16 v[176:191], a[124:127], v[56:59], v[176:191]
    ds_read_b64_tr_b16 a[160:161], v16 offset:8192
    s_waitcnt lgkmcnt(6)
    v_exp_f32 v39, v39
    v_add_f32 v26, v26, v38
    v_mfma_f32_32x32x16_bf16 v[48:63], a[128:131], a[0:3], 0
    ds_read_b64_tr_b16 a[162:163], v16 offset:12288
    v_exp_f32 v40, v40
    v_add_f32 v26, v26, v39
    v_cvt_pk_bf16_f32 v35, v38, v39
    v_mfma_f32_32x32x16_bf16 v[48:63], a[132:135], a[4:7], v[48:63]
    ds_read_b64_tr_b16 a[164:165], v17 offset:8192
    v_exp_f32 v41, v41
    v_add_f32 v26, v26, v40
    v_mfma_f32_32x32x16_bf16 v[48:63], a[136:139], a[8:11], v[48:63]
    s_waitcnt lgkmcnt(5)
    v_exp_f32 v42, v42
    v_add_f32 v26, v26, v41
    v_cvt_pk_bf16_f32 v40, v40, v41
    v_mfma_f32_32x32x16_bf16 v[48:63], a[140:143], a[12:15], v[48:63]
    ds_read_b64_tr_b16 a[166:167], v17 offset:12288
    v_exp_f32 v43, v43
    v_add_f32 v26, v26, v42
    v_mfma_f32_32x32x16_bf16 v[48:63], a[144:147], a[16:19], v[48:63]
    ds_read_b64_tr_b16 a[168:169], v16 offset:9216
    v_exp_f32 v44, v44
    v_add_f32 v26, v26, v43
    v_cvt_pk_bf16_f32 v41, v42, v43
    v_mfma_f32_32x32x16_bf16 v[48:63], a[148:151], a[20:23], v[48:63]
    s_waitcnt lgkmcnt(4)
    v_exp_f32 v45, v45
    v_add_f32 v26, v26, v44
    v_exp_f32 v46, v46
    v_mfma_f32_32x32x16_bf16 v[48:63], a[152:155], a[24:27], v[48:63]
    ds_read_b64_tr_b16 a[170:171], v16 offset:13312
    v_add_f32 v26, v26, v45
    v_cvt_pk_bf16_f32 v42, v44, v45
    v_exp_f32 v47, v47
    v_mfma_f32_32x32x16_bf16 v[48:63], a[156:159], a[28:31], v[48:63]
    ds_read_b64_tr_b16 a[172:173], v17 offset:9216
    v_add_f32 v26, v26, v46
    v_add_f32 v26, v26, v47
    v_cvt_pk_bf16_f32 v43, v46, v47
    v_mfma_f32_32x32x16_bf16 v[192:207], a[96:99], v[32:35], v[192:207]
    v_mfma_f32_32x32x16_bf16 v[208:223], a[100:103], v[32:35], v[208:223]
    ds_read_b64_tr_b16 a[174:175], v17 offset:13312
    v_exp_f32 v48, v48
    v_exp_f32 v49, v49
    v_mfma_f32_32x32x16_bf16 v[224:239], a[104:107], v[32:35], v[224:239]
    ds_read_b64_tr_b16 a[176:177], v16 offset:10240
    s_add_u32 m0, s52, 65536
    v_add_f32 v24, v24, v48
    v_exp_f32 v50, v50
    v_add_f32 v24, v24, v49
    v_mfma_f32_32x32x16_bf16 v[240:255], a[108:111], v[32:35], v[240:255]
    buffer_load_dwordx4 v21, s[20:23], s45 offen offset:0 nt lds
    v_cvt_pk_bf16_f32 v48, v48, v49
    v_exp_f32 v51, v51
    v_add_f32 v24, v24, v50
    v_mfma_f32_32x32x16_bf16 v[192:207], a[112:115], v[40:43], v[192:207]
    ds_read_b64_tr_b16 a[178:179], v16 offset:14336
    v_exp_f32 v52, v52
    v_add_f32 v24, v24, v51
    v_cvt_pk_bf16_f32 v49, v50, v51
    v_mfma_f32_32x32x16_bf16 v[208:223], a[116:119], v[40:43], v[208:223]
    buffer_load_dwordx4 v21, s[20:23], s46 offen offset:1024 nt lds
    v_exp_f32 v53, v53
    v_add_f32 v24, v24, v52
    v_mfma_f32_32x32x16_bf16 v[224:239], a[120:123], v[40:43], v[224:239]
    ds_read_b64_tr_b16 a[180:181], v17 offset:10240
    v_exp_f32 v54, v54
    v_add_f32 v24, v24, v53
    v_cvt_pk_bf16_f32 v50, v52, v53
    v_mfma_f32_32x32x16_bf16 v[240:255], a[124:127], v[40:43], v[240:255]
    buffer_load_dwordx4 v21, s[20:23], s47 offen offset:2048 nt lds
    v_exp_f32 v55, v55
    v_add_f32 v24, v24, v54
    v_mfma_f32_32x32x16_bf16 v[32:47], a[128:131], a[32:35], 0
    ds_read_b64_tr_b16 a[182:183], v17 offset:14336
    v_exp_f32 v56, v56
    v_add_f32 v24, v24, v55
    v_cvt_pk_bf16_f32 v51, v54, v55
    v_mfma_f32_32x32x16_bf16 v[32:47], a[132:135], a[36:39], v[32:47]
    buffer_load_dwordx4 v21, s[20:23], s48 offen offset:3072 nt lds
    v_xor_b32 v21, 8192, v21
    v_exp_f32 v57, v57
    v_add_f32 v24, v24, v56
    v_mfma_f32_32x32x16_bf16 v[32:47], a[136:139], a[40:43], v[32:47]
    ds_read_b64_tr_b16 a[184:185], v16 offset:11264
    v_exp_f32 v58, v58
    v_add_f32 v24, v24, v57
    v_cvt_pk_bf16_f32 v56, v56, v57
    v_mfma_f32_32x32x16_bf16 v[32:47], a[140:143], a[44:47], v[32:47]
    ds_read_b64_tr_b16 a[186:187], v16 offset:15360
    v_exp_f32 v59, v59
    v_add_f32 v24, v24, v58
    v_mfma_f32_32x32x16_bf16 v[32:47], a[144:147], a[48:51], v[32:47]
    ds_read_b64_tr_b16 a[188:189], v17 offset:11264
    v_exp_f32 v60, v60
    v_add_f32 v24, v24, v59
    v_cvt_pk_bf16_f32 v57, v58, v59
    v_mfma_f32_32x32x16_bf16 v[32:47], a[148:151], a[52:55], v[32:47]
    ds_read_b64_tr_b16 a[190:191], v17 offset:15360
    v_exp_f32 v61, v61
    v_add_f32 v24, v24, v60
    v_mfma_f32_32x32x16_bf16 v[32:47], a[152:155], a[56:59], v[32:47]
    v_exp_f32 v62, v62
    v_add_f32 v24, v24, v61
    v_cvt_pk_bf16_f32 v58, v60, v61
    v_mfma_f32_32x32x16_bf16 v[32:47], a[156:159], a[60:63], v[32:47]
    s_waitcnt lgkmcnt(4)
    v_exp_f32 v63, v63
    v_add_f32 v24, v24, v62
    v_add_f32 v24, v24, v63
    v_cvt_pk_bf16_f32 v59, v62, v63
    v_mfma_f32_32x32x16_bf16 v[64:79], a[160:163], v[48:51], v[64:79]
    v_mfma_f32_32x32x16_bf16 v[80:95], a[164:167], v[48:51], v[80:95]
    v_exp_f32 v32, v32
    v_exp_f32 v33, v33
    v_add_f32 v25, v25, v32
    v_mfma_f32_32x32x16_bf16 v[96:111], a[168:171], v[48:51], v[96:111]
    v_exp_f32 v34, v34
    v_add_f32 v25, v25, v33
    v_cvt_pk_bf16_f32 v32, v32, v33
    v_mfma_f32_32x32x16_bf16 v[112:127], a[172:175], v[48:51], v[112:127]
    v_exp_f32 v35, v35
    v_add_f32 v25, v25, v34
    v_exp_f32 v36, v36
    v_mfma_f32_32x32x16_bf16 v[64:79], a[176:179], v[56:59], v[64:79]
    v_add_f32 v25, v25, v35
    v_cvt_pk_bf16_f32 v33, v34, v35
    v_exp_f32 v37, v37
    v_add_f32 v25, v25, v36
    v_mfma_f32_32x32x16_bf16 v[80:95], a[180:183], v[56:59], v[80:95]
    s_waitcnt lgkmcnt(0)
    v_exp_f32 v38, v38
    v_add_f32 v25, v25, v37
    v_cvt_pk_bf16_f32 v34, v36, v37
    v_mfma_f32_32x32x16_bf16 v[96:111], a[184:187], v[56:59], v[96:111]
    v_exp_f32 v39, v39
    v_add_f32 v25, v25, v38
    v_exp_f32 v40, v40
    v_mfma_f32_32x32x16_bf16 v[112:127], a[188:191], v[56:59], v[112:127]
    v_add_f32 v25, v25, v39
    v_cvt_pk_bf16_f32 v35, v38, v39
    v_exp_f32 v41, v41
    v_add_f32 v25, v25, v40
    v_mfma_f32_32x32x16_bf16 v[48:63], a[128:131], a[64:67], 0
    v_exp_f32 v42, v42
    v_add_f32 v25, v25, v41
    v_cvt_pk_bf16_f32 v40, v40, v41
    v_mfma_f32_32x32x16_bf16 v[48:63], a[132:135], a[68:71], v[48:63]
    v_exp_f32 v43, v43
    v_add_f32 v25, v25, v42
    v_exp_f32 v44, v44
    v_mfma_f32_32x32x16_bf16 v[48:63], a[136:139], a[72:75], v[48:63]
    v_add_f32 v25, v25, v43
    v_cvt_pk_bf16_f32 v41, v42, v43
    v_exp_f32 v45, v45
    v_add_f32 v25, v25, v44
    v_mfma_f32_32x32x16_bf16 v[48:63], a[140:143], a[76:79], v[48:63]
    v_exp_f32 v46, v46
    v_add_f32 v25, v25, v45
    v_cvt_pk_bf16_f32 v42, v44, v45
    v_mfma_f32_32x32x16_bf16 v[48:63], a[144:147], a[80:83], v[48:63]
    v_exp_f32 v47, v47
    v_add_f32 v25, v25, v46
    v_add_f32 v25, v25, v47
    v_cvt_pk_bf16_f32 v43, v46, v47
    v_mfma_f32_32x32x16_bf16 v[48:63], a[148:151], a[84:87], v[48:63]
    global_load_dword v29, v28, s[36:37] sc1
    v_mfma_f32_32x32x16_bf16 v[48:63], a[152:155], a[88:91], v[48:63]
    s_waitcnt vmcnt(5)
    s_barrier
    v_mfma_f32_32x32x16_bf16 v[48:63], a[156:159], a[92:95], v[48:63]
    ds_read_b128 a[192:195], v12 offset:0
    v_mfma_f32_32x32x16_bf16 v[128:143], a[160:163], v[32:35], v[128:143]
    ds_read_b128 a[196:199], v13 offset:0
    v_mfma_f32_32x32x16_bf16 v[144:159], a[164:167], v[32:35], v[144:159]
    ds_read_b128 a[200:203], v14 offset:0
    s_add_u32 m0, s52, 49152
    v_exp_f32 v48, v48
    v_exp_f32 v49, v49
    v_mfma_f32_32x32x16_bf16 v[160:175], a[168:171], v[32:35], v[160:175]
    buffer_load_dwordx4 v20, s[16:19], s45 offen offset:0 nt lds
    ds_read_b128 a[204:207], v15 offset:0
    v_add_f32 v26, v26, v48
    v_mfma_f32_32x32x16_bf16 v[176:191], a[172:175], v[32:35], v[176:191]
    ds_read_b128 a[208:211], v12 offset:1024
    v_exp_f32 v50, v50
    v_add_f32 v26, v26, v49
    v_cvt_pk_bf16_f32 v48, v48, v49
    v_mfma_f32_32x32x16_bf16 v[128:143], a[176:179], v[40:43], v[128:143]
    buffer_load_dwordx4 v20, s[16:19], s46 offen offset:1024 nt lds
    ds_read_b128 a[212:215], v13 offset:1024
    v_exp_f32 v51, v51
    v_mfma_f32_32x32x16_bf16 v[144:159], a[180:183], v[40:43], v[144:159]
    ds_read_b128 a[216:219], v14 offset:1024
    v_add_f32 v26, v26, v50
    v_exp_f32 v52, v52
    v_add_f32 v26, v26, v51
    v_mfma_f32_32x32x16_bf16 v[160:175], a[184:187], v[40:43], v[160:175]
    buffer_load_dwordx4 v20, s[16:19], s47 offen offset:2048 nt lds
    ds_read_b128 a[220:223], v15 offset:1024
    v_cvt_pk_bf16_f32 v49, v50, v51
    v_mfma_f32_32x32x16_bf16 v[176:191], a[188:191], v[40:43], v[176:191]
    s_waitcnt lgkmcnt(5)
    v_exp_f32 v53, v53
    v_add_f32 v26, v26, v52
    v_exp_f32 v54, v54
    v_mfma_f32_32x32x16_bf16 v[32:47], a[192:195], a[0:3], 0
    buffer_load_dwordx4 v20, s[16:19], s48 offen offset:3072 nt lds
    v_xor_b32 v20, 122880, v20
    v_add_f32 v26, v26, v53
    v_cvt_pk_bf16_f32 v50, v52, v53
    v_mfma_f32_32x32x16_bf16 v[32:47], a[196:199], a[4:7], v[32:47]
    v_exp_f32 v55, v55
    v_add_f32 v26, v26, v54
    v_exp_f32 v56, v56
    v_mfma_f32_32x32x16_bf16 v[32:47], a[200:203], a[8:11], v[32:47]
    s_waitcnt lgkmcnt(2)
    v_add_f32 v26, v26, v55
    v_cvt_pk_bf16_f32 v51, v54, v55
    v_exp_f32 v57, v57
    v_add_f32 v26, v26, v56
    v_mfma_f32_32x32x16_bf16 v[32:47], a[204:207], a[12:15], v[32:47]
    v_exp_f32 v58, v58
    v_add_f32 v26, v26, v57
    v_cvt_pk_bf16_f32 v56, v56, v57
    v_mfma_f32_32x32x16_bf16 v[32:47], a[208:211], a[16:19], v[32:47]
    v_exp_f32 v59, v59
    v_add_f32 v26, v26, v58
    v_exp_f32 v60, v60
    v_mfma_f32_32x32x16_bf16 v[32:47], a[212:215], a[20:23], v[32:47]
    s_waitcnt lgkmcnt(0)
    v_add_f32 v26, v26, v59
    v_cvt_pk_bf16_f32 v57, v58, v59
    v_exp_f32 v61, v61
    v_add_f32 v26, v26, v60
    v_mfma_f32_32x32x16_bf16 v[32:47], a[216:219], a[24:27], v[32:47]
    v_exp_f32 v62, v62
    v_add_f32 v26, v26, v61
    v_cvt_pk_bf16_f32 v58, v60, v61
    v_mfma_f32_32x32x16_bf16 v[32:47], a[220:223], a[28:31], v[32:47]
    v_exp_f32 v63, v63
    v_add_f32 v26, v26, v62
    v_add_f32 v26, v26, v63
    v_cvt_pk_bf16_f32 v59, v62, v63
    v_mfma_f32_32x32x16_bf16 v[192:207], a[160:163], v[48:51], v[192:207]
    s_waitcnt vmcnt(5)
    s_barrier
    v_mfma_f32_32x32x16_bf16 v[208:223], a[164:167], v[48:51], v[208:223]
    ds_read_b64_tr_b16 a[224:225], v16 offset:49152
    ds_read_b64_tr_b16 a[226:227], v16 offset:53248
    v_exp_f32 v32, v32
    v_mfma_f32_32x32x16_bf16 v[224:239], a[168:171], v[48:51], v[224:239]
    ds_read_b64_tr_b16 a[228:229], v17 offset:49152
    v_exp_f32 v33, v33
    v_add_f32 v24, v24, v32
    v_mfma_f32_32x32x16_bf16 v[240:255], a[172:175], v[48:51], v[240:255]
    ds_read_b64_tr_b16 a[230:231], v17 offset:53248
    v_exp_f32 v34, v34
    v_add_f32 v24, v24, v33
    v_cvt_pk_bf16_f32 v32, v32, v33
    v_mfma_f32_32x32x16_bf16 v[192:207], a[176:179], v[56:59], v[192:207]
    ds_read_b64_tr_b16 a[232:233], v16 offset:50176
    v_exp_f32 v35, v35
    v_add_f32 v24, v24, v34
    v_mfma_f32_32x32x16_bf16 v[208:223], a[180:183], v[56:59], v[208:223]
    ds_read_b64_tr_b16 a[234:235], v16 offset:54272
    v_exp_f32 v36, v36
    v_add_f32 v24, v24, v35
    v_cvt_pk_bf16_f32 v33, v34, v35
    v_mfma_f32_32x32x16_bf16 v[224:239], a[184:187], v[56:59], v[224:239]
    ds_read_b64_tr_b16 a[236:237], v17 offset:50176
    v_exp_f32 v37, v37
    v_add_f32 v24, v24, v36
    v_mfma_f32_32x32x16_bf16 v[240:255], a[188:191], v[56:59], v[240:255]
    ds_read_b64_tr_b16 a[238:239], v17 offset:54272
    v_exp_f32 v38, v38
    v_add_f32 v24, v24, v37
    v_cvt_pk_bf16_f32 v34, v36, v37
    v_mfma_f32_32x32x16_bf16 v[48:63], a[192:195], a[32:35], 0
    ds_read_b64_tr_b16 a[240:241], v16 offset:51200
    v_exp_f32 v39, v39
    v_add_f32 v24, v24, v38
    v_mfma_f32_32x32x16_bf16 v[48:63], a[196:199], a[36:39], v[48:63]
    ds_read_b64_tr_b16 a[242:243], v16 offset:55296
    v_exp_f32 v40, v40
    v_add_f32 v24, v24, v39
    v_cvt_pk_bf16_f32 v35, v38, v39
    v_mfma_f32_32x32x16_bf16 v[48:63], a[200:203], a[40:43], v[48:63]
    ds_read_b64_tr_b16 a[244:245], v17 offset:51200
    v_exp_f32 v41, v41
    v_add_f32 v24, v24, v40
    v_mfma_f32_32x32x16_bf16 v[48:63], a[204:207], a[44:47], v[48:63]
    ds_read_b64_tr_b16 a[246:247], v17 offset:55296
    v_exp_f32 v42, v42
    v_add_f32 v24, v24, v41
    v_cvt_pk_bf16_f32 v40, v40, v41
    v_mfma_f32_32x32x16_bf16 v[48:63], a[208:211], a[48:51], v[48:63]
    ds_read_b64_tr_b16 a[248:249], v16 offset:52224
    v_exp_f32 v43, v43
    v_add_f32 v24, v24, v42
    v_mfma_f32_32x32x16_bf16 v[48:63], a[212:215], a[52:55], v[48:63]
    ds_read_b64_tr_b16 a[250:251], v16 offset:56320
    v_exp_f32 v44, v44
    v_add_f32 v24, v24, v43
    v_cvt_pk_bf16_f32 v41, v42, v43
    v_mfma_f32_32x32x16_bf16 v[48:63], a[216:219], a[56:59], v[48:63]
    ds_read_b64_tr_b16 a[252:253], v17 offset:52224
    v_exp_f32 v45, v45
    v_add_f32 v24, v24, v44
    v_mfma_f32_32x32x16_bf16 v[48:63], a[220:223], a[60:63], v[48:63]
    ds_read_b64_tr_b16 a[254:255], v17 offset:56320
    s_waitcnt lgkmcnt(6)
    v_exp_f32 v46, v46
    v_add_f32 v24, v24, v45
    v_cvt_pk_bf16_f32 v42, v44, v45
    v_mfma_f32_32x32x16_bf16 v[64:79], a[224:227], v[32:35], v[64:79]
    v_exp_f32 v47, v47
    v_add_f32 v24, v24, v46
    v_add_f32 v24, v24, v47
    v_cvt_pk_bf16_f32 v43, v46, v47
    v_mfma_f32_32x32x16_bf16 v[80:95], a[228:231], v[32:35], v[80:95]
    s_add_u32 m0, s52, 73728
    v_exp_f32 v48, v48
    v_exp_f32 v49, v49
    v_add_f32 v25, v25, v48
    v_mfma_f32_32x32x16_bf16 v[96:111], a[232:235], v[32:35], v[96:111]
    buffer_load_dwordx4 v21, s[20:23], s45 offen offset:0 nt lds
    v_exp_f32 v50, v50
    v_add_f32 v25, v25, v49
    v_cvt_pk_bf16_f32 v48, v48, v49
    v_mfma_f32_32x32x16_bf16 v[112:127], a[236:239], v[32:35], v[112:127]
    v_exp_f32 v51, v51
    v_add_f32 v25, v25, v50
    v_exp_f32 v52, v52
    v_mfma_f32_32x32x16_bf16 v[64:79], a[240:243], v[40:43], v[64:79]
    buffer_load_dwordx4 v21, s[20:23], s46 offen offset:1024 nt lds
    s_waitcnt lgkmcnt(1)
    v_add_f32 v25, v25, v51
    v_cvt_pk_bf16_f32 v49, v50, v51
    v_exp_f32 v53, v53
    v_mfma_f32_32x32x16_bf16 v[80:95], a[244:247], v[40:43], v[80:95]
    v_add_f32 v25, v25, v52
    v_exp_f32 v54, v54
    v_add_f32 v25, v25, v53
    v_cvt_pk_bf16_f32 v50, v52, v53
    v_mfma_f32_32x32x16_bf16 v[96:111], a[248:251], v[40:43], v[96:111]
    buffer_load_dwordx4 v21, s[20:23], s47 offen offset:2048 nt lds
    s_waitcnt lgkmcnt(0)
    v_exp_f32 v55, v55
    v_add_f32 v25, v25, v54
    v_mfma_f32_32x32x16_bf16 v[112:127], a[252:255], v[40:43], v[112:127]
    v_exp_f32 v56, v56
    v_add_f32 v25, v25, v55
    v_cvt_pk_bf16_f32 v51, v54, v55
    v_mfma_f32_32x32x16_bf16 v[32:47], a[192:195], a[64:67], 0
    buffer_load_dwordx4 v21, s[20:23], s48 offen offset:3072 nt lds
    v_xor_b32 v21, 122880, v21
    v_exp_f32 v57, v57
    v_add_f32 v25, v25, v56
    v_mfma_f32_32x32x16_bf16 v[32:47], a[196:199], a[68:71], v[32:47]
    v_exp_f32 v58, v58
    v_add_f32 v25, v25, v57
    v_cvt_pk_bf16_f32 v56, v56, v57
    v_mfma_f32_32x32x16_bf16 v[32:47], a[200:203], a[72:75], v[32:47]
    buffer_load_dword v31, v27, s[24:27], 0 offen
    v_exp_f32 v59, v59
    v_add_f32 v25, v25, v58
    v_mfma_f32_32x32x16_bf16 v[32:47], a[204:207], a[76:79], v[32:47]
    v_exp_f32 v60, v60
    v_add_f32 v25, v25, v59
    v_cvt_pk_bf16_f32 v57, v58, v59
    v_mfma_f32_32x32x16_bf16 v[32:47], a[208:211], a[80:83], v[32:47]
    v_exp_f32 v61, v61
    v_add_f32 v25, v25, v60
    v_exp_f32 v62, v62
    v_bfe_u32 v1, v0, 4, 1
    v_mfma_f32_32x32x16_bf16 v[32:47], a[212:215], a[84:87], v[32:47]
    v_add_f32 v25, v25, v61
    v_cvt_pk_bf16_f32 v58, v60, v61
    v_exp_f32 v63, v63
    v_add_f32 v25, v25, v62
    v_mfma_f32_32x32x16_bf16 v[32:47], a[216:219], a[88:91], v[32:47]
    s_waitcnt vmcnt(5)
    s_barrier
    v_mfma_f32_32x32x16_bf16 v[32:47], a[220:223], a[92:95], v[32:47]
    ds_read_b128 a[96:99], v12 offset:49152
    v_add_f32 v25, v25, v63
    v_cvt_pk_bf16_f32 v59, v62, v63
    v_bfe_u32 v2, v0, 2, 2
    v_mfma_f32_32x32x16_bf16 v[128:143], a[224:227], v[48:51], v[128:143]
    ds_read_b128 a[100:103], v13 offset:49152
    v_mfma_f32_32x32x16_bf16 v[144:159], a[228:231], v[48:51], v[144:159]
    ds_read_b128 a[104:107], v14 offset:49152
    v_exp_f32 v32, v32
    v_exp_f32 v33, v33
    v_lshrrev_b32 v3, 5, v0
    v_mfma_f32_32x32x16_bf16 v[160:175], a[232:235], v[48:51], v[160:175]
    ds_read_b128 a[108:111], v15 offset:49152
    v_add_f32 v26, v26, v32
    v_exp_f32 v34, v34
    v_add_f32 v26, v26, v33
    v_mfma_f32_32x32x16_bf16 v[176:191], a[236:239], v[48:51], v[176:191]
    ds_read_b128 a[112:115], v12 offset:50176
    v_cvt_pk_bf16_f32 v32, v32, v33
    v_exp_f32 v35, v35
    v_add_f32 v26, v26, v34
    v_mfma_f32_32x32x16_bf16 v[128:143], a[240:243], v[56:59], v[128:143]
    ds_read_b128 a[116:119], v13 offset:50176
    v_exp_f32 v36, v36
    v_add_f32 v26, v26, v35
    v_cvt_pk_bf16_f32 v33, v34, v35
    v_lshl_add_u32 v3, v3, 2, v2
    v_mfma_f32_32x32x16_bf16 v[144:159], a[244:247], v[56:59], v[144:159]
    ds_read_b128 a[120:123], v14 offset:50176
    v_exp_f32 v37, v37
    v_add_f32 v26, v26, v36
    v_mfma_f32_32x32x16_bf16 v[160:175], a[248:251], v[56:59], v[160:175]
    s_add_u32 m0, s54, 16384
    ds_read_b128 a[124:127], v15 offset:50176
    buffer_load_dwordx4 v18, s[24:27], 0 offen offset:0 lds
    v_exp_f32 v38, v38
    v_mfma_f32_32x32x16_bf16 v[176:191], a[252:255], v[56:59], v[176:191]
    s_waitcnt lgkmcnt(5)
    v_add_f32 v26, v26, v37
    v_cvt_pk_bf16_f32 v34, v36, v37
    v_exp_f32 v39, v39
    v_add_f32 v26, v26, v38
    v_lshlrev_b32 v3, 7, v3
    v_mfma_f32_32x32x16_bf16 v[48:63], a[96:99], a[0:3], 0
    buffer_load_dwordx4 v18, s[24:27], s49 offen offset:1024 lds
    v_exp_f32 v40, v40
    v_add_f32 v26, v26, v39
    v_cvt_pk_bf16_f32 v35, v38, v39
    v_mfma_f32_32x32x16_bf16 v[48:63], a[100:103], a[4:7], v[48:63]
    v_exp_f32 v41, v41
    v_add_f32 v26, v26, v40
    v_exp_f32 v42, v42
    v_mfma_f32_32x32x16_bf16 v[48:63], a[104:107], a[8:11], v[48:63]
    buffer_load_dwordx4 v18, s[24:27], s50 offen offset:2048 lds
    s_waitcnt lgkmcnt(2)
    v_add_f32 v26, v26, v41
    v_cvt_pk_bf16_f32 v40, v40, v41
    v_exp_f32 v43, v43
    v_lshl_add_u32 v3, v1, 12, v3
    v_mfma_f32_32x32x16_bf16 v[48:63], a[108:111], a[12:15], v[48:63]
    v_add_f32 v26, v26, v42
    v_exp_f32 v44, v44
    v_add_f32 v26, v26, v43
    v_cvt_pk_bf16_f32 v41, v42, v43
    v_mfma_f32_32x32x16_bf16 v[48:63], a[112:115], a[16:19], v[48:63]
    buffer_load_dwordx4 v18, s[24:27], s51 offen offset:3072 lds
    v_add_u32 v18, 32768, v18
    v_exp_f32 v45, v45
    v_add_f32 v26, v26, v44
    v_mfma_f32_32x32x16_bf16 v[48:63], a[116:119], a[20:23], v[48:63]
    s_add_u32 m0, s54, 24576
    s_waitcnt lgkmcnt(0)
    v_exp_f32 v46, v46
    v_add_f32 v26, v26, v45
    v_cvt_pk_bf16_f32 v42, v44, v45
    v_lshrrev_b32 v2, 1, v2
    v_mfma_f32_32x32x16_bf16 v[48:63], a[120:123], a[24:27], v[48:63]
    buffer_load_dwordx4 v18, s[24:27], 0 offen offset:0 lds
    v_exp_f32 v47, v47
    v_add_f32 v26, v26, v46
    v_add_f32 v26, v26, v47
    v_mfma_f32_32x32x16_bf16 v[48:63], a[124:127], a[28:31], v[48:63]
    v_cvt_pk_bf16_f32 v43, v46, v47
    v_lshl_add_u32 v2, v1, 1, v2
    v_mfma_f32_32x32x16_bf16 v[192:207], a[224:227], v[32:35], v[192:207]
    s_waitcnt vmcnt(6)
    s_barrier
    v_mfma_f32_32x32x16_bf16 v[208:223], a[228:231], v[32:35], v[208:223]
    ds_read_b64_tr_b16 a[128:129], v16 offset:57344
    ds_read_b64_tr_b16 a[130:131], v16 offset:61440
    v_exp_f32 v48, v48
    v_mfma_f32_32x32x16_bf16 v[224:239], a[232:235], v[32:35], v[224:239]
    ds_read_b64_tr_b16 a[132:133], v17 offset:57344
    buffer_load_dwordx4 v18, s[24:27], s49 offen offset:1024 lds
    s_lshl_b32 s74, s7, 1
    v_exp_f32 v49, v49
    v_add_f32 v24, v24, v48
    v_mfma_f32_32x32x16_bf16 v[240:255], a[236:239], v[32:35], v[240:255]
    ds_read_b64_tr_b16 a[134:135], v17 offset:61440
    v_exp_f32 v50, v50
    v_add_f32 v24, v24, v49
    v_cvt_pk_bf16_f32 v48, v48, v49
    v_mfma_f32_32x32x16_bf16 v[192:207], a[240:243], v[40:43], v[192:207]
    ds_read_b64_tr_b16 a[136:137], v16 offset:58368
    buffer_load_dwordx4 v18, s[24:27], s50 offen offset:2048 lds
    v_exp_f32 v51, v51
    v_add_f32 v24, v24, v50
    v_mfma_f32_32x32x16_bf16 v[208:223], a[244:247], v[40:43], v[208:223]
    ds_read_b64_tr_b16 a[138:139], v16 offset:62464
    v_exp_f32 v52, v52
    v_add_f32 v24, v24, v51
    v_cvt_pk_bf16_f32 v49, v50, v51
    v_xor_b32 v2, s74, v2
    v_mfma_f32_32x32x16_bf16 v[224:239], a[248:251], v[40:43], v[224:239]
    ds_read_b64_tr_b16 a[140:141], v17 offset:58368
    buffer_load_dwordx4 v18, s[24:27], s51 offen offset:3072 lds
    v_add_u32 v18, 32768, v18
    v_exp_f32 v53, v53
    v_mfma_f32_32x32x16_bf16 v[240:255], a[252:255], v[40:43], v[240:255]
    ds_read_b64_tr_b16 a[142:143], v17 offset:62464
    v_add_f32 v24, v24, v52
    v_exp_f32 v54, v54
    v_add_f32 v24, v24, v53
    v_cvt_pk_bf16_f32 v50, v52, v53
    v_mfma_f32_32x32x16_bf16 v[32:47], a[96:99], a[32:35], 0
    s_add_u32 m0, s54, 65536
    ds_read_b64_tr_b16 a[144:145], v16 offset:59392
    buffer_load_dwordx4 v18, s[24:27], 0 offen offset:0 lds
    v_exp_f32 v55, v55
    v_add_f32 v24, v24, v54
    v_mfma_f32_32x32x16_bf16 v[32:47], a[100:103], a[36:39], v[32:47]
    ds_read_b64_tr_b16 a[146:147], v16 offset:63488
    v_exp_f32 v56, v56
    v_add_f32 v24, v24, v55
    v_cvt_pk_bf16_f32 v51, v54, v55
    v_lshl_add_u32 v3, v2, 5, v3
    v_mfma_f32_32x32x16_bf16 v[32:47], a[104:107], a[40:43], v[32:47]
    ds_read_b64_tr_b16 a[148:149], v17 offset:59392
    buffer_load_dwordx4 v18, s[24:27], s49 offen offset:1024 lds
    v_exp_f32 v57, v57
    v_add_f32 v24, v24, v56
    v_mfma_f32_32x32x16_bf16 v[32:47], a[108:111], a[44:47], v[32:47]
    ds_read_b64_tr_b16 a[150:151], v17 offset:63488
    v_exp_f32 v58, v58
    v_add_f32 v24, v24, v57
    v_cvt_pk_bf16_f32 v56, v56, v57
    v_and_b32 v2, 3, v0
    v_mfma_f32_32x32x16_bf16 v[32:47], a[112:115], a[48:51], v[32:47]
    ds_read_b64_tr_b16 a[152:153], v16 offset:60416
    buffer_load_dwordx4 v18, s[24:27], s50 offen offset:2048 lds
    v_exp_f32 v59, v59
    v_add_f32 v24, v24, v58
    v_mfma_f32_32x32x16_bf16 v[32:47], a[116:119], a[52:55], v[32:47]
    ds_read_b64_tr_b16 a[154:155], v16 offset:64512
    v_exp_f32 v60, v60
    v_add_f32 v24, v24, v59
    v_cvt_pk_bf16_f32 v57, v58, v59
    v_mfma_f32_32x32x16_bf16 v[32:47], a[120:123], a[56:59], v[32:47]
    ds_read_b64_tr_b16 a[156:157], v17 offset:60416
    buffer_load_dwordx4 v18, s[24:27], s51 offen offset:3072 lds
    v_add_u32 v18, 32768, v18
    v_exp_f32 v61, v61
    v_mfma_f32_32x32x16_bf16 v[32:47], a[124:127], a[60:63], v[32:47]
    ds_read_b64_tr_b16 a[158:159], v17 offset:64512
    s_add_u32 m0, s54, 57344
    s_waitcnt lgkmcnt(6)
    v_add_f32 v24, v24, v60
    v_exp_f32 v62, v62
    v_add_f32 v24, v24, v61
    v_cvt_pk_bf16_f32 v58, v60, v61
    v_mfma_f32_32x32x16_bf16 v[64:79], a[128:131], v[48:51], v[64:79]
    buffer_load_dwordx4 v18, s[24:27], 0 offen offset:0 lds
    v_exp_f32 v63, v63
    v_add_f32 v24, v24, v62
    v_add_f32 v24, v24, v63
    v_cvt_pk_bf16_f32 v59, v62, v63
    v_mfma_f32_32x32x16_bf16 v[80:95], a[132:135], v[48:51], v[80:95]
    s_mul_i32 s74, s7, 81920
    v_exp_f32 v32, v32
    v_exp_f32 v33, v33
    v_add_f32 v25, v25, v32
    v_lshl_add_u32 v3, v2, 3, v3
    v_mfma_f32_32x32x16_bf16 v[96:111], a[136:139], v[48:51], v[96:111]
    buffer_load_dwordx4 v18, s[24:27], s49 offen offset:1024 lds
    v_exp_f32 v34, v34
    v_add_f32 v25, v25, v33
    v_cvt_pk_bf16_f32 v32, v32, v33
    v_mfma_f32_32x32x16_bf16 v[112:127], a[140:143], v[48:51], v[112:127]
    s_add_u32 s75, s74, 16384
    v_exp_f32 v35, v35
    v_add_f32 v25, v25, v34
    v_exp_f32 v36, v36
    v_mfma_f32_32x32x16_bf16 v[64:79], a[144:147], v[56:59], v[64:79]
    buffer_load_dwordx4 v18, s[24:27], s50 offen offset:2048 lds
    s_waitcnt lgkmcnt(1)
    v_add_f32 v25, v25, v35
    v_cvt_pk_bf16_f32 v33, v34, v35
    v_exp_f32 v37, v37
    v_mfma_f32_32x32x16_bf16 v[80:95], a[148:151], v[56:59], v[80:95]
    v_add_f32 v25, v25, v36
    v_exp_f32 v38, v38
    v_add_f32 v25, v25, v37
    v_cvt_pk_bf16_f32 v34, v36, v37
    v_mfma_f32_32x32x16_bf16 v[96:111], a[152:155], v[56:59], v[96:111]
    buffer_load_dwordx4 v18, s[24:27], s51 offen offset:3072 lds
    s_waitcnt lgkmcnt(0)
    v_add_u32 v18, s60, v19
    v_exp_f32 v39, v39
    v_add_f32 v25, v25, v38
    v_add_u32 v4, s75, v3
    v_mfma_f32_32x32x16_bf16 v[112:127], a[156:159], v[56:59], v[112:127]
    s_add_u32 m0, s54, 32768
    v_exp_f32 v40, v40
    v_add_f32 v25, v25, v39
    v_cvt_pk_bf16_f32 v35, v38, v39
    v_mfma_f32_32x32x16_bf16 v[48:63], a[96:99], a[64:67], 0
    buffer_load_dwordx4 v18, s[24:27], 0 offen offset:0 lds
    v_exp_f32 v41, v41
    v_add_f32 v25, v25, v40
    v_mfma_f32_32x32x16_bf16 v[48:63], a[100:103], a[68:71], v[48:63]
    v_exp_f32 v42, v42
    v_add_f32 v25, v25, v41
    v_cvt_pk_bf16_f32 v40, v40, v41
    v_xor_b32 v5, 32, v4
    v_mfma_f32_32x32x16_bf16 v[48:63], a[104:107], a[72:75], v[48:63]
    buffer_load_dwordx4 v18, s[24:27], s49 offen offset:1024 lds
    v_exp_f32 v43, v43
    v_add_f32 v25, v25, v42
    v_mfma_f32_32x32x16_bf16 v[48:63], a[108:111], a[76:79], v[48:63]
    v_exp_f32 v44, v44
    v_add_f32 v25, v25, v43
    v_cvt_pk_bf16_f32 v41, v42, v43
    v_mfma_f32_32x32x16_bf16 v[48:63], a[112:115], a[80:83], v[48:63]
    buffer_load_dwordx4 v18, s[24:27], s50 offen offset:2048 lds
    s_sub_u32 s75, 98304, s74
    v_exp_f32 v45, v45
    v_add_f32 v25, v25, v44
    v_mfma_f32_32x32x16_bf16 v[48:63], a[116:119], a[84:87], v[48:63]
    v_exp_f32 v46, v46
    v_add_f32 v25, v25, v45
    v_cvt_pk_bf16_f32 v42, v44, v45
    v_mfma_f32_32x32x16_bf16 v[48:63], a[120:123], a[88:91], v[48:63]
    buffer_load_dwordx4 v18, s[24:27], s51 offen offset:3072 lds
    s_barrier
    v_add_u32 v18, 32768, v18
    v_mfma_f32_32x32x16_bf16 v[48:63], a[124:127], a[92:95], v[48:63]
    s_add_u32 m0, s54, 73728
    v_exp_f32 v47, v47
    v_add_f32 v25, v25, v46
    v_add_f32 v25, v25, v47
    v_cvt_pk_bf16_f32 v43, v46, v47
    v_add_u32 v6, s75, v3
    v_mfma_f32_32x32x16_bf16 v[128:143], a[128:131], v[32:35], v[128:143]
    buffer_load_dwordx4 v18, s[24:27], 0 offen offset:0 lds
    v_mfma_f32_32x32x16_bf16 v[144:159], a[132:135], v[32:35], v[144:159]
    v_exp_f32 v48, v48
    v_exp_f32 v49, v49
    v_add_f32 v26, v26, v48
    v_mfma_f32_32x32x16_bf16 v[160:175], a[136:139], v[32:35], v[160:175]
    buffer_load_dwordx4 v18, s[24:27], s49 offen offset:1024 lds
    v_exp_f32 v50, v50
    v_add_f32 v26, v26, v49
    v_cvt_pk_bf16_f32 v48, v48, v49
    v_xor_b32 v7, 32, v6
    v_mfma_f32_32x32x16_bf16 v[176:191], a[140:143], v[32:35], v[176:191]
    v_exp_f32 v51, v51
    v_add_f32 v26, v26, v50
    v_exp_f32 v52, v52
    v_add_f32 v26, v26, v51
    v_mfma_f32_32x32x16_bf16 v[128:143], a[144:147], v[40:43], v[128:143]
    buffer_load_dwordx4 v18, s[24:27], s50 offen offset:2048 lds
    v_cvt_pk_bf16_f32 v49, v50, v51
    v_exp_f32 v53, v53
    v_add_f32 v26, v26, v52
    v_mfma_f32_32x32x16_bf16 v[144:159], a[148:151], v[40:43], v[144:159]
    v_exp_f32 v54, v54
    v_add_f32 v26, v26, v53
    v_cvt_pk_bf16_f32 v50, v52, v53
    v_exp_f32 v55, v55
    v_mfma_f32_32x32x16_bf16 v[160:175], a[152:155], v[40:43], v[160:175]
    buffer_load_dwordx4 v18, s[24:27], s51 offen offset:3072 lds
    v_add_u32 v18, 32768, v18
    v_add_f32 v26, v26, v54
    v_exp_f32 v56, v56
    v_add_f32 v26, v26, v55
    v_cvt_pk_bf16_f32 v51, v54, v55
    v_mfma_f32_32x32x16_bf16 v[176:191], a[156:159], v[40:43], v[176:191]
    v_exp_f32 v57, v57
    v_add_f32 v26, v26, v56
    v_exp_f32 v58, v58
    v_add_f32 v26, v26, v57
    v_mfma_f32_32x32x16_bf16 v[192:207], a[128:131], v[48:51], v[192:207]
    v_cvt_pk_bf16_f32 v56, v56, v57
    v_exp_f32 v59, v59
    v_add_f32 v26, v26, v58
    v_exp_f32 v60, v60
    v_mfma_f32_32x32x16_bf16 v[208:223], a[132:135], v[48:51], v[208:223]
    v_add_f32 v26, v26, v59
    v_cvt_pk_bf16_f32 v57, v58, v59
    v_exp_f32 v61, v61
    v_add_f32 v26, v26, v60
    v_mfma_f32_32x32x16_bf16 v[224:239], a[136:139], v[48:51], v[224:239]
    v_exp_f32 v62, v62
    v_add_f32 v26, v26, v61
    v_cvt_pk_bf16_f32 v58, v60, v61
    v_exp_f32 v63, v63
    v_add_f32 v26, v26, v62
    v_add_f32 v26, v26, v63
    v_cvt_pk_bf16_f32 v59, v62, v63
    v_mfma_f32_32x32x16_bf16 v[240:255], a[140:143], v[48:51], v[240:255]
    v_mov_b32 v1, v24
    v_mov_b32 v2, v25
    v_mov_b32 v3, v26
    v_permlane32_swap_b32 v1, v24
    v_permlane32_swap_b32 v2, v25
    v_permlane32_swap_b32 v3, v26
    v_mfma_f32_32x32x16_bf16 v[192:207], a[144:147], v[56:59], v[192:207]
    v_add_f32 v24, v24, v1
    v_add_f32 v25, v25, v2
    v_add_f32 v26, v26, v3
    v_min3_f32 v1, v24, v25, v26
    v_max3_f32 v2, v24, v25, v26
    v_cmp_gt_f32 vcc, 0x30800000, v1
    v_mfma_f32_32x32x16_bf16 v[208:223], a[148:151], v[56:59], v[208:223]
    s_mov_b64 s[74:75], vcc
    v_cmp_lt_f32 vcc, 0x4e800000, v2
    v_mfma_f32_32x32x16_bf16 v[224:239], a[152:155], v[56:59], v[224:239]
    v_mfma_f32_32x32x16_bf16 v[240:255], a[156:159], v[56:59], v[240:255]
    s_or_b64 s[74:75], s[74:75], vcc
    s_cbranch_scc1 L_slow
L_join:
    v_rcp_f32 v24, v24
    v_rcp_f32 v25, v25
    v_rcp_f32 v26, v26
    v_pk_mul_f32 v[64:65], v[64:65], v[24:25] op_sel:[0,0] op_sel_hi:[1,0]
    v_cvt_pk_bf16_f32 v64, v64, v65
    v_pk_mul_f32 v[66:67], v[66:67], v[24:25] op_sel:[0,0] op_sel_hi:[1,0]
    v_cvt_pk_bf16_f32 v65, v66, v67
    v_pk_mul_f32 v[68:69], v[68:69], v[24:25] op_sel:[0,0] op_sel_hi:[1,0]
    v_cvt_pk_bf16_f32 v66, v68, v69
    v_pk_mul_f32 v[70:71], v[70:71], v[24:25] op_sel:[0,0] op_sel_hi:[1,0]
    v_cvt_pk_bf16_f32 v67, v70, v71
    v_pk_mul_f32 v[128:129], v[128:129], v[24:25] op_sel:[0,1] op_sel_hi:[1,1]
    v_cvt_pk_bf16_f32 v128, v128, v129
    v_pk_mul_f32 v[130:131], v[130:131], v[24:25] op_sel:[0,1] op_sel_hi:[1,1]
    v_cvt_pk_bf16_f32 v129, v130, v131
    v_pk_mul_f32 v[132:133], v[132:133], v[24:25] op_sel:[0,1] op_sel_hi:[1,1]
    v_cvt_pk_bf16_f32 v130, v132, v133
    v_pk_mul_f32 v[134:135], v[134:135], v[24:25] op_sel:[0,1] op_sel_hi:[1,1]
    v_cvt_pk_bf16_f32 v131, v134, v135
    v_pk_mul_f32 v[192:193], v[192:193], v[26:27] op_sel:[0,0] op_sel_hi:[1,0]
    v_cvt_pk_bf16_f32 v192, v192, v193
    v_pk_mul_f32 v[194:195], v[194:195], v[26:27] op_sel:[0,0] op_sel_hi:[1,0]
    v_cvt_pk_bf16_f32 v193, v194, v195
    v_pk_mul_f32 v[196:197], v[196:197], v[26:27] op_sel:[0,0] op_sel_hi:[1,0]
    v_cvt_pk_bf16_f32 v194, v196, v197
    v_pk_mul_f32 v[198:199], v[198:199], v[26:27] op_sel:[0,0] op_sel_hi:[1,0]
    v_cvt_pk_bf16_f32 v195, v198, v199
    v_pk_mul_f32 v[72:73], v[72:73], v[24:25] op_sel:[0,0] op_sel_hi:[1,0]
    v_cvt_pk_bf16_f32 v72, v72, v73
    v_pk_mul_f32 v[74:75], v[74:75], v[24:25] op_sel:[0,0] op_sel_hi:[1,0]
    v_cvt_pk_bf16_f32 v73, v74, v75
    v_pk_mul_f32 v[76:77], v[76:77], v[24:25] op_sel:[0,0] op_sel_hi:[1,0]
    v_cvt_pk_bf16_f32 v74, v76, v77
    v_pk_mul_f32 v[78:79], v[78:79], v[24:25] op_sel:[0,0] op_sel_hi:[1,0]
    v_cvt_pk_bf16_f32 v75, v78, v79
    v_pk_mul_f32 v[136:137], v[136:137], v[24:25] op_sel:[0,1] op_sel_hi:[1,1]
    v_cvt_pk_bf16_f32 v136, v136, v137
    v_pk_mul_f32 v[138:139], v[138:139], v[24:25] op_sel:[0,1] op_sel_hi:[1,1]
    v_cvt_pk_bf16_f32 v137, v138, v139
    v_pk_mul_f32 v[140:141], v[140:141], v[24:25] op_sel:[0,1] op_sel_hi:[1,1]
    v_cvt_pk_bf16_f32 v138, v140, v141
    v_pk_mul_f32 v[142:143], v[142:143], v[24:25] op_sel:[0,1] op_sel_hi:[1,1]
    v_cvt_pk_bf16_f32 v139, v142, v143
    v_pk_mul_f32 v[200:201], v[200:201], v[26:27] op_sel:[0,0] op_sel_hi:[1,0]
    v_cvt_pk_bf16_f32 v200, v200, v201
    v_pk_mul_f32 v[202:203], v[202:203], v[26:27] op_sel:[0,0] op_sel_hi:[1,0]
    v_cvt_pk_bf16_f32 v201, v202, v203
    v_pk_mul_f32 v[204:205], v[204:205], v[26:27] op_sel:[0,0] op_sel_hi:[1,0]
    v_cvt_pk_bf16_f32 v202, v204, v205
    v_pk_mul_f32 v[206:207], v[206:207], v[26:27] op_sel:[0,0] op_sel_hi:[1,0]
    v_cvt_pk_bf16_f32 v203, v206, v207
    ds_write_b128 v22, v[64:67] offset:0
    v_pk_mul_f32 v[80:81], v[80:81], v[24:25] op_sel:[0,0] op_sel_hi:[1,0]
    v_cvt_pk_bf16_f32 v80, v80, v81
    v_pk_mul_f32 v[82:83], v[82:83], v[24:25] op_sel:[0,0] op_sel_hi:[1,0]
    v_cvt_pk_bf16_f32 v81, v82, v83
    v_pk_mul_f32 v[84:85], v[84:85], v[24:25] op_sel:[0,0] op_sel_hi:[1,0]
    v_cvt_pk_bf16_f32 v82, v84, v85
    v_pk_mul_f32 v[86:87], v[86:87], v[24:25] op_sel:[0,0] op_sel_hi:[1,0]
    v_cvt_pk_bf16_f32 v83, v86, v87
    v_pk_mul_f32 v[144:145], v[144:145], v[24:25] op_sel:[0,1] op_sel_hi:[1,1]
    v_cvt_pk_bf16_f32 v144, v144, v145
    v_pk_mul_f32 v[146:147], v[146:147], v[24:25] op_sel:[0,1] op_sel_hi:[1,1]
    v_cvt_pk_bf16_f32 v145, v146, v147
    v_pk_mul_f32 v[148:149], v[148:149], v[24:25] op_sel:[0,1] op_sel_hi:[1,1]
    v_cvt_pk_bf16_f32 v146, v148, v149
    v_pk_mul_f32 v[150:151], v[150:151], v[24:25] op_sel:[0,1] op_sel_hi:[1,1]
    v_cvt_pk_bf16_f32 v147, v150, v151
    v_pk_mul_f32 v[208:209], v[208:209], v[26:27] op_sel:[0,0] op_sel_hi:[1,0]
    v_cvt_pk_bf16_f32 v208, v208, v209
    v_pk_mul_f32 v[210:211], v[210:211], v[26:27] op_sel:[0,0] op_sel_hi:[1,0]
    v_cvt_pk_bf16_f32 v209, v210, v211
    v_pk_mul_f32 v[212:213], v[212:213], v[26:27] op_sel:[0,0] op_sel_hi:[1,0]
    v_cvt_pk_bf16_f32 v210, v212, v213
    v_pk_mul_f32 v[214:215], v[214:215], v[26:27] op_sel:[0,0] op_sel_hi:[1,0]
    v_cvt_pk_bf16_f32 v211, v214, v215
    ds_write_b128 v22, v[128:131] offset:1024
    v_pk_mul_f32 v[88:89], v[88:89], v[24:25] op_sel:[0,0] op_sel_hi:[1,0]
    v_cvt_pk_bf16_f32 v88, v88, v89
    v_pk_mul_f32 v[90:91], v[90:91], v[24:25] op_sel:[0,0] op_sel_hi:[1,0]
    v_cvt_pk_bf16_f32 v89, v90, v91
    v_pk_mul_f32 v[92:93], v[92:93], v[24:25] op_sel:[0,0] op_sel_hi:[1,0]
    v_cvt_pk_bf16_f32 v90, v92, v93
    v_pk_mul_f32 v[94:95], v[94:95], v[24:25] op_sel:[0,0] op_sel_hi:[1,0]
    v_cvt_pk_bf16_f32 v91, v94, v95
    v_pk_mul_f32 v[152:153], v[152:153], v[24:25] op_sel:[0,1] op_sel_hi:[1,1]
    v_cvt_pk_bf16_f32 v152, v152, v153
    v_pk_mul_f32 v[154:155], v[154:155], v[24:25] op_sel:[0,1] op_sel_hi:[1,1]
    v_cvt_pk_bf16_f32 v153, v154, v155
    v_pk_mul_f32 v[156:157], v[156:157], v[24:25] op_sel:[0,1] op_sel_hi:[1,1]
    v_cvt_pk_bf16_f32 v154, v156, v157
    v_pk_mul_f32 v[158:159], v[158:159], v[24:25] op_sel:[0,1] op_sel_hi:[1,1]
    v_cvt_pk_bf16_f32 v155, v158, v159
    v_pk_mul_f32 v[216:217], v[216:217], v[26:27] op_sel:[0,0] op_sel_hi:[1,0]
    v_cvt_pk_bf16_f32 v216, v216, v217
    v_pk_mul_f32 v[218:219], v[218:219], v[26:27] op_sel:[0,0] op_sel_hi:[1,0]
    v_cvt_pk_bf16_f32 v217, v218, v219
    v_pk_mul_f32 v[220:221], v[220:221], v[26:27] op_sel:[0,0] op_sel_hi:[1,0]
    v_cvt_pk_bf16_f32 v218, v220, v221
    v_pk_mul_f32 v[222:223], v[222:223], v[26:27] op_sel:[0,0] op_sel_hi:[1,0]
    v_cvt_pk_bf16_f32 v219, v222, v223
    ds_write_b128 v22, v[192:195] offset:2048
    v_pk_mul_f32 v[96:97], v[96:97], v[24:25] op_sel:[0,0] op_sel_hi:[1,0]
    v_cvt_pk_bf16_f32 v96, v96, v97
    v_pk_mul_f32 v[98:99], v[98:99], v[24:25] op_sel:[0,0] op_sel_hi:[1,0]
    v_cvt_pk_bf16_f32 v97, v98, v99
    v_pk_mul_f32 v[100:101], v[100:101], v[24:25] op_sel:[0,0] op_sel_hi:[1,0]
    v_cvt_pk_bf16_f32 v98, v100, v101
    v_pk_mul_f32 v[102:103], v[102:103], v[24:25] op_sel:[0,0] op_sel_hi:[1,0]
    v_cvt_pk_bf16_f32 v99, v102, v103
    v_pk_mul_f32 v[160:161], v[160:161], v[24:25] op_sel:[0,1] op_sel_hi:[1,1]
    v_cvt_pk_bf16_f32 v160, v160, v161
    v_pk_mul_f32 v[162:163], v[162:163], v[24:25] op_sel:[0,1] op_sel_hi:[1,1]
    v_cvt_pk_bf16_f32 v161, v162, v163
    v_pk_mul_f32 v[164:165], v[164:165], v[24:25] op_sel:[0,1] op_sel_hi:[1,1]
    v_cvt_pk_bf16_f32 v162, v164, v165
    v_pk_mul_f32 v[166:167], v[166:167], v[24:25] op_sel:[0,1] op_sel_hi:[1,1]
    v_cvt_pk_bf16_f32 v163, v166, v167
    v_pk_mul_f32 v[224:225], v[224:225], v[26:27] op_sel:[0,0] op_sel_hi:[1,0]
    v_cvt_pk_bf16_f32 v224, v224, v225
    v_pk_mul_f32 v[226:227], v[226:227], v[26:27] op_sel:[0,0] op_sel_hi:[1,0]
    v_cvt_pk_bf16_f32 v225, v226, v227
    v_pk_mul_f32 v[228:229], v[228:229], v[26:27] op_sel:[0,0] op_sel_hi:[1,0]
    v_cvt_pk_bf16_f32 v226, v228, v229
    v_pk_mul_f32 v[230:231], v[230:231], v[26:27] op_sel:[0,0] op_sel_hi:[1,0]
    v_cvt_pk_bf16_f32 v227, v230, v231
    ds_write_b128 v22, v[72:75] offset:3072
    v_pk_mul_f32 v[104:105], v[104:105], v[24:25] op_sel:[0,0] op_sel_hi:[1,0]
    v_cvt_pk_bf16_f32 v104, v104, v105
    v_pk_mul_f32 v[106:107], v[106:107], v[24:25] op_sel:[0,0] op_sel_hi:[1,0]
    v_cvt_pk_bf16_f32 v105, v106, v107
    v_pk_mul_f32 v[108:109], v[108:109], v[24:25] op_sel:[0,0] op_sel_hi:[1,0]
    v_cvt_pk_bf16_f32 v106, v108, v109
    v_pk_mul_f32 v[110:111], v[110:111], v[24:25] op_sel:[0,0] op_sel_hi:[1,0]
    v_cvt_pk_bf16_f32 v107, v110, v111
    v_pk_mul_f32 v[168:169], v[168:169], v[24:25] op_sel:[0,1] op_sel_hi:[1,1]
    v_cvt_pk_bf16_f32 v168, v168, v169
    v_pk_mul_f32 v[170:171], v[170:171], v[24:25] op_sel:[0,1] op_sel_hi:[1,1]
    v_cvt_pk_bf16_f32 v169, v170, v171
    v_pk_mul_f32 v[172:173], v[172:173], v[24:25] op_sel:[0,1] op_sel_hi:[1,1]
    v_cvt_pk_bf16_f32 v170, v172, v173
    v_pk_mul_f32 v[174:175], v[174:175], v[24:25] op_sel:[0,1] op_sel_hi:[1,1]
    v_cvt_pk_bf16_f32 v171, v174, v175
    v_pk_mul_f32 v[232:233], v[232:233], v[26:27] op_sel:[0,0] op_sel_hi:[1,0]
    v_cvt_pk_bf16_f32 v232, v232, v233
    v_pk_mul_f32 v[234:235], v[234:235], v[26:27] op_sel:[0,0] op_sel_hi:[1,0]
    v_cvt_pk_bf16_f32 v233, v234, v235
    v_pk_mul_f32 v[236:237], v[236:237], v[26:27] op_sel:[0,0] op_sel_hi:[1,0]
    v_cvt_pk_bf16_f32 v234, v236, v237
    v_pk_mul_f32 v[238:239], v[238:239], v[26:27] op_sel:[0,0] op_sel_hi:[1,0]
    v_cvt_pk_bf16_f32 v235, v238, v239
    ds_write_b128 v22, v[136:139] offset:8192
    s_waitcnt vmcnt(8)
    s_barrier
    ds_read_b64_tr_b16 v[32:33], v4 offset:0
    ds_read_b64_tr_b16 v[34:35], v4 offset:1024
    ds_read_b64_tr_b16 v[36:37], v5 offset:0
    ds_read_b64_tr_b16 v[38:39], v5 offset:1024
    ds_read_b64_tr_b16 v[40:41], v4 offset:2048
    ds_read_b64_tr_b16 v[42:43], v4 offset:3072
    ds_read_b64_tr_b16 v[44:45], v5 offset:2048
    ds_read_b64_tr_b16 v[46:47], v5 offset:3072
    ds_read_b64_tr_b16 v[48:49], v4 offset:8192
    ds_read_b64_tr_b16 v[50:51], v4 offset:9216
    ds_read_b64_tr_b16 v[52:53], v5 offset:8192
    ds_read_b64_tr_b16 v[54:55], v5 offset:9216
    v_pk_mul_f32 v[112:113], v[112:113], v[24:25] op_sel:[0,0] op_sel_hi:[1,0]
    v_cvt_pk_bf16_f32 v112, v112, v113
    v_pk_mul_f32 v[114:115], v[114:115], v[24:25] op_sel:[0,0] op_sel_hi:[1,0]
    v_cvt_pk_bf16_f32 v113, v114, v115
    v_pk_mul_f32 v[116:117], v[116:117], v[24:25] op_sel:[0,0] op_sel_hi:[1,0]
    v_cvt_pk_bf16_f32 v114, v116, v117
    v_pk_mul_f32 v[118:119], v[118:119], v[24:25] op_sel:[0,0] op_sel_hi:[1,0]
    v_cvt_pk_bf16_f32 v115, v118, v119
    v_pk_mul_f32 v[176:177], v[176:177], v[24:25] op_sel:[0,1] op_sel_hi:[1,1]
    v_cvt_pk_bf16_f32 v176, v176, v177
    v_pk_mul_f32 v[178:179], v[178:179], v[24:25] op_sel:[0,1] op_sel_hi:[1,1]
    v_cvt_pk_bf16_f32 v177, v178, v179
    v_pk_mul_f32 v[180:181], v[180:181], v[24:25] op_sel:[0,1] op_sel_hi:[1,1]
    v_cvt_pk_bf16_f32 v178, v180, v181
    v_pk_mul_f32 v[182:183], v[182:183], v[24:25] op_sel:[0,1] op_sel_hi:[1,1]
    v_cvt_pk_bf16_f32 v179, v182, v183
    v_pk_mul_f32 v[240:241], v[240:241], v[26:27] op_sel:[0,0] op_sel_hi:[1,0]
    v_cvt_pk_bf16_f32 v240, v240, v241
    v_pk_mul_f32 v[242:243], v[242:243], v[26:27] op_sel:[0,0] op_sel_hi:[1,0]
    v_cvt_pk_bf16_f32 v241, v242, v243
    v_pk_mul_f32 v[244:245], v[244:245], v[26:27] op_sel:[0,0] op_sel_hi:[1,0]
    v_cvt_pk_bf16_f32 v242, v244, v245
    v_pk_mul_f32 v[246:247], v[246:247], v[26:27] op_sel:[0,0] op_sel_hi:[1,0]
    v_cvt_pk_bf16_f32 v243, v246, v247
    v_pk_mul_f32 v[120:121], v[120:121], v[24:25] op_sel:[0,0] op_sel_hi:[1,0]
    v_cvt_pk_bf16_f32 v120, v120, v121
    v_pk_mul_f32 v[122:123], v[122:123], v[24:25] op_sel:[0,0] op_sel_hi:[1,0]
    v_cvt_pk_bf16_f32 v121, v122, v123
    v_pk_mul_f32 v[124:125], v[124:125], v[24:25] op_sel:[0,0] op_sel_hi:[1,0]
    v_cvt_pk_bf16_f32 v122, v124, v125
    v_pk_mul_f32 v[126:127], v[126:127], v[24:25] op_sel:[0,0] op_sel_hi:[1,0]
    v_cvt_pk_bf16_f32 v123, v126, v127
    v_pk_mul_f32 v[184:185], v[184:185], v[24:25] op_sel:[0,1] op_sel_hi:[1,1]
    v_cvt_pk_bf16_f32 v184, v184, v185
    v_pk_mul_f32 v[186:187], v[186:187], v[24:25] op_sel:[0,1] op_sel_hi:[1,1]
    v_cvt_pk_bf16_f32 v185, v186, v187
    v_pk_mul_f32 v[188:189], v[188:189], v[24:25] op_sel:[0,1] op_sel_hi:[1,1]
    v_cvt_pk_bf16_f32 v186, v188, v189
    v_pk_mul_f32 v[190:191], v[190:191], v[24:25] op_sel:[0,1] op_sel_hi:[1,1]
    v_cvt_pk_bf16_f32 v187, v190, v191
    v_pk_mul_f32 v[248:249], v[248:249], v[26:27] op_sel:[0,0] op_sel_hi:[1,0]
    v_cvt_pk_bf16_f32 v248, v248, v249
    v_pk_mul_f32 v[250:251], v[250:251], v[26:27] op_sel:[0,0] op_sel_hi:[1,0]
    v_cvt_pk_bf16_f32 v249, v250, v251
    v_pk_mul_f32 v[252:253], v[252:253], v[26:27] op_sel:[0,0] op_sel_hi:[1,0]
    v_cvt_pk_bf16_f32 v250, v252, v253
    v_pk_mul_f32 v[254:255], v[254:255], v[26:27] op_sel:[0,0] op_sel_hi:[1,0]
    v_cvt_pk_bf16_f32 v251, v254, v255
    s_waitcnt lgkmcnt(0)
    v_mfma_f32_16x16x32_bf16 v[68:71], v[32:35], v[64:67], 0
    ds_read_b64_tr_b16 v[56:57], v4 offset:10240
    v_mfma_f32_16x16x32_bf16 v[132:135], v[32:35], v[128:131], 0
    ds_read_b64_tr_b16 v[58:59], v4 offset:11264
    v_mfma_f32_16x16x32_bf16 v[196:199], v[32:35], v[192:195], 0
    ds_write_b128 v22, v[200:203] offset:9216
    v_mfma_f32_16x16x32_bf16 v[76:79], v[36:39], v[64:67], 0
    ds_read_b64_tr_b16 v[60:61], v5 offset:10240
    v_mfma_f32_16x16x32_bf16 v[140:143], v[36:39], v[128:131], 0
    ds_read_b64_tr_b16 v[62:63], v5 offset:11264
    v_mfma_f32_16x16x32_bf16 v[204:207], v[36:39], v[192:195], 0
    ds_write_b128 v22, v[80:83] offset:10240
    v_mfma_f32_16x16x32_bf16 v[68:71], v[40:43], v[72:75], v[68:71]
    ds_read_b64_tr_b16 v[32:33], v4 offset:49152
    v_mfma_f32_16x16x32_bf16 v[132:135], v[40:43], v[136:139], v[132:135]
    ds_read_b64_tr_b16 v[34:35], v4 offset:50176
    v_mfma_f32_16x16x32_bf16 v[196:199], v[40:43], v[200:203], v[196:199]
    ds_write_b128 v22, v[144:147] offset:11264
    v_mfma_f32_16x16x32_bf16 v[76:79], v[44:47], v[72:75], v[76:79]
    ds_read_b64_tr_b16 v[36:37], v5 offset:49152
    v_mfma_f32_16x16x32_bf16 v[140:143], v[44:47], v[136:139], v[140:143]
    ds_read_b64_tr_b16 v[38:39], v5 offset:50176
    buffer_load_dword v31, v10, s[32:35], s66 offen sc1
    v_mfma_f32_16x16x32_bf16 v[204:207], v[44:47], v[200:203], v[204:207]
    s_waitcnt lgkmcnt(2)
    s_barrier
    v_mfma_f32_16x16x32_bf16 v[68:71], v[48:51], v[80:83], v[68:71]
    ds_read_b64_tr_b16 v[40:41], v4 offset:51200
    v_mfma_f32_16x16x32_bf16 v[132:135], v[48:51], v[144:147], v[132:135]
    ds_read_b64_tr_b16 v[42:43], v4 offset:52224
    v_mfma_f32_16x16x32_bf16 v[196:199], v[48:51], v[208:211], v[196:199]
    ds_write_b128 v22, v[208:211] offset:40960
    v_mfma_f32_16x16x32_bf16 v[76:79], v[52:55], v[80:83], v[76:79]
    ds_read_b64_tr_b16 v[44:45], v5 offset:51200
    v_mfma_f32_16x16x32_bf16 v[140:143], v[52:55], v[144:147], v[140:143]
    ds_read_b64_tr_b16 v[46:47], v5 offset:52224
    v_mfma_f32_16x16x32_bf16 v[204:207], v[52:55], v[208:211], v[204:207]
    ds_write_b128 v22, v[88:91] offset:41984
    v_mfma_f32_16x16x32_bf16 v[68:71], v[56:59], v[88:91], v[68:71]
    ds_read_b64_tr_b16 v[48:49], v4 offset:40960
    v_mfma_f32_16x16x32_bf16 v[132:135], v[56:59], v[152:155], v[132:135]
    ds_read_b64_tr_b16 v[50:51], v4 offset:41984
    v_mfma_f32_16x16x32_bf16 v[196:199], v[56:59], v[216:219], v[196:199]
    ds_write_b128 v22, v[152:155] offset:43008
    v_mfma_f32_16x16x32_bf16 v[76:79], v[60:63], v[88:91], v[76:79]
    ds_read_b64_tr_b16 v[52:53], v5 offset:40960
    v_mfma_f32_16x16x32_bf16 v[140:143], v[60:63], v[152:155], v[140:143]
    ds_read_b64_tr_b16 v[54:55], v5 offset:41984
    v_mfma_f32_16x16x32_bf16 v[204:207], v[60:63], v[216:219], v[204:207]
    ds_write_b128 v22, v[216:219] offset:44032
    v_mfma_f32_16x16x32_bf16 v[68:71], v[32:35], v[96:99], v[68:71]
    ds_read_b64_tr_b16 v[56:57], v4 offset:43008
    ds_read_b128 a[0:3], v23 offset:0
    ds_read_b128 a[32:35], v23 offset:1024
    ds_read_b128 a[64:67], v23 offset:2048
    ds_read_b128 a[4:7], v23 offset:3072
    ds_read_b128 a[36:39], v23 offset:8192
    ds_read_b128 a[68:71], v23 offset:9216
    ds_read_b128 a[8:11], v23 offset:10240
    ds_read_b128 a[40:43], v23 offset:11264
    v_mfma_f32_16x16x32_bf16 v[132:135], v[32:35], v[160:163], v[132:135]
    ds_read_b64_tr_b16 v[58:59], v4 offset:44032
    v_mfma_f32_16x16x32_bf16 v[196:199], v[32:35], v[224:227], v[196:199]
    ds_write_b128 v22, v[96:99] offset:49152
    s_waitcnt lgkmcnt(15)
    v_mfma_f32_16x16x32_bf16 v[76:79], v[36:39], v[96:99], v[76:79]
    ds_read_b64_tr_b16 v[60:61], v5 offset:43008
    v_mfma_f32_16x16x32_bf16 v[140:143], v[36:39], v[160:163], v[140:143]
    ds_read_b64_tr_b16 v[62:63], v5 offset:44032
    v_mfma_f32_16x16x32_bf16 v[204:207], v[36:39], v[224:227], v[204:207]
    ds_write_b128 v22, v[160:163] offset:50176
    v_mfma_f32_16x16x32_bf16 v[68:71], v[40:43], v[104:107], v[68:71]
    ds_read_b64_tr_b16 v[32:33], v6 offset:0
    v_mfma_f32_16x16x32_bf16 v[132:135], v[40:43], v[168:171], v[132:135]
    ds_read_b64_tr_b16 v[34:35], v6 offset:1024
    v_mfma_f32_16x16x32_bf16 v[196:199], v[40:43], v[232:235], v[196:199]
    ds_write_b128 v22, v[224:227] offset:51200
    v_mfma_f32_16x16x32_bf16 v[76:79], v[44:47], v[104:107], v[76:79]
    ds_read_b64_tr_b16 v[36:37], v7 offset:0
    v_mfma_f32_16x16x32_bf16 v[140:143], v[44:47], v[168:171], v[140:143]
    ds_read_b64_tr_b16 v[38:39], v7 offset:1024
    v_mfma_f32_16x16x32_bf16 v[204:207], v[44:47], v[232:235], v[204:207]
    ds_write_b128 v22, v[104:107] offset:52224
    v_mfma_f32_16x16x32_bf16 v[68:71], v[48:51], v[112:115], v[68:71]
    ds_read_b64_tr_b16 v[40:41], v6 offset:2048
    v_mfma_f32_16x16x32_bf16 v[132:135], v[48:51], v[176:179], v[132:135]
    ds_read_b64_tr_b16 v[42:43], v6 offset:3072
    v_mfma_f32_16x16x32_bf16 v[196:199], v[48:51], v[240:243], v[196:199]
    s_waitcnt lgkmcnt(2)
    s_barrier
    v_mfma_f32_16x16x32_bf16 v[76:79], v[52:55], v[112:115], v[76:79]
    ds_read_b64_tr_b16 v[44:45], v7 offset:2048
    v_mfma_f32_16x16x32_bf16 v[140:143], v[52:55], v[176:179], v[140:143]
    ds_read_b64_tr_b16 v[46:47], v7 offset:3072
    v_mfma_f32_16x16x32_bf16 v[204:207], v[52:55], v[240:243], v[204:207]
    ds_write_b128 v22, v[168:171] offset:0
    v_mfma_f32_16x16x32_bf16 v[68:71], v[56:59], v[120:123], v[68:71]
    ds_read_b64_tr_b16 v[48:49], v6 offset:8192
    v_mfma_f32_16x16x32_bf16 v[132:135], v[56:59], v[184:187], v[132:135]
    ds_read_b64_tr_b16 v[50:51], v6 offset:9216
    v_mfma_f32_16x16x32_bf16 v[196:199], v[56:59], v[248:251], v[196:199]
    ds_write_b128 v22, v[232:235] offset:1024
    v_mfma_f32_16x16x32_bf16 v[76:79], v[60:63], v[120:123], v[76:79]
    ds_read_b64_tr_b16 v[52:53], v7 offset:8192
    v_mfma_f32_16x16x32_bf16 v[140:143], v[60:63], v[184:187], v[140:143]
    ds_read_b64_tr_b16 v[54:55], v7 offset:9216
    v_mfma_f32_16x16x32_bf16 v[204:207], v[60:63], v[248:251], v[204:207]
    ds_write_b128 v22, v[112:115] offset:2048
    v_mfma_f32_16x16x32_bf16 v[68:71], v[32:35], a[0:3], v[68:71]
    ds_read_b64_tr_b16 v[56:57], v6 offset:10240
    v_mfma_f32_16x16x32_bf16 v[132:135], v[32:35], a[32:35], v[132:135]
    ds_read_b64_tr_b16 v[58:59], v6 offset:11264
    v_mfma_f32_16x16x32_bf16 v[196:199], v[32:35], a[64:67], v[196:199]
    ds_write_b128 v22, v[176:179] offset:3072
    v_mfma_f32_16x16x32_bf16 v[76:79], v[36:39], a[0:3], v[76:79]
    ds_read_b64_tr_b16 v[60:61], v7 offset:10240
    ds_read_b128 a[72:75], v23 offset:40960
    ds_read_b128 a[12:15], v23 offset:41984
    ds_read_b128 a[44:47], v23 offset:43008
    ds_read_b128 a[76:79], v23 offset:44032
    ds_read_b128 a[16:19], v23 offset:49152
    ds_read_b128 a[48:51], v23 offset:50176
    ds_read_b128 a[80:83], v23 offset:51200
    ds_read_b128 a[20:23], v23 offset:52224
    v_mfma_f32_16x16x32_bf16 v[140:143], v[36:39], a[32:35], v[140:143]
    ds_read_b64_tr_b16 v[62:63], v7 offset:11264
    v_mfma_f32_16x16x32_bf16 v[204:207], v[36:39], a[64:67], v[204:207]
    ds_write_b128 v22, v[240:243] offset:8192
    s_waitcnt lgkmcnt(15)
    v_mfma_f32_16x16x32_bf16 v[68:71], v[40:43], a[4:7], v[68:71]
    ds_read_b64_tr_b16 v[32:33], v6 offset:49152
    v_mfma_f32_16x16x32_bf16 v[132:135], v[40:43], a[36:39], v[132:135]
    ds_read_b64_tr_b16 v[34:35], v6 offset:50176
    v_mfma_f32_16x16x32_bf16 v[196:199], v[40:43], a[68:71], v[196:199]
    ds_write_b128 v22, v[120:123] offset:9216
    v_mfma_f32_16x16x32_bf16 v[76:79], v[44:47], a[4:7], v[76:79]
    ds_read_b64_tr_b16 v[36:37], v7 offset:49152
    v_mfma_f32_16x16x32_bf16 v[140:143], v[44:47], a[36:39], v[140:143]
    ds_read_b64_tr_b16 v[38:39], v7 offset:50176
    v_mfma_f32_16x16x32_bf16 v[204:207], v[44:47], a[68:71], v[204:207]
    ds_write_b128 v22, v[184:187] offset:10240
    v_mfma_f32_16x16x32_bf16 v[68:71], v[48:51], a[8:11], v[68:71]
    ds_read_b64_tr_b16 v[40:41], v6 offset:51200
    v_readfirstlane_b32 s55, v29
    s_nop 0
    s_cmp_ge_u32 s55, 8
    s_cbranch_scc0 L_cwait
L_cok:
    v_mfma_f32_16x16x32_bf16 v[132:135], v[48:51], a[40:43], v[132:135]
    ds_read_b64_tr_b16 v[42:43], v6 offset:52224
    s_waitcnt lgkmcnt(10)
    v_mfma_f32_16x16x32_bf16 v[196:199], v[48:51], a[72:75], v[196:199]
    ds_write_b128 v22, v[248:251] offset:11264
    v_mfma_f32_16x16x32_bf16 v[76:79], v[52:55], a[8:11], v[76:79]
    ds_read_b64_tr_b16 v[44:45], v7 offset:51200
    v_mfma_f32_16x16x32_bf16 v[140:143], v[52:55], a[40:43], v[140:143]
    ds_read_b64_tr_b16 v[46:47], v7 offset:52224
    v_mfma_f32_16x16x32_bf16 v[204:207], v[52:55], a[72:75], v[204:207]
    s_waitcnt vmcnt(1)
    s_waitcnt lgkmcnt(2)
    s_barrier
    v_mfma_f32_16x16x32_bf16 v[68:71], v[56:59], a[12:15], v[68:71]
    ds_read_b64_tr_b16 v[48:49], v6 offset:40960
    v_mfma_f32_16x16x32_bf16 v[132:135], v[56:59], a[44:47], v[132:135]
    ds_read_b64_tr_b16 v[50:51], v6 offset:41984
    s_add_u32 m0, s54, 16384
    v_mfma_f32_16x16x32_bf16 v[196:199], v[56:59], a[76:79], v[196:199]
    buffer_load_dwordx4 v18, s[24:27], 0 offen offset:0 lds
    v_mfma_f32_16x16x32_bf16 v[76:79], v[60:63], a[12:15], v[76:79]
    ds_read_b64_tr_b16 v[52:53], v7 offset:40960
    v_mfma_f32_16x16x32_bf16 v[140:143], v[60:63], a[44:47], v[140:143]
    ds_read_b64_tr_b16 v[54:55], v7 offset:41984
    v_mfma_f32_16x16x32_bf16 v[204:207], v[60:63], a[76:79], v[204:207]
    buffer_load_dwordx4 v18, s[24:27], s49 offen offset:1024 lds
    v_mfma_f32_16x16x32_bf16 v[68:71], v[32:35], a[16:19], v[68:71]
    ds_read_b64_tr_b16 v[56:57], v6 offset:43008
    v_mfma_f32_16x16x32_bf16 v[132:135], v[32:35], a[48:51], v[132:135]
    ds_read_b64_tr_b16 v[58:59], v6 offset:44032
    v_mfma_f32_16x16x32_bf16 v[196:199], v[32:35], a[80:83], v[196:199]
    buffer_load_dwordx4 v18, s[24:27], s50 offen offset:2048 lds
    v_mfma_f32_16x16x32_bf16 v[76:79], v[36:39], a[16:19], v[76:79]
    ds_read_b64_tr_b16 v[60:61], v7 offset:43008
    v_mfma_f32_16x16x32_bf16 v[140:143], v[36:39], a[48:51], v[140:143]
    ds_read_b64_tr_b16 v[62:63], v7 offset:44032
    v_mfma_f32_16x16x32_bf16 v[204:207], v[36:39], a[80:83], v[204:207]
    buffer_load_dwordx4 v18, s[24:27], s51 offen offset:3072 lds
    v_add_u32 v18, 32768, v18
    v_mfma_f32_16x16x32_bf16 v[68:71], v[40:43], a[20:23], v[68:71]
    ds_read_b64_tr_b16 v[32:33], v4 offset:16384
    ds_read_b128 a[52:55], v23 offset:0
    ds_read_b128 a[84:87], v23 offset:1024
    ds_read_b128 a[24:27], v23 offset:2048
    ds_read_b128 a[56:59], v23 offset:3072
    ds_read_b128 a[88:91], v23 offset:8192
    ds_read_b128 a[28:31], v23 offset:9216
    ds_read_b128 a[60:63], v23 offset:10240
    ds_read_b128 a[92:95], v23 offset:11264
    s_waitcnt lgkmcnt(7)
    v_mfma_f32_16x16x32_bf16 v[132:135], v[40:43], a[52:55], v[132:135]
    ds_read_b64_tr_b16 v[34:35], v4 offset:17408
    s_add_u32 m0, s54, 40960
    s_waitcnt lgkmcnt(7)
    v_mfma_f32_16x16x32_bf16 v[196:199], v[40:43], a[84:87], v[196:199]
    buffer_load_dwordx4 v18, s[24:27], 0 offen offset:0 lds
    v_mfma_f32_16x16x32_bf16 v[76:79], v[44:47], a[20:23], v[76:79]
    ds_read_b64_tr_b16 v[36:37], v5 offset:16384
    v_mfma_f32_16x16x32_bf16 v[140:143], v[44:47], a[52:55], v[140:143]
    ds_read_b64_tr_b16 v[38:39], v5 offset:17408
    v_mfma_f32_16x16x32_bf16 v[204:207], v[44:47], a[84:87], v[204:207]
    buffer_load_dwordx4 v18, s[24:27], s49 offen offset:1024 lds
    s_waitcnt lgkmcnt(8)
    v_mfma_f32_16x16x32_bf16 v[68:71], v[48:51], a[24:27], v[68:71]
    ds_read_b64_tr_b16 v[40:41], v4 offset:18432
    s_waitcnt lgkmcnt(8)
    v_mfma_f32_16x16x32_bf16 v[132:135], v[48:51], a[56:59], v[132:135]
    ds_read_b64_tr_b16 v[42:43], v4 offset:19456
    s_waitcnt lgkmcnt(8)
    v_mfma_f32_16x16x32_bf16 v[196:199], v[48:51], a[88:91], v[196:199]
    buffer_load_dwordx4 v18, s[24:27], s50 offen offset:2048 lds
    v_mfma_f32_16x16x32_bf16 v[76:79], v[52:55], a[24:27], v[76:79]
    ds_read_b64_tr_b16 v[44:45], v5 offset:18432
    v_mfma_f32_16x16x32_bf16 v[140:143], v[52:55], a[56:59], v[140:143]
    ds_read_b64_tr_b16 v[46:47], v5 offset:19456
    v_mfma_f32_16x16x32_bf16 v[204:207], v[52:55], a[88:91], v[204:207]
    buffer_load_dwordx4 v18, s[24:27], s51 offen offset:3072 lds
    s_waitcnt lgkmcnt(9)
    v_add_u32 v18, s61, v19
    v_mfma_f32_16x16x32_bf16 v[68:71], v[56:59], a[28:31], v[68:71]
    ds_read_b64_tr_b16 v[48:49], v6 offset:16384
    s_waitcnt lgkmcnt(9)
    v_mfma_f32_16x16x32_bf16 v[132:135], v[56:59], a[60:63], v[132:135]
    ds_read_b64_tr_b16 v[50:51], v6 offset:17408
    s_add_u32 m0, s54, 49152
    s_waitcnt lgkmcnt(8)
    v_mfma_f32_16x16x32_bf16 v[196:199], v[56:59], a[92:95], v[196:199]
    buffer_load_dwordx4 v18, s[24:27], 0 offen offset:0 lds
    v_mfma_f32_16x16x32_bf16 v[76:79], v[60:63], a[28:31], v[76:79]
    ds_read_b64_tr_b16 v[52:53], v7 offset:16384
    v_mfma_f32_16x16x32_bf16 v[140:143], v[60:63], a[60:63], v[140:143]
    ds_read_b64_tr_b16 v[54:55], v7 offset:17408
    v_mfma_f32_16x16x32_bf16 v[204:207], v[60:63], a[92:95], v[204:207]
    buffer_load_dwordx4 v18, s[24:27], s49 offen offset:1024 lds
    v_mfma_f32_16x16x32_bf16 v[84:87], v[32:35], v[64:67], 0
    ds_read_b64_tr_b16 v[56:57], v6 offset:18432
    v_mfma_f32_16x16x32_bf16 v[148:151], v[32:35], v[128:131], 0
    ds_read_b64_tr_b16 v[58:59], v6 offset:19456
    v_mfma_f32_16x16x32_bf16 v[212:215], v[32:35], v[192:195], 0
    buffer_load_dwordx4 v18, s[24:27], s50 offen offset:2048 lds
    s_waitcnt lgkmcnt(8)
    v_add_u32 v8, 12288, v8
    v_mfma_f32_16x16x32_bf16 v[92:95], v[36:39], v[64:67], 0
    ds_read_b64_tr_b16 v[60:61], v7 offset:18432
    v_cvt_pk_bf16_f32 v100, v68, v69
    v_mfma_f32_16x16x32_bf16 v[156:159], v[36:39], v[128:131], 0
    ds_read_b64_tr_b16 v[62:63], v7 offset:19456
    s_add_u32 s43, s66, 12288
    v_cvt_pk_bf16_f32 v101, v70, v71
    v_mfma_f32_16x16x32_bf16 v[220:223], v[36:39], v[192:195], 0
    buffer_load_dwordx4 v18, s[24:27], s51 offen offset:3072 lds
    v_add_u32 v18, 32768, v18
    v_mfma_f32_16x16x32_bf16 v[84:87], v[40:43], v[72:75], v[84:87]
    ds_read_b64_tr_b16 v[32:33], v4 offset:57344
    v_cvt_pk_bf16_f32 v102, v76, v77
    v_mfma_f32_16x16x32_bf16 v[148:151], v[40:43], v[136:139], v[148:151]
    ds_read_b64_tr_b16 v[34:35], v4 offset:58368
    v_cvt_pk_bf16_f32 v103, v78, v79
    v_mfma_f32_16x16x32_bf16 v[212:215], v[40:43], v[200:203], v[212:215]
    buffer_store_dwordx4 v[100:103], v8, s[32:35], s67 offen offset:0 sc1
    s_add_u32 s44, s66, 24576
    s_waitcnt lgkmcnt(8)
    v_cvt_pk_bf16_f32 v164, v132, v133
    v_mfma_f32_16x16x32_bf16 v[92:95], v[44:47], v[72:75], v[92:95]
    ds_read_b64_tr_b16 v[36:37], v5 offset:57344
    v_cvt_pk_bf16_f32 v165, v134, v135
    v_mfma_f32_16x16x32_bf16 v[156:159], v[44:47], v[136:139], v[156:159]
    ds_read_b64_tr_b16 v[38:39], v5 offset:58368
    v_cvt_pk_bf16_f32 v166, v140, v141
    v_mfma_f32_16x16x32_bf16 v[220:223], v[44:47], v[200:203], v[220:223]
    v_cvt_pk_bf16_f32 v167, v142, v143
    v_mfma_f32_16x16x32_bf16 v[84:87], v[48:51], a[0:3], v[84:87]
    ds_read_b64_tr_b16 v[40:41], v4 offset:59392
    v_mfma_f32_16x16x32_bf16 v[148:151], v[48:51], a[32:35], v[148:151]
    ds_read_b64_tr_b16 v[42:43], v4 offset:60416
    s_add_u32 s45, s66, 36864
    v_mfma_f32_16x16x32_bf16 v[212:215], v[48:51], a[64:67], v[212:215]
    buffer_store_dwordx4 v[164:167], v8, s[32:35], s67 offen offset:1024 sc1
    s_waitcnt lgkmcnt(8)
    v_cvt_pk_bf16_f32 v228, v196, v197
    v_mfma_f32_16x16x32_bf16 v[92:95], v[52:55], a[0:3], v[92:95]
    ds_read_b64_tr_b16 v[44:45], v5 offset:59392
    v_cvt_pk_bf16_f32 v229, v198, v199
    v_mfma_f32_16x16x32_bf16 v[156:159], v[52:55], a[32:35], v[156:159]
    ds_read_b64_tr_b16 v[46:47], v5 offset:60416
    v_cvt_pk_bf16_f32 v230, v204, v205
    v_mfma_f32_16x16x32_bf16 v[220:223], v[52:55], a[64:67], v[220:223]
    v_cvt_pk_bf16_f32 v231, v206, v207
    v_mfma_f32_16x16x32_bf16 v[84:87], v[56:59], a[4:7], v[84:87]
    ds_read_b64_tr_b16 v[48:49], v6 offset:57344
    s_add_u32 s46, s66, 49152
    v_mfma_f32_16x16x32_bf16 v[148:151], v[56:59], a[36:39], v[148:151]
    ds_read_b64_tr_b16 v[50:51], v6 offset:58368
    v_mfma_f32_16x16x32_bf16 v[212:215], v[56:59], a[68:71], v[212:215]
    buffer_store_dwordx4 v[228:231], v8, s[32:35], s67 offen offset:2048 sc1
    s_waitcnt lgkmcnt(8)
    v_mfma_f32_16x16x32_bf16 v[92:95], v[60:63], a[4:7], v[92:95]
    ds_read_b64_tr_b16 v[52:53], v7 offset:57344
    v_mfma_f32_16x16x32_bf16 v[156:159], v[60:63], a[36:39], v[156:159]
    ds_read_b64_tr_b16 v[54:55], v7 offset:58368
    v_mfma_f32_16x16x32_bf16 v[220:223], v[60:63], a[68:71], v[220:223]
    s_add_u32 s47, s66, 61440
    v_mfma_f32_16x16x32_bf16 v[84:87], v[32:35], v[80:83], v[84:87]
    ds_read_b64_tr_b16 v[56:57], v6 offset:59392
    v_mfma_f32_16x16x32_bf16 v[148:151], v[32:35], v[144:147], v[148:151]
    ds_read_b64_tr_b16 v[58:59], v6 offset:60416
    v_mfma_f32_16x16x32_bf16 v[212:215], v[32:35], v[208:211], v[212:215]
    s_waitcnt lgkmcnt(8)
    v_mfma_f32_16x16x32_bf16 v[92:95], v[36:39], v[80:83], v[92:95]
    ds_read_b64_tr_b16 v[60:61], v7 offset:59392
    v_mfma_f32_16x16x32_bf16 v[156:159], v[36:39], v[144:147], v[156:159]
    ds_read_b64_tr_b16 v[62:63], v7 offset:60416
    s_add_u32 s48, s66, 73728
    v_mfma_f32_16x16x32_bf16 v[220:223], v[36:39], v[208:211], v[220:223]
    s_waitcnt vmcnt(7)
    s_barrier
    v_mfma_f32_16x16x32_bf16 v[84:87], v[40:43], v[88:91], v[84:87]
    ds_read_b64_tr_b16 v[32:33], v4 offset:0
    v_mfma_f32_16x16x32_bf16 v[148:151], v[40:43], v[152:155], v[148:151]
    ds_read_b64_tr_b16 v[34:35], v4 offset:1024
    s_add_u32 m0, s54, 24576
    v_mfma_f32_16x16x32_bf16 v[212:215], v[40:43], v[216:219], v[212:215]
    buffer_load_dwordx4 v18, s[24:27], 0 offen offset:0 lds
    s_waitcnt lgkmcnt(8)
    v_mfma_f32_16x16x32_bf16 v[92:95], v[44:47], v[88:91], v[92:95]
    ds_read_b64_tr_b16 v[36:37], v5 offset:0
    v_mfma_f32_16x16x32_bf16 v[156:159], v[44:47], v[152:155], v[156:159]
    ds_read_b64_tr_b16 v[38:39], v5 offset:1024
    v_mov_b32 v12, 0
    v_mfma_f32_16x16x32_bf16 v[220:223], v[44:47], v[216:219], v[220:223]
    buffer_load_dwordx4 v18, s[24:27], s49 offen offset:1024 lds
    v_mfma_f32_16x16x32_bf16 v[84:87], v[48:51], a[8:11], v[84:87]
    ds_read_b64_tr_b16 v[40:41], v4 offset:2048
    v_mfma_f32_16x16x32_bf16 v[148:151], v[48:51], a[40:43], v[148:151]
    ds_read_b64_tr_b16 v[42:43], v4 offset:3072
    v_mfma_f32_16x16x32_bf16 v[212:215], v[48:51], a[72:75], v[212:215]
    buffer_load_dwordx4 v18, s[24:27], s50 offen offset:2048 lds
    s_waitcnt lgkmcnt(8)
    v_mfma_f32_16x16x32_bf16 v[92:95], v[52:55], a[8:11], v[92:95]
    ds_read_b64_tr_b16 v[44:45], v5 offset:2048
    v_mfma_f32_16x16x32_bf16 v[156:159], v[52:55], a[40:43], v[156:159]
    ds_read_b64_tr_b16 v[46:47], v5 offset:3072
    v_mov_b32 v13, 0
    v_mfma_f32_16x16x32_bf16 v[220:223], v[52:55], a[72:75], v[220:223]
    buffer_load_dwordx4 v18, s[24:27], s51 offen offset:3072 lds
    v_add_u32 v18, 32768, v18
    v_mfma_f32_16x16x32_bf16 v[84:87], v[56:59], a[12:15], v[84:87]
    ds_read_b64_tr_b16 v[48:49], v6 offset:0
    v_mfma_f32_16x16x32_bf16 v[148:151], v[56:59], a[44:47], v[148:151]
    ds_read_b64_tr_b16 v[50:51], v6 offset:1024
    s_add_u32 m0, s54, 65536
    v_mfma_f32_16x16x32_bf16 v[212:215], v[56:59], a[76:79], v[212:215]
    buffer_load_dwordx4 v18, s[24:27], 0 offen offset:0 lds
    s_waitcnt lgkmcnt(8)
    v_mfma_f32_16x16x32_bf16 v[92:95], v[60:63], a[12:15], v[92:95]
    ds_read_b64_tr_b16 v[52:53], v7 offset:0
    v_mfma_f32_16x16x32_bf16 v[156:159], v[60:63], a[44:47], v[156:159]
    ds_read_b64_tr_b16 v[54:55], v7 offset:1024
    v_mfma_f32_16x16x32_bf16 v[220:223], v[60:63], a[76:79], v[220:223]
    buffer_load_dwordx4 v18, s[24:27], s49 offen offset:1024 lds
    v_mov_b32 v16, 0
    v_mfma_f32_16x16x32_bf16 v[84:87], v[32:35], v[96:99], v[84:87]
    ds_read_b64_tr_b16 v[56:57], v6 offset:2048
    v_mfma_f32_16x16x32_bf16 v[148:151], v[32:35], v[160:163], v[148:151]
    ds_read_b64_tr_b16 v[58:59], v6 offset:3072
    v_mfma_f32_16x16x32_bf16 v[212:215], v[32:35], v[224:227], v[212:215]
    buffer_load_dwordx4 v18, s[24:27], s50 offen offset:2048 lds
    s_waitcnt lgkmcnt(8)
    v_mfma_f32_16x16x32_bf16 v[92:95], v[36:39], v[96:99], v[92:95]
    ds_read_b64_tr_b16 v[60:61], v7 offset:2048
    v_mfma_f32_16x16x32_bf16 v[156:159], v[36:39], v[160:163], v[156:159]
    ds_read_b64_tr_b16 v[62:63], v7 offset:3072
    v_mfma_f32_16x16x32_bf16 v[220:223], v[36:39], v[224:227], v[220:223]
    buffer_load_dwordx4 v18, s[24:27], s51 offen offset:3072 lds
    v_add_u32 v18, 32768, v18
    v_mfma_f32_16x16x32_bf16 v[84:87], v[40:43], v[104:107], v[84:87]
    ds_read_b64_tr_b16 v[32:33], v4 offset:24576
    v_mov_b32 v17, 0
    v_mfma_f32_16x16x32_bf16 v[148:151], v[40:43], v[168:171], v[148:151]
    ds_read_b64_tr_b16 v[34:35], v4 offset:25600
    s_add_u32 m0, s54, 57344
    v_mfma_f32_16x16x32_bf16 v[212:215], v[40:43], v[232:235], v[212:215]
    buffer_load_dwordx4 v18, s[24:27], 0 offen offset:0 lds
    s_waitcnt lgkmcnt(8)
    v_mfma_f32_16x16x32_bf16 v[92:95], v[44:47], v[104:107], v[92:95]
    ds_read_b64_tr_b16 v[36:37], v5 offset:24576
    v_mfma_f32_16x16x32_bf16 v[156:159], v[44:47], v[168:171], v[156:159]
    ds_read_b64_tr_b16 v[38:39], v5 offset:25600
    v_mfma_f32_16x16x32_bf16 v[220:223], v[44:47], v[232:235], v[220:223]
    buffer_load_dwordx4 v18, s[24:27], s49 offen offset:1024 lds
    v_mfma_f32_16x16x32_bf16 v[84:87], v[48:51], a[16:19], v[84:87]
    ds_read_b64_tr_b16 v[40:41], v4 offset:26624
    v_and_b32 v1, 1, v0
    v_mfma_f32_16x16x32_bf16 v[148:151], v[48:51], a[48:51], v[148:151]
    ds_read_b64_tr_b16 v[42:43], v4 offset:27648
    v_mfma_f32_16x16x32_bf16 v[212:215], v[48:51], a[80:83], v[212:215]
    buffer_load_dwordx4 v18, s[24:27], s50 offen offset:2048 lds
    s_waitcnt lgkmcnt(8)
    v_mfma_f32_16x16x32_bf16 v[92:95], v[52:55], a[16:19], v[92:95]
    ds_read_b64_tr_b16 v[44:45], v5 offset:26624
    v_mfma_f32_16x16x32_bf16 v[156:159], v[52:55], a[48:51], v[156:159]
    ds_read_b64_tr_b16 v[46:47], v5 offset:27648
    v_mfma_f32_16x16x32_bf16 v[220:223], v[52:55], a[80:83], v[220:223]
    buffer_load_dwordx4 v18, s[24:27], s51 offen offset:3072 lds
    v_add_u32 v18, s62, v19
    v_mfma_f32_16x16x32_bf16 v[84:87], v[56:59], a[20:23], v[84:87]
    ds_read_b64_tr_b16 v[48:49], v6 offset:24576
    v_lshlrev_b32 v1, 4, v1
    v_mfma_f32_16x16x32_bf16 v[148:151], v[56:59], a[52:55], v[148:151]
    ds_read_b64_tr_b16 v[50:51], v6 offset:25600
    s_add_u32 m0, s54, 32768
    v_mfma_f32_16x16x32_bf16 v[212:215], v[56:59], a[84:87], v[212:215]
    buffer_load_dwordx4 v18, s[24:27], 0 offen offset:0 lds
    s_waitcnt lgkmcnt(8)
    v_mfma_f32_16x16x32_bf16 v[92:95], v[60:63], a[20:23], v[92:95]
    ds_read_b64_tr_b16 v[52:53], v7 offset:24576
    v_mfma_f32_16x16x32_bf16 v[156:159], v[60:63], a[52:55], v[156:159]
    ds_read_b64_tr_b16 v[54:55], v7 offset:25600
    v_mfma_f32_16x16x32_bf16 v[220:223], v[60:63], a[84:87], v[220:223]
    buffer_load_dwordx4 v18, s[24:27], s49 offen offset:1024 lds
    v_mfma_f32_16x16x32_bf16 v[84:87], v[32:35], v[112:115], v[84:87]
    ds_read_b64_tr_b16 v[56:57], v6 offset:26624
    v_mfma_f32_16x16x32_bf16 v[148:151], v[32:35], v[176:179], v[148:151]
    ds_read_b64_tr_b16 v[58:59], v6 offset:27648
    v_mov_b32 v2, 0x3f80
    v_mfma_f32_16x16x32_bf16 v[212:215], v[32:35], v[240:243], v[212:215]
    buffer_load_dwordx4 v18, s[24:27], s50 offen offset:2048 lds
    s_waitcnt lgkmcnt(8)
    v_mfma_f32_16x16x32_bf16 v[92:95], v[36:39], v[112:115], v[92:95]
    ds_read_b64_tr_b16 v[60:61], v7 offset:26624
    v_mfma_f32_16x16x32_bf16 v[156:159], v[36:39], v[176:179], v[156:159]
    ds_read_b64_tr_b16 v[62:63], v7 offset:27648
    v_mfma_f32_16x16x32_bf16 v[220:223], v[36:39], v[240:243], v[220:223]
    s_waitcnt vmcnt(11)
    s_barrier
    v_mfma_f32_16x16x32_bf16 v[84:87], v[40:43], v[120:123], v[84:87]
    ds_read_b64_tr_b16 v[32:33], v4 offset:32768
    v_mfma_f32_16x16x32_bf16 v[148:151], v[40:43], v[184:187], v[148:151]
    ds_read_b64_tr_b16 v[34:35], v4 offset:33792
    v_mfma_f32_16x16x32_bf16 v[212:215], v[40:43], v[248:251], v[212:215]
    buffer_load_dwordx4 v18, s[24:27], s51 offen offset:3072 lds
    s_waitcnt lgkmcnt(7)
    v_add_u32 v18, 32768, v18
    v_mfma_f32_16x16x32_bf16 v[92:95], v[44:47], v[120:123], v[92:95]
    ds_read_b64_tr_b16 v[36:37], v5 offset:32768
    v_lshlrev_b32 v1, v1, v2
    v_mfma_f32_16x16x32_bf16 v[156:159], v[44:47], v[184:187], v[156:159]
    ds_read_b64_tr_b16 v[38:39], v5 offset:33792
    s_add_u32 m0, s54, 73728
    v_mfma_f32_16x16x32_bf16 v[220:223], v[44:47], v[248:251], v[220:223]
    buffer_load_dwordx4 v18, s[24:27], 0 offen offset:0 lds
    v_mfma_f32_16x16x32_bf16 v[84:87], v[48:51], a[24:27], v[84:87]
    ds_read_b64_tr_b16 v[40:41], v4 offset:34816
    v_mfma_f32_16x16x32_bf16 v[148:151], v[48:51], a[56:59], v[148:151]
    ds_read_b64_tr_b16 v[42:43], v4 offset:35840
    v_mfma_f32_16x16x32_bf16 v[212:215], v[48:51], a[88:91], v[212:215]
    buffer_load_dwordx4 v18, s[24:27], s49 offen offset:1024 lds
    s_waitcnt lgkmcnt(7)
    v_bfe_u32 v2, v0, 1, 3
    v_mfma_f32_16x16x32_bf16 v[92:95], v[52:55], a[24:27], v[92:95]
    ds_read_b64_tr_b16 v[44:45], v5 offset:34816
    v_mfma_f32_16x16x32_bf16 v[156:159], v[52:55], a[56:59], v[156:159]
    ds_read_b64_tr_b16 v[46:47], v5 offset:35840
    s_mov_b64 exec, 1
    buffer_store_dword v11, v9, s[32:35], s67 offen offset:4 sc1
    s_mov_b64 exec, -1
    v_mfma_f32_16x16x32_bf16 v[220:223], v[52:55], a[88:91], v[220:223]
    buffer_load_dwordx4 v18, s[24:27], s50 offen offset:2048 lds
    v_mfma_f32_16x16x32_bf16 v[84:87], v[56:59], a[28:31], v[84:87]
    ds_read_b64_tr_b16 v[48:49], v6 offset:32768
    v_mfma_f32_16x16x32_bf16 v[148:151], v[56:59], a[60:63], v[148:151]
    ds_read_b64_tr_b16 v[50:51], v6 offset:33792
    v_mfma_f32_16x16x32_bf16 v[212:215], v[56:59], a[92:95], v[212:215]
    buffer_load_dwordx4 v18, s[24:27], s51 offen offset:3072 lds
    s_waitcnt lgkmcnt(8)
    v_add_u32 v18, 32768, v18
    v_mfma_f32_16x16x32_bf16 v[92:95], v[60:63], a[28:31], v[92:95]
    ds_read_b64_tr_b16 v[52:53], v7 offset:32768
    v_lshrrev_b32 v3, 4, v0
    v_mfma_f32_16x16x32_bf16 v[156:159], v[60:63], a[60:63], v[156:159]
    ds_read_b64_tr_b16 v[54:55], v7 offset:33792
    s_add_u32 m0, s54, 16384
    v_mfma_f32_16x16x32_bf16 v[220:223], v[60:63], a[92:95], v[220:223]
    buffer_load_dwordx4 v18, s[24:27], 0 offen offset:0 lds
    v_mfma_f32_16x16x32_bf16 v[68:71], v[32:35], v[64:67], 0
    ds_read_b64_tr_b16 v[56:57], v6 offset:34816
    v_mfma_f32_16x16x32_bf16 v[132:135], v[32:35], v[128:131], 0
    ds_read_b64_tr_b16 v[58:59], v6 offset:35840
    v_mfma_f32_16x16x32_bf16 v[196:199], v[32:35], v[192:195], 0
    buffer_load_dwordx4 v18, s[24:27], s49 offen offset:1024 lds
    s_waitcnt lgkmcnt(8)
    v_add_u32 v8, 12288, v8
    v_mfma_f32_16x16x32_bf16 v[76:79], v[36:39], v[64:67], 0
    ds_read_b64_tr_b16 v[60:61], v7 offset:34816
    v_cvt_pk_bf16_f32 v100, v84, v85
    v_mfma_f32_16x16x32_bf16 v[140:143], v[36:39], v[128:131], 0
    ds_read_b64_tr_b16 v[62:63], v7 offset:35840
    v_cvt_pk_bf16_f32 v101, v86, v87
    v_mfma_f32_16x16x32_bf16 v[204:207], v[36:39], v[192:195], 0
    buffer_load_dwordx4 v18, s[24:27], s50 offen offset:2048 lds
    v_cvt_pk_bf16_f32 v102, v92, v93
    v_mfma_f32_16x16x32_bf16 v[68:71], v[40:43], v[72:75], v[68:71]
    ds_read_b64_tr_b16 v[32:33], v4 offset:8192
    v_cvt_pk_bf16_f32 v103, v94, v95
    v_mfma_f32_16x16x32_bf16 v[132:135], v[40:43], v[136:139], v[132:135]
    ds_read_b64_tr_b16 v[34:35], v4 offset:9216
    v_lshlrev_b32 v3, 1, v3
    v_mfma_f32_16x16x32_bf16 v[196:199], v[40:43], v[200:203], v[196:199]
    buffer_load_dwordx4 v18, s[24:27], s51 offen offset:3072 lds
    s_waitcnt lgkmcnt(8)
    v_add_u32 v18, 32768, v18
    v_mfma_f32_16x16x32_bf16 v[76:79], v[44:47], v[72:75], v[76:79]
    ds_read_b64_tr_b16 v[36:37], v5 offset:8192
    v_mfma_f32_16x16x32_bf16 v[140:143], v[44:47], v[136:139], v[140:143]
    ds_read_b64_tr_b16 v[38:39], v5 offset:9216
    v_cmp_eq_u32 vcc, v2, v3
    v_mfma_f32_16x16x32_bf16 v[204:207], v[44:47], v[200:203], v[204:207]
    buffer_store_dwordx4 v[100:103], v8, s[32:35], s68 offen offset:0 sc1
    v_cvt_pk_bf16_f32 v164, v148, v149
    v_mfma_f32_16x16x32_bf16 v[68:71], v[48:51], a[0:3], v[68:71]
    ds_read_b64_tr_b16 v[40:41], v4 offset:10240
    v_cvt_pk_bf16_f32 v165, v150, v151
    v_mfma_f32_16x16x32_bf16 v[132:135], v[48:51], a[32:35], v[132:135]
    ds_read_b64_tr_b16 v[42:43], v4 offset:11264
    v_cvt_pk_bf16_f32 v166, v156, v157
    v_mfma_f32_16x16x32_bf16 v[196:199], v[48:51], a[64:67], v[196:199]
    s_waitcnt lgkmcnt(8)
    v_cvt_pk_bf16_f32 v167, v158, v159
    v_mfma_f32_16x16x32_bf16 v[76:79], v[52:55], a[0:3], v[76:79]
    ds_read_b64_tr_b16 v[44:45], v5 offset:10240
    v_mfma_f32_16x16x32_bf16 v[140:143], v[52:55], a[32:35], v[140:143]
    ds_read_b64_tr_b16 v[46:47], v5 offset:11264
    v_cndmask_b32 v14, v12, v1, vcc
    v_mfma_f32_16x16x32_bf16 v[204:207], v[52:55], a[64:67], v[204:207]
    buffer_store_dwordx4 v[164:167], v8, s[32:35], s68 offen offset:1024 sc1
    v_cvt_pk_bf16_f32 v228, v212, v213
    v_mfma_f32_16x16x32_bf16 v[68:71], v[56:59], a[4:7], v[68:71]
    ds_read_b64_tr_b16 v[48:49], v6 offset:8192
    v_cvt_pk_bf16_f32 v229, v214, v215
    v_mfma_f32_16x16x32_bf16 v[132:135], v[56:59], a[36:39], v[132:135]
    ds_read_b64_tr_b16 v[50:51], v6 offset:9216
    v_cvt_pk_bf16_f32 v230, v220, v221
    v_mfma_f32_16x16x32_bf16 v[196:199], v[56:59], a[68:71], v[196:199]
    s_waitcnt lgkmcnt(8)
    v_cvt_pk_bf16_f32 v231, v222, v223
    v_mfma_f32_16x16x32_bf16 v[76:79], v[60:63], a[4:7], v[76:79]
    ds_read_b64_tr_b16 v[52:53], v7 offset:8192
    v_mfma_f32_16x16x32_bf16 v[140:143], v[60:63], a[36:39], v[140:143]
    ds_read_b64_tr_b16 v[54:55], v7 offset:9216
    v_mfma_f32_16x16x32_bf16 v[204:207], v[60:63], a[68:71], v[204:207]
    buffer_store_dwordx4 v[228:231], v8, s[32:35], s68 offen offset:2048 sc1
    v_add_u32 v3, 1, v3
    v_mfma_f32_16x16x32_bf16 v[68:71], v[32:35], v[80:83], v[68:71]
    ds_read_b64_tr_b16 v[56:57], v6 offset:10240
    v_mfma_f32_16x16x32_bf16 v[132:135], v[32:35], v[144:147], v[132:135]
    ds_read_b64_tr_b16 v[58:59], v6 offset:11264
    v_mfma_f32_16x16x32_bf16 v[196:199], v[32:35], v[208:211], v[196:199]
    s_waitcnt lgkmcnt(8)
    v_mfma_f32_16x16x32_bf16 v[76:79], v[36:39], v[80:83], v[76:79]
    ds_read_b64_tr_b16 v[60:61], v7 offset:10240
    v_mfma_f32_16x16x32_bf16 v[140:143], v[36:39], v[144:147], v[140:143]
    ds_read_b64_tr_b16 v[62:63], v7 offset:11264
    v_mfma_f32_16x16x32_bf16 v[204:207], v[36:39], v[208:211], v[204:207]
    s_waitcnt vmcnt(16)
    s_barrier
    v_mfma_f32_16x16x32_bf16 v[68:71], v[40:43], v[88:91], v[68:71]
    ds_read_b64_tr_b16 v[32:33], v4 offset:49152
    v_cmp_eq_u32 vcc, v2, v3
    v_mfma_f32_16x16x32_bf16 v[132:135], v[40:43], v[152:155], v[132:135]
    ds_read_b64_tr_b16 v[34:35], v4 offset:50176
    s_add_u32 m0, s54, 40960
    v_mfma_f32_16x16x32_bf16 v[196:199], v[40:43], v[216:219], v[196:199]
    buffer_load_dwordx4 v18, s[24:27], 0 offen offset:0 lds
    s_waitcnt lgkmcnt(8)
    v_mfma_f32_16x16x32_bf16 v[76:79], v[44:47], v[88:91], v[76:79]
    ds_read_b64_tr_b16 v[36:37], v5 offset:49152
    v_mfma_f32_16x16x32_bf16 v[140:143], v[44:47], v[152:155], v[140:143]
    ds_read_b64_tr_b16 v[38:39], v5 offset:50176
    v_mfma_f32_16x16x32_bf16 v[204:207], v[44:47], v[216:219], v[204:207]
    buffer_load_dwordx4 v18, s[24:27], s49 offen offset:1024 lds
    v_mfma_f32_16x16x32_bf16 v[68:71], v[48:51], a[8:11], v[68:71]
    ds_read_b64_tr_b16 v[40:41], v4 offset:51200
    v_cndmask_b32 v15, v12, v1, vcc
    v_mfma_f32_16x16x32_bf16 v[132:135], v[48:51], a[40:43], v[132:135]
    ds_read_b64_tr_b16 v[42:43], v4 offset:52224
    v_mfma_f32_16x16x32_bf16 v[196:199], v[48:51], a[72:75], v[196:199]
    s_waitcnt lgkmcnt(8)
    v_mfma_f32_16x16x32_bf16 v[76:79], v[52:55], a[8:11], v[76:79]
    ds_read_b64_tr_b16 v[44:45], v5 offset:51200
    v_mfma_f32_16x16x32_bf16 v[140:143], v[52:55], a[40:43], v[140:143]
    ds_read_b64_tr_b16 v[46:47], v5 offset:52224
    v_mfma_f32_16x16x32_bf16 v[204:207], v[52:55], a[72:75], v[204:207]
    buffer_load_dwordx4 v18, s[24:27], s50 offen offset:2048 lds
    v_mfma_f32_16x16x32_bf16 v[68:71], v[56:59], a[12:15], v[68:71]
    ds_read_b64_tr_b16 v[48:49], v6 offset:49152
    v_mfma_f32_16x16x32_bf16 v[132:135], v[56:59], a[44:47], v[132:135]
    ds_read_b64_tr_b16 v[50:51], v6 offset:50176
    v_and_b32 v1, 15, v0
    v_mfma_f32_16x16x32_bf16 v[196:199], v[56:59], a[76:79], v[196:199]
    s_waitcnt lgkmcnt(8)
    v_mfma_f32_16x16x32_bf16 v[76:79], v[60:63], a[12:15], v[76:79]
    ds_read_b64_tr_b16 v[52:53], v7 offset:49152
    v_mfma_f32_16x16x32_bf16 v[140:143], v[60:63], a[44:47], v[140:143]
    ds_read_b64_tr_b16 v[54:55], v7 offset:50176
    v_mfma_f32_16x16x32_bf16 v[204:207], v[60:63], a[76:79], v[204:207]
    buffer_load_dwordx4 v18, s[24:27], s51 offen offset:3072 lds
    v_add_u32 v18, s63, v19
    v_mfma_f32_16x16x32_bf16 v[68:71], v[32:35], v[96:99], v[68:71]
    ds_read_b64_tr_b16 v[56:57], v6 offset:51200
    v_mfma_f32_16x16x32_bf16 v[132:135], v[32:35], v[160:163], v[132:135]
    ds_read_b64_tr_b16 v[58:59], v6 offset:52224
    s_add_u32 m0, s54, 49152
    v_lshlrev_b32 v1, 11, v1
    v_mfma_f32_16x16x32_bf16 v[196:199], v[32:35], v[224:227], v[196:199]
    buffer_load_dwordx4 v18, s[24:27], 0 offen offset:0 lds
    s_waitcnt lgkmcnt(8)
    v_mfma_f32_16x16x32_bf16 v[76:79], v[36:39], v[96:99], v[76:79]
    ds_read_b64_tr_b16 v[60:61], v7 offset:51200
    v_mfma_f32_16x16x32_bf16 v[140:143], v[36:39], v[160:163], v[140:143]
    ds_read_b64_tr_b16 v[62:63], v7 offset:52224
    v_mfma_f32_16x16x32_bf16 v[204:207], v[36:39], v[224:227], v[204:207]
    v_mfma_f32_16x16x32_bf16 v[68:71], v[40:43], v[104:107], v[68:71]
    ds_read_b64_tr_b16 v[32:33], v4 offset:40960
    v_mfma_f32_16x16x32_bf16 v[132:135], v[40:43], v[168:171], v[132:135]
    ds_read_b64_tr_b16 v[34:35], v4 offset:41984
    v_mfma_f32_16x16x32_bf16 v[196:199], v[40:43], v[232:235], v[196:199]
    buffer_load_dwordx4 v18, s[24:27], s49 offen offset:1024 lds
    s_waitcnt lgkmcnt(8)
    v_lshrrev_b32 v2, 5, v0
    v_mfma_f32_16x16x32_bf16 v[76:79], v[44:47], v[104:107], v[76:79]
    ds_read_b64_tr_b16 v[36:37], v5 offset:40960
    v_mfma_f32_16x16x32_bf16 v[140:143], v[44:47], v[168:171], v[140:143]
    ds_read_b64_tr_b16 v[38:39], v5 offset:41984
    v_mfma_f32_16x16x32_bf16 v[204:207], v[44:47], v[232:235], v[204:207]
    v_mfma_f32_16x16x32_bf16 v[68:71], v[48:51], a[16:19], v[68:71]
    ds_read_b64_tr_b16 v[40:41], v4 offset:43008
    v_mfma_f32_16x16x32_bf16 v[132:135], v[48:51], a[48:51], v[132:135]
    ds_read_b64_tr_b16 v[42:43], v4 offset:44032
    v_mfma_f32_16x16x32_bf16 v[196:199], v[48:51], a[80:83], v[196:199]
    buffer_load_dwordx4 v18, s[24:27], s50 offen offset:2048 lds
    s_waitcnt lgkmcnt(8)
    v_lshl_add_u32 v1, v2, 4, v1
    v_mfma_f32_16x16x32_bf16 v[76:79], v[52:55], a[16:19], v[76:79]
    ds_read_b64_tr_b16 v[44:45], v5 offset:43008
    v_mfma_f32_16x16x32_bf16 v[140:143], v[52:55], a[48:51], v[140:143]
    ds_read_b64_tr_b16 v[46:47], v5 offset:44032
    v_mfma_f32_16x16x32_bf16 v[204:207], v[52:55], a[80:83], v[204:207]
    buffer_load_dwordx4 v18, s[24:27], s51 offen offset:3072 lds
    v_add_u32 v18, 32768, v18
    v_mfma_f32_16x16x32_bf16 v[68:71], v[56:59], a[20:23], v[68:71]
    ds_read_b64_tr_b16 v[48:49], v6 offset:40960
    v_mfma_f32_16x16x32_bf16 v[132:135], v[56:59], a[52:55], v[132:135]
    ds_read_b64_tr_b16 v[50:51], v6 offset:41984
    v_mfma_f32_16x16x32_bf16 v[196:199], v[56:59], a[84:87], v[196:199]
    s_waitcnt lgkmcnt(8)
    v_mfma_f32_16x16x32_bf16 v[76:79], v[60:63], a[20:23], v[76:79]
    ds_read_b64_tr_b16 v[52:53], v7 offset:40960
    v_bfe_u32 v2, v0, 4, 1
    v_mfma_f32_16x16x32_bf16 v[140:143], v[60:63], a[52:55], v[140:143]
    ds_read_b64_tr_b16 v[54:55], v7 offset:41984
    v_mfma_f32_16x16x32_bf16 v[204:207], v[60:63], a[84:87], v[204:207]
    v_mfma_f32_16x16x32_bf16 v[68:71], v[32:35], v[112:115], v[68:71]
    ds_read_b64_tr_b16 v[56:57], v6 offset:43008
    v_mfma_f32_16x16x32_bf16 v[132:135], v[32:35], v[176:179], v[132:135]
    ds_read_b64_tr_b16 v[58:59], v6 offset:44032
    v_mfma_f32_16x16x32_bf16 v[196:199], v[32:35], v[240:243], v[196:199]
    s_waitcnt lgkmcnt(8)
    v_mfma_f32_16x16x32_bf16 v[76:79], v[36:39], v[112:115], v[76:79]
    ds_read_b64_tr_b16 v[60:61], v7 offset:43008
    v_mfma_f32_16x16x32_bf16 v[140:143], v[36:39], v[176:179], v[140:143]
    ds_read_b64_tr_b16 v[62:63], v7 offset:44032
    v_lshl_add_u32 v20, v2, 5, v1
    v_mfma_f32_16x16x32_bf16 v[204:207], v[36:39], v[240:243], v[204:207]
    s_waitcnt vmcnt(15)
    s_barrier
    v_mfma_f32_16x16x32_bf16 v[68:71], v[40:43], v[120:123], v[68:71]
    ds_read_b64_tr_b16 v[32:33], v4 offset:16384
    v_mfma_f32_16x16x32_bf16 v[132:135], v[40:43], v[184:187], v[132:135]
    ds_read_b64_tr_b16 v[34:35], v4 offset:17408
    s_add_u32 m0, s54, 24576
    v_mfma_f32_16x16x32_bf16 v[196:199], v[40:43], v[248:251], v[196:199]
    buffer_load_dwordx4 v18, s[24:27], 0 offen offset:0 lds
    s_waitcnt lgkmcnt(8)
    v_mfma_f32_16x16x32_bf16 v[76:79], v[44:47], v[120:123], v[76:79]
    ds_read_b64_tr_b16 v[36:37], v5 offset:16384
    v_mfma_f32_16x16x32_bf16 v[140:143], v[44:47], v[184:187], v[140:143]
    ds_read_b64_tr_b16 v[38:39], v5 offset:17408
    s_lshl_b32 s74, s4, 1
    v_mfma_f32_16x16x32_bf16 v[204:207], v[44:47], v[248:251], v[204:207]
    buffer_load_dwordx4 v18, s[24:27], s49 offen offset:1024 lds
    v_mfma_f32_16x16x32_bf16 v[68:71], v[48:51], a[24:27], v[68:71]
    ds_read_b64_tr_b16 v[40:41], v4 offset:18432
    v_mfma_f32_16x16x32_bf16 v[132:135], v[48:51], a[56:59], v[132:135]
    ds_read_b64_tr_b16 v[42:43], v4 offset:19456
    v_mfma_f32_16x16x32_bf16 v[196:199], v[48:51], a[88:91], v[196:199]
    s_waitcnt lgkmcnt(8)
    v_mfma_f32_16x16x32_bf16 v[76:79], v[52:55], a[24:27], v[76:79]
    ds_read_b64_tr_b16 v[44:45], v5 offset:18432
    v_mfma_f32_16x16x32_bf16 v[140:143], v[52:55], a[56:59], v[140:143]
    ds_read_b64_tr_b16 v[46:47], v5 offset:19456
    s_waitcnt vmcnt(10)
    s_mov_b64 exec, 1
    buffer_store_dword v11, v9, s[32:35], s68 offen offset:8 sc1
    s_mov_b64 exec, -1
    v_mfma_f32_16x16x32_bf16 v[204:207], v[52:55], a[88:91], v[204:207]
    buffer_load_dwordx4 v18, s[24:27], s50 offen offset:2048 lds
    s_add_u32 s74, s74, s6
    v_mfma_f32_16x16x32_bf16 v[68:71], v[56:59], a[28:31], v[68:71]
    ds_read_b64_tr_b16 v[48:49], v6 offset:16384
    v_mfma_f32_16x16x32_bf16 v[132:135], v[56:59], a[60:63], v[132:135]
    ds_read_b64_tr_b16 v[50:51], v6 offset:17408
    v_mfma_f32_16x16x32_bf16 v[196:199], v[56:59], a[92:95], v[196:199]
    s_waitcnt lgkmcnt(8)
    v_mfma_f32_16x16x32_bf16 v[76:79], v[60:63], a[28:31], v[76:79]
    ds_read_b64_tr_b16 v[52:53], v7 offset:16384
    v_mfma_f32_16x16x32_bf16 v[140:143], v[60:63], a[60:63], v[140:143]
    ds_read_b64_tr_b16 v[54:55], v7 offset:17408
    v_mfma_f32_16x16x32_bf16 v[204:207], v[60:63], a[92:95], v[204:207]
    buffer_load_dwordx4 v18, s[24:27], s51 offen offset:3072 lds
    s_mul_i32 s74, s74, 98304
    v_add_u32 v18, 32768, v18
    v_mfma_f32_16x16x32_bf16 v[84:87], v[32:35], v[64:67], 0
    ds_read_b64_tr_b16 v[56:57], v6 offset:18432
    v_mfma_f32_16x16x32_bf16 v[148:151], v[32:35], v[128:131], 0
    ds_read_b64_tr_b16 v[58:59], v6 offset:19456
    s_add_u32 m0, s54, 65536
    v_mfma_f32_16x16x32_bf16 v[212:215], v[32:35], v[192:195], 0
    buffer_load_dwordx4 v18, s[24:27], 0 offen offset:0 lds
    s_waitcnt lgkmcnt(8)
    v_add_u32 v8, 12288, v8
    v_mfma_f32_16x16x32_bf16 v[92:95], v[36:39], v[64:67], 0
    ds_read_b64_tr_b16 v[60:61], v7 offset:18432
    v_cvt_pk_bf16_f32 v100, v68, v69
    v_mfma_f32_16x16x32_bf16 v[156:159], v[36:39], v[128:131], 0
    ds_read_b64_tr_b16 v[62:63], v7 offset:19456
    buffer_load_dword v29, v10, s[32:35], s66 offen sc1
    v_cvt_pk_bf16_f32 v101, v70, v71
    v_mfma_f32_16x16x32_bf16 v[220:223], v[36:39], v[192:195], 0
    v_cvt_pk_bf16_f32 v102, v76, v77
    v_cvt_pk_bf16_f32 v103, v78, v79
    v_mfma_f32_16x16x32_bf16 v[84:87], v[40:43], v[72:75], v[84:87]
    ds_read_b64_tr_b16 v[32:33], v4 offset:57344
    s_lshl_b32 s75, s5, 10
    v_mfma_f32_16x16x32_bf16 v[148:151], v[40:43], v[136:139], v[148:151]
    ds_read_b64_tr_b16 v[34:35], v4 offset:58368
    v_mfma_f32_16x16x32_bf16 v[212:215], v[40:43], v[200:203], v[212:215]
    buffer_load_dwordx4 v18, s[24:27], s49 offen offset:1024 lds
    s_waitcnt lgkmcnt(8)
    v_mfma_f32_16x16x32_bf16 v[92:95], v[44:47], v[72:75], v[92:95]
    ds_read_b64_tr_b16 v[36:37], v5 offset:57344
    v_mfma_f32_16x16x32_bf16 v[156:159], v[44:47], v[136:139], v[156:159]
    ds_read_b64_tr_b16 v[38:39], v5 offset:58368
    v_mfma_f32_16x16x32_bf16 v[220:223], v[44:47], v[200:203], v[220:223]
    buffer_store_dwordx4 v[100:103], v8, s[32:35], s69 offen offset:0 sc1
    v_cvt_pk_bf16_f32 v164, v132, v133
    v_mfma_f32_16x16x32_bf16 v[84:87], v[48:51], a[0:3], v[84:87]
    ds_read_b64_tr_b16 v[40:41], v4 offset:59392
    s_add_u32 s74, s74, s75
    v_cvt_pk_bf16_f32 v165, v134, v135
    v_mfma_f32_16x16x32_bf16 v[148:151], v[48:51], a[32:35], v[148:151]
    ds_read_b64_tr_b16 v[42:43], v4 offset:60416
    v_cvt_pk_bf16_f32 v166, v140, v141
    v_mfma_f32_16x16x32_bf16 v[212:215], v[48:51], a[64:67], v[212:215]
    buffer_load_dwordx4 v18, s[24:27], s50 offen offset:2048 lds
    s_waitcnt lgkmcnt(8)
    v_cvt_pk_bf16_f32 v167, v142, v143
    v_mfma_f32_16x16x32_bf16 v[92:95], v[52:55], a[0:3], v[92:95]
    ds_read_b64_tr_b16 v[44:45], v5 offset:59392
    v_mfma_f32_16x16x32_bf16 v[156:159], v[52:55], a[32:35], v[156:159]
    ds_read_b64_tr_b16 v[46:47], v5 offset:60416
    v_mfma_f32_16x16x32_bf16 v[220:223], v[52:55], a[64:67], v[220:223]
    buffer_load_dwordx4 v18, s[24:27], s51 offen offset:3072 lds
    v_add_u32 v18, 32768, v18
    v_mfma_f32_16x16x32_bf16 v[84:87], v[56:59], a[4:7], v[84:87]
    ds_read_b64_tr_b16 v[48:49], v6 offset:57344
    v_mfma_f32_16x16x32_bf16 v[148:151], v[56:59], a[36:39], v[148:151]
    ds_read_b64_tr_b16 v[50:51], v6 offset:58368
    s_lshl_b32 s75, s7, 6
    v_mfma_f32_16x16x32_bf16 v[212:215], v[56:59], a[68:71], v[212:215]
    buffer_store_dwordx4 v[164:167], v8, s[32:35], s69 offen offset:1024 sc1
    s_waitcnt lgkmcnt(8)
    v_cvt_pk_bf16_f32 v228, v196, v197
    v_mfma_f32_16x16x32_bf16 v[92:95], v[60:63], a[4:7], v[92:95]
    ds_read_b64_tr_b16 v[52:53], v7 offset:57344
    v_cvt_pk_bf16_f32 v229, v198, v199
    v_mfma_f32_16x16x32_bf16 v[156:159], v[60:63], a[36:39], v[156:159]
    ds_read_b64_tr_b16 v[54:55], v7 offset:58368
    v_cvt_pk_bf16_f32 v230, v204, v205
    v_mfma_f32_16x16x32_bf16 v[220:223], v[60:63], a[68:71], v[220:223]
    v_cvt_pk_bf16_f32 v231, v206, v207
    v_mfma_f32_16x16x32_bf16 v[84:87], v[32:35], v[80:83], v[84:87]
    ds_read_b64_tr_b16 v[56:57], v6 offset:59392
    v_mfma_f32_16x16x32_bf16 v[148:151], v[32:35], v[144:147], v[148:151]
    ds_read_b64_tr_b16 v[58:59], v6 offset:60416
    v_mfma_f32_16x16x32_bf16 v[212:215], v[32:35], v[208:211], v[212:215]
    buffer_store_dwordx4 v[228:231], v8, s[32:35], s69 offen offset:2048 sc1
    s_add_u32 s74, s74, s75
    s_waitcnt lgkmcnt(8)
    v_mfma_f32_16x16x32_bf16 v[92:95], v[36:39], v[80:83], v[92:95]
    ds_read_b64_tr_b16 v[60:61], v7 offset:59392
    v_mfma_f32_16x16x32_bf16 v[156:159], v[36:39], v[144:147], v[156:159]
    ds_read_b64_tr_b16 v[62:63], v7 offset:60416
    v_mfma_f32_16x16x32_bf16 v[220:223], v[36:39], v[208:211], v[220:223]
    s_waitcnt vmcnt(17)
    s_barrier
    v_mfma_f32_16x16x32_bf16 v[84:87], v[40:43], v[88:91], v[84:87]
    ds_read_b64_tr_b16 v[32:33], v4 offset:0
    v_mfma_f32_16x16x32_bf16 v[148:151], v[40:43], v[152:155], v[148:151]
    ds_read_b64_tr_b16 v[34:35], v4 offset:1024
    s_add_u32 m0, s54, 57344
    v_mfma_f32_16x16x32_bf16 v[212:215], v[40:43], v[216:219], v[212:215]
    buffer_load_dwordx4 v18, s[24:27], 0 offen offset:0 lds
    s_add_u32 s40, s74, s58
    s_waitcnt lgkmcnt(8)
    v_mfma_f32_16x16x32_bf16 v[92:95], v[44:47], v[88:91], v[92:95]
    ds_read_b64_tr_b16 v[36:37], v5 offset:0
    v_mfma_f32_16x16x32_bf16 v[156:159], v[44:47], v[152:155], v[156:159]
    ds_read_b64_tr_b16 v[38:39], v5 offset:1024
    v_mfma_f32_16x16x32_bf16 v[220:223], v[44:47], v[216:219], v[220:223]
    buffer_load_dwordx4 v18, s[24:27], s49 offen offset:1024 lds
    v_mfma_f32_16x16x32_bf16 v[84:87], v[48:51], a[8:11], v[84:87]
    ds_read_b64_tr_b16 v[40:41], v4 offset:2048
    v_mfma_f32_16x16x32_bf16 v[148:151], v[48:51], a[40:43], v[148:151]
    ds_read_b64_tr_b16 v[42:43], v4 offset:3072
    v_mfma_f32_16x16x32_bf16 v[212:215], v[48:51], a[72:75], v[212:215]
    s_waitcnt lgkmcnt(8)
    v_mfma_f32_16x16x32_bf16 v[92:95], v[52:55], a[8:11], v[92:95]
    ds_read_b64_tr_b16 v[44:45], v5 offset:2048
    s_add_u32 s41, s40, 0x8000
    v_mfma_f32_16x16x32_bf16 v[156:159], v[52:55], a[40:43], v[156:159]
    ds_read_b64_tr_b16 v[46:47], v5 offset:3072
    v_mfma_f32_16x16x32_bf16 v[220:223], v[52:55], a[72:75], v[220:223]
    buffer_load_dwordx4 v18, s[24:27], s50 offen offset:2048 lds
    v_mfma_f32_16x16x32_bf16 v[84:87], v[56:59], a[12:15], v[84:87]
    ds_read_b64_tr_b16 v[48:49], v6 offset:0
    v_mfma_f32_16x16x32_bf16 v[148:151], v[56:59], a[44:47], v[148:151]
    ds_read_b64_tr_b16 v[50:51], v6 offset:1024
    v_mfma_f32_16x16x32_bf16 v[212:215], v[56:59], a[76:79], v[212:215]
    s_waitcnt lgkmcnt(8)
    v_mfma_f32_16x16x32_bf16 v[92:95], v[60:63], a[12:15], v[92:95]
    ds_read_b64_tr_b16 v[52:53], v7 offset:0
    s_add_u32 s42, s40, 0x10000
    v_mfma_f32_16x16x32_bf16 v[156:159], v[60:63], a[44:47], v[156:159]
    ds_read_b64_tr_b16 v[54:55], v7 offset:1024
    v_mfma_f32_16x16x32_bf16 v[220:223], v[60:63], a[76:79], v[220:223]
    buffer_load_dwordx4 v18, s[24:27], s51 offen offset:3072 lds
    v_add_u32 v18, s64, v19
    v_mfma_f32_16x16x32_bf16 v[84:87], v[32:35], v[96:99], v[84:87]
    ds_read_b64_tr_b16 v[56:57], v6 offset:2048
    v_mfma_f32_16x16x32_bf16 v[148:151], v[32:35], v[160:163], v[148:151]
    ds_read_b64_tr_b16 v[58:59], v6 offset:3072
    s_add_u32 m0, s54, 32768
    v_mfma_f32_16x16x32_bf16 v[212:215], v[32:35], v[224:227], v[212:215]
    buffer_load_dwordx4 v18, s[24:27], 0 offen offset:0 lds
    s_waitcnt lgkmcnt(8)
    v_mfma_f32_16x16x32_bf16 v[92:95], v[36:39], v[96:99], v[92:95]
    ds_read_b64_tr_b16 v[60:61], v7 offset:2048
    v_mfma_f32_16x16x32_bf16 v[156:159], v[36:39], v[160:163], v[156:159]
    ds_read_b64_tr_b16 v[62:63], v7 offset:3072
    v_lshl_add_u32 v21, v0, 4, v9
    v_mfma_f32_16x16x32_bf16 v[220:223], v[36:39], v[224:227], v[220:223]
    v_mfma_f32_16x16x32_bf16 v[84:87], v[40:43], v[104:107], v[84:87]
    ds_read_b64_tr_b16 v[32:33], v4 offset:24576
    v_mfma_f32_16x16x32_bf16 v[148:151], v[40:43], v[168:171], v[148:151]
    ds_read_b64_tr_b16 v[34:35], v4 offset:25600
    v_mfma_f32_16x16x32_bf16 v[212:215], v[40:43], v[232:235], v[212:215]
    buffer_load_dwordx4 v18, s[24:27], s49 offen offset:1024 lds
    s_waitcnt lgkmcnt(8)
    v_mfma_f32_16x16x32_bf16 v[92:95], v[44:47], v[104:107], v[92:95]
    ds_read_b64_tr_b16 v[36:37], v5 offset:24576
    v_mfma_f32_16x16x32_bf16 v[156:159], v[44:47], v[168:171], v[156:159]
    ds_read_b64_tr_b16 v[38:39], v5 offset:25600
    v_mfma_f32_16x16x32_bf16 v[220:223], v[44:47], v[232:235], v[220:223]
    v_mfma_f32_16x16x32_bf16 v[84:87], v[48:51], a[16:19], v[84:87]
    ds_read_b64_tr_b16 v[40:41], v4 offset:26624
    v_mfma_f32_16x16x32_bf16 v[148:151], v[48:51], a[48:51], v[148:151]
    ds_read_b64_tr_b16 v[42:43], v4 offset:27648
    v_mfma_f32_16x16x32_bf16 v[212:215], v[48:51], a[80:83], v[212:215]
    buffer_load_dwordx4 v18, s[24:27], s50 offen offset:2048 lds
    s_waitcnt vmcnt(13)
    s_waitcnt lgkmcnt(8)
    v_cmp_ne_u32 s[76:77], 1, v29
    v_mfma_f32_16x16x32_bf16 v[92:95], v[52:55], a[16:19], v[92:95]
    ds_read_b64_tr_b16 v[44:45], v5 offset:26624
    s_lshl_b64 s[76:77], s[76:77], 48
    s_cbranch_scc1 L_fwaitc
L_fokc:
    v_mfma_f32_16x16x32_bf16 v[156:159], v[52:55], a[48:51], v[156:159]
    ds_read_b64_tr_b16 v[46:47], v5 offset:27648
    v_mfma_f32_16x16x32_bf16 v[220:223], v[52:55], a[80:83], v[220:223]
    buffer_load_dwordx4 v18, s[24:27], s51 offen offset:3072 lds
    v_add_u32 v18, 32768, v18
    v_mfma_f32_16x16x32_bf16 v[84:87], v[56:59], a[20:23], v[84:87]
    ds_read_b64_tr_b16 v[48:49], v6 offset:24576
    v_mfma_f32_16x16x32_bf16 v[148:151], v[56:59], a[52:55], v[148:151]
    ds_read_b64_tr_b16 v[50:51], v6 offset:25600
    v_mfma_f32_16x16x32_bf16 v[212:215], v[56:59], a[84:87], v[212:215]
    buffer_load_dwordx4 a[96:99], v21, s[32:35], s43 offen offset:0 sc1
    s_waitcnt lgkmcnt(8)
    v_mfma_f32_16x16x32_bf16 v[92:95], v[60:63], a[20:23], v[92:95]
    ds_read_b64_tr_b16 v[52:53], v7 offset:24576
    v_mfma_f32_16x16x32_bf16 v[156:159], v[60:63], a[52:55], v[156:159]
    ds_read_b64_tr_b16 v[54:55], v7 offset:25600
    v_mfma_f32_16x16x32_bf16 v[220:223], v[60:63], a[84:87], v[220:223]
    buffer_load_dwordx4 a[100:103], v21, s[32:35], s43 offen offset:1024 sc1
    v_mfma_f32_16x16x32_bf16 v[84:87], v[32:35], v[112:115], v[84:87]
    ds_read_b64_tr_b16 v[56:57], v6 offset:26624
    buffer_load_dwordx4 a[104:107], v21, s[32:35], s43 offen offset:2048 sc1
    v_mfma_f32_16x16x32_bf16 v[148:151], v[32:35], v[176:179], v[148:151]
    ds_read_b64_tr_b16 v[58:59], v6 offset:27648
    v_mfma_f32_16x16x32_bf16 v[212:215], v[32:35], v[240:243], v[212:215]
    s_waitcnt lgkmcnt(8)
    v_mfma_f32_16x16x32_bf16 v[92:95], v[36:39], v[112:115], v[92:95]
    ds_read_b64_tr_b16 v[60:61], v7 offset:26624
    v_mfma_f32_16x16x32_bf16 v[156:159], v[36:39], v[176:179], v[156:159]
    ds_read_b64_tr_b16 v[62:63], v7 offset:27648
    v_mfma_f32_16x16x32_bf16 v[220:223], v[36:39], v[240:243], v[220:223]
    s_barrier
    v_mfma_f32_16x16x32_bf16 v[84:87], v[40:43], v[120:123], v[84:87]
    ds_read_b64_tr_b16 v[32:33], v4 offset:32768
    v_mfma_f32_16x16x32_bf16 v[148:151], v[40:43], v[184:187], v[148:151]
    ds_read_b64_tr_b16 v[34:35], v4 offset:33792
    s_add_u32 m0, s54, 73728
    v_mfma_f32_16x16x32_bf16 v[212:215], v[40:43], v[248:251], v[212:215]
    buffer_load_dwordx4 v18, s[24:27], 0 offen offset:0 lds
    s_waitcnt lgkmcnt(8)
    v_mfma_f32_16x16x32_bf16 v[92:95], v[44:47], v[120:123], v[92:95]
    ds_read_b64_tr_b16 v[36:37], v5 offset:32768
    v_mfma_f32_16x16x32_bf16 v[156:159], v[44:47], v[184:187], v[156:159]
    ds_read_b64_tr_b16 v[38:39], v5 offset:33792
    v_mfma_f32_16x16x32_bf16 v[220:223], v[44:47], v[248:251], v[220:223]
    buffer_load_dwordx4 v18, s[24:27], s49 offen offset:1024 lds
    v_mfma_f32_16x16x32_bf16 v[84:87], v[48:51], a[24:27], v[84:87]
    ds_read_b64_tr_b16 v[40:41], v4 offset:34816
    v_mfma_f32_16x16x32_bf16 v[148:151], v[48:51], a[56:59], v[148:151]
    ds_read_b64_tr_b16 v[42:43], v4 offset:35840
    v_mfma_f32_16x16x32_bf16 v[212:215], v[48:51], a[88:91], v[212:215]
    s_waitcnt lgkmcnt(8)
    v_mfma_f32_16x16x32_bf16 v[92:95], v[52:55], a[24:27], v[92:95]
    ds_read_b64_tr_b16 v[44:45], v5 offset:34816
    v_mfma_f32_16x16x32_bf16 v[156:159], v[52:55], a[56:59], v[156:159]
    ds_read_b64_tr_b16 v[46:47], v5 offset:35840
    s_waitcnt vmcnt(13)
    s_mov_b64 exec, 1
    buffer_store_dword v11, v9, s[32:35], s69 offen offset:12 sc1
    s_mov_b64 exec, -1
    v_mfma_f32_16x16x32_bf16 v[220:223], v[52:55], a[88:91], v[220:223]
    buffer_load_dwordx4 v18, s[24:27], s50 offen offset:2048 lds
    v_mfma_f32_16x16x32_bf16 v[84:87], v[56:59], a[28:31], v[84:87]
    ds_read_b64_tr_b16 v[48:49], v6 offset:32768
    v_mfma_f32_16x16x32_bf16 v[148:151], v[56:59], a[60:63], v[148:151]
    ds_read_b64_tr_b16 v[50:51], v6 offset:33792
    v_mfma_f32_16x16x32_bf16 v[212:215], v[56:59], a[92:95], v[212:215]
    s_waitcnt lgkmcnt(8)
    v_mfma_f32_16x16x32_bf16 v[92:95], v[60:63], a[28:31], v[92:95]
    ds_read_b64_tr_b16 v[52:53], v7 offset:32768
    v_mfma_f32_16x16x32_bf16 v[156:159], v[60:63], a[60:63], v[156:159]
    ds_read_b64_tr_b16 v[54:55], v7 offset:33792
    v_mfma_f32_16x16x32_bf16 v[220:223], v[60:63], a[92:95], v[220:223]
    buffer_load_dwordx4 v18, s[24:27], s51 offen offset:3072 lds
    v_add_u32 v18, 32768, v18
    v_mfma_f32_16x16x32_bf16 v[68:71], v[32:35], v[64:67], 0
    ds_read_b64_tr_b16 v[56:57], v6 offset:34816
    v_mfma_f32_16x16x32_bf16 v[132:135], v[32:35], v[128:131], 0
    ds_read_b64_tr_b16 v[58:59], v6 offset:35840
    s_add_u32 m0, s54, 16384
    v_mfma_f32_16x16x32_bf16 v[196:199], v[32:35], v[192:195], 0
    buffer_load_dwordx4 v18, s[24:27], 0 offen offset:0 lds
    s_waitcnt lgkmcnt(8)
    v_add_u32 v8, 12288, v8
    v_mfma_f32_16x16x32_bf16 v[76:79], v[36:39], v[64:67], 0
    ds_read_b64_tr_b16 v[60:61], v7 offset:34816
    v_cvt_pk_bf16_f32 v100, v84, v85
    v_mfma_f32_16x16x32_bf16 v[140:143], v[36:39], v[128:131], 0
    ds_read_b64_tr_b16 v[62:63], v7 offset:35840
    buffer_load_dword v29, v10, s[32:35], s66 offen sc1
    v_cvt_pk_bf16_f32 v101, v86, v87
    v_mfma_f32_16x16x32_bf16 v[204:207], v[36:39], v[192:195], 0
    v_cvt_pk_bf16_f32 v102, v92, v93
    v_cvt_pk_bf16_f32 v103, v94, v95
    v_mfma_f32_16x16x32_bf16 v[68:71], v[40:43], v[72:75], v[68:71]
    ds_read_b64_tr_b16 v[32:33], v4 offset:8192
    v_mfma_f32_16x16x32_bf16 v[132:135], v[40:43], v[136:139], v[132:135]
    ds_read_b64_tr_b16 v[34:35], v4 offset:9216
    v_mfma_f32_16x16x32_bf16 v[196:199], v[40:43], v[200:203], v[196:199]
    buffer_load_dwordx4 v18, s[24:27], s49 offen offset:1024 lds
    s_waitcnt lgkmcnt(8)
    v_mfma_f32_16x16x32_bf16 v[76:79], v[44:47], v[72:75], v[76:79]
    ds_read_b64_tr_b16 v[36:37], v5 offset:8192
    v_mfma_f32_16x16x32_bf16 v[140:143], v[44:47], v[136:139], v[140:143]
    ds_read_b64_tr_b16 v[38:39], v5 offset:9216
    v_mfma_f32_16x16x32_bf16 v[204:207], v[44:47], v[200:203], v[204:207]
    buffer_store_dwordx4 v[100:103], v8, s[32:35], s70 offen offset:0 sc1
    v_cvt_pk_bf16_f32 v164, v148, v149
    v_mfma_f32_16x16x32_bf16 v[68:71], v[48:51], a[0:3], v[68:71]
    ds_read_b64_tr_b16 v[40:41], v4 offset:10240
    v_cvt_pk_bf16_f32 v165, v150, v151
    v_mfma_f32_16x16x32_bf16 v[132:135], v[48:51], a[32:35], v[132:135]
    ds_read_b64_tr_b16 v[42:43], v4 offset:11264
    v_cvt_pk_bf16_f32 v166, v156, v157
    v_mfma_f32_16x16x32_bf16 v[196:199], v[48:51], a[64:67], v[196:199]
    buffer_load_dwordx4 v18, s[24:27], s50 offen offset:2048 lds
    s_waitcnt lgkmcnt(8)
    v_cvt_pk_bf16_f32 v167, v158, v159
    v_mfma_f32_16x16x32_bf16 v[76:79], v[52:55], a[0:3], v[76:79]
    ds_read_b64_tr_b16 v[44:45], v5 offset:10240
    v_mfma_f32_16x16x32_bf16 v[140:143], v[52:55], a[32:35], v[140:143]
    ds_read_b64_tr_b16 v[46:47], v5 offset:11264
    v_mfma_f32_16x16x32_bf16 v[204:207], v[52:55], a[64:67], v[204:207]
    buffer_load_dwordx4 v18, s[24:27], s51 offen offset:3072 lds
    v_add_u32 v18, 32768, v18
    v_mfma_f32_16x16x32_bf16 v[68:71], v[56:59], a[4:7], v[68:71]
    ds_read_b64_tr_b16 v[48:49], v6 offset:8192
    v_mfma_f32_16x16x32_bf16 v[132:135], v[56:59], a[36:39], v[132:135]
    ds_read_b64_tr_b16 v[50:51], v6 offset:9216
    v_mfma_f32_16x16x32_bf16 v[196:199], v[56:59], a[68:71], v[196:199]
    buffer_store_dwordx4 v[164:167], v8, s[32:35], s70 offen offset:1024 sc1
    s_waitcnt lgkmcnt(8)
    v_cvt_pk_bf16_f32 v228, v212, v213
    v_mfma_f32_16x16x32_bf16 v[76:79], v[60:63], a[4:7], v[76:79]
    ds_read_b64_tr_b16 v[52:53], v7 offset:8192
    v_cvt_pk_bf16_f32 v229, v214, v215
    v_mfma_f32_16x16x32_bf16 v[140:143], v[60:63], a[36:39], v[140:143]
    ds_read_b64_tr_b16 v[54:55], v7 offset:9216
    v_cvt_pk_bf16_f32 v230, v220, v221
    v_mfma_f32_16x16x32_bf16 v[204:207], v[60:63], a[68:71], v[204:207]
    v_cvt_pk_bf16_f32 v231, v222, v223
    v_mfma_f32_16x16x32_bf16 v[68:71], v[32:35], v[80:83], v[68:71]
    ds_read_b64_tr_b16 v[56:57], v6 offset:10240
    v_mfma_f32_16x16x32_bf16 v[132:135], v[32:35], v[144:147], v[132:135]
    ds_read_b64_tr_b16 v[58:59], v6 offset:11264
    v_mfma_f32_16x16x32_bf16 v[196:199], v[32:35], v[208:211], v[196:199]
    buffer_store_dwordx4 v[228:231], v8, s[32:35], s70 offen offset:2048 sc1
    s_waitcnt lgkmcnt(8)
    v_mfma_f32_16x16x32_bf16 v[76:79], v[36:39], v[80:83], v[76:79]
    ds_read_b64_tr_b16 v[60:61], v7 offset:10240
    v_mfma_f32_16x16x32_bf16 v[140:143], v[36:39], v[144:147], v[140:143]
    ds_read_b64_tr_b16 v[62:63], v7 offset:11264
    v_mfma_f32_16x16x32_bf16 v[204:207], v[36:39], v[208:211], v[204:207]
    s_waitcnt vmcnt(20)
    s_barrier
    v_mfma_f32_16x16x32_bf16 v[68:71], v[40:43], v[88:91], v[68:71]
    ds_read_b64_tr_b16 v[32:33], v4 offset:49152
    v_mfma_f32_16x16x32_bf16 v[132:135], v[40:43], v[152:155], v[132:135]
    ds_read_b64_tr_b16 v[34:35], v4 offset:50176
    s_add_u32 m0, s54, 40960
    v_mfma_f32_16x16x32_bf16 v[196:199], v[40:43], v[216:219], v[196:199]
    buffer_load_dwordx4 v18, s[24:27], 0 offen offset:0 lds
    s_waitcnt lgkmcnt(8)
    v_mfma_f32_16x16x32_bf16 v[76:79], v[44:47], v[88:91], v[76:79]
    ds_read_b64_tr_b16 v[36:37], v5 offset:49152
    v_mfma_f32_16x16x32_bf16 v[140:143], v[44:47], v[152:155], v[140:143]
    ds_read_b64_tr_b16 v[38:39], v5 offset:50176
    v_mfma_f32_16x16x32_bf16 v[204:207], v[44:47], v[216:219], v[204:207]
    buffer_load_dwordx4 v18, s[24:27], s49 offen offset:1024 lds
    v_mfma_f32_16x16x32_bf16 v[68:71], v[48:51], a[8:11], v[68:71]
    ds_read_b64_tr_b16 v[40:41], v4 offset:51200
    v_mfma_f32_16x16x32_bf16 v[132:135], v[48:51], a[40:43], v[132:135]
    ds_read_b64_tr_b16 v[42:43], v4 offset:52224
    v_mfma_f32_16x16x32_bf16 v[196:199], v[48:51], a[72:75], v[196:199]
    s_waitcnt lgkmcnt(8)
    v_mfma_f32_16x16x32_bf16 v[76:79], v[52:55], a[8:11], v[76:79]
    ds_read_b64_tr_b16 v[44:45], v5 offset:51200
    v_mfma_f32_16x16x32_bf16 v[140:143], v[52:55], a[40:43], v[140:143]
    ds_read_b64_tr_b16 v[46:47], v5 offset:52224
    v_mfma_f32_16x16x32_bf16 v[204:207], v[52:55], a[72:75], v[204:207]
    buffer_load_dwordx4 v18, s[24:27], s50 offen offset:2048 lds
    v_mfma_f32_16x16x32_bf16 v[68:71], v[56:59], a[12:15], v[68:71]
    ds_read_b64_tr_b16 v[48:49], v6 offset:49152
    v_mfma_f32_16x16x32_bf16 v[132:135], v[56:59], a[44:47], v[132:135]
    ds_read_b64_tr_b16 v[50:51], v6 offset:50176
    v_mfma_f32_16x16x32_bf16 v[196:199], v[56:59], a[76:79], v[196:199]
    s_waitcnt lgkmcnt(8)
    v_mfma_f32_16x16x32_bf16 v[76:79], v[60:63], a[12:15], v[76:79]
    ds_read_b64_tr_b16 v[52:53], v7 offset:49152
    v_mfma_f32_16x16x32_bf16 v[140:143], v[60:63], a[44:47], v[140:143]
    ds_read_b64_tr_b16 v[54:55], v7 offset:50176
    v_mfma_f32_16x16x32_bf16 v[204:207], v[60:63], a[76:79], v[204:207]
    buffer_load_dwordx4 v18, s[24:27], s51 offen offset:3072 lds
    v_add_u32 v18, s65, v19
    v_mfma_f32_16x16x32_bf16 v[68:71], v[32:35], v[96:99], v[68:71]
    ds_read_b64_tr_b16 v[56:57], v6 offset:51200
    v_mfma_f32_16x16x32_bf16 v[132:135], v[32:35], v[160:163], v[132:135]
    ds_read_b64_tr_b16 v[58:59], v6 offset:52224
    s_add_u32 m0, s54, 49152
    v_mfma_f32_16x16x32_bf16 v[196:199], v[32:35], v[224:227], v[196:199]
    buffer_load_dwordx4 v18, s[24:27], 0 offen offset:0 lds
    s_waitcnt lgkmcnt(8)
    v_mfma_f32_16x16x32_bf16 v[76:79], v[36:39], v[96:99], v[76:79]
    ds_read_b64_tr_b16 v[60:61], v7 offset:51200
    v_mfma_f32_16x16x32_bf16 v[140:143], v[36:39], v[160:163], v[140:143]
    ds_read_b64_tr_b16 v[62:63], v7 offset:52224
    v_mfma_f32_16x16x32_bf16 v[204:207], v[36:39], v[224:227], v[204:207]
    v_mfma_f32_16x16x32_bf16 v[68:71], v[40:43], v[104:107], v[68:71]
    ds_read_b64_tr_b16 v[32:33], v4 offset:40960
    v_mfma_f32_16x16x32_bf16 v[132:135], v[40:43], v[168:171], v[132:135]
    ds_read_b64_tr_b16 v[34:35], v4 offset:41984
    v_mfma_f32_16x16x32_bf16 v[196:199], v[40:43], v[232:235], v[196:199]
    buffer_load_dwordx4 v18, s[24:27], s49 offen offset:1024 lds
    s_waitcnt lgkmcnt(8)
    v_mfma_f32_16x16x32_bf16 v[76:79], v[44:47], v[104:107], v[76:79]
    ds_read_b64_tr_b16 v[36:37], v5 offset:40960
    v_mfma_f32_16x16x32_bf16 v[140:143], v[44:47], v[168:171], v[140:143]
    ds_read_b64_tr_b16 v[38:39], v5 offset:41984
    v_mfma_f32_16x16x32_bf16 v[204:207], v[44:47], v[232:235], v[204:207]
    v_mfma_f32_16x16x32_bf16 v[68:71], v[48:51], a[16:19], v[68:71]
    ds_read_b64_tr_b16 v[40:41], v4 offset:43008
    v_mfma_f32_16x16x32_bf16 v[132:135], v[48:51], a[48:51], v[132:135]
    ds_read_b64_tr_b16 v[42:43], v4 offset:44032
    v_mfma_f32_16x16x32_bf16 v[196:199], v[48:51], a[80:83], v[196:199]
    buffer_load_dwordx4 v18, s[24:27], s50 offen offset:2048 lds
    s_waitcnt vmcnt(13)
    s_waitcnt lgkmcnt(8)
    v_cmp_ne_u32 s[76:77], 1, v29
    v_mfma_f32_16x16x32_bf16 v[76:79], v[52:55], a[16:19], v[76:79]
    ds_read_b64_tr_b16 v[44:45], v5 offset:43008
    s_lshl_b64 s[76:77], s[76:77], 40
    s_cbranch_scc1 L_fwaitd
L_fokd:
    v_mfma_f32_16x16x32_bf16 v[140:143], v[52:55], a[48:51], v[140:143]
    ds_read_b64_tr_b16 v[46:47], v5 offset:44032
    v_mfma_f32_16x16x32_bf16 v[204:207], v[52:55], a[80:83], v[204:207]
    buffer_load_dwordx4 v18, s[24:27], s51 offen offset:3072 lds
    v_add_u32 v18, 32768, v18
    v_mfma_f32_16x16x32_bf16 v[68:71], v[56:59], a[20:23], v[68:71]
    ds_read_b64_tr_b16 v[48:49], v6 offset:40960
    v_mfma_f32_16x16x32_bf16 v[132:135], v[56:59], a[52:55], v[132:135]
    ds_read_b64_tr_b16 v[50:51], v6 offset:41984
    v_mfma_f32_16x16x32_bf16 v[196:199], v[56:59], a[84:87], v[196:199]
    buffer_load_dwordx4 a[108:111], v21, s[32:35], s44 offen offset:0 sc1
    s_waitcnt lgkmcnt(8)
    v_mfma_f32_16x16x32_bf16 v[76:79], v[60:63], a[20:23], v[76:79]
    ds_read_b64_tr_b16 v[52:53], v7 offset:40960
    v_mfma_f32_16x16x32_bf16 v[140:143], v[60:63], a[52:55], v[140:143]
    ds_read_b64_tr_b16 v[54:55], v7 offset:41984
    v_mfma_f32_16x16x32_bf16 v[204:207], v[60:63], a[84:87], v[204:207]
    buffer_load_dwordx4 a[112:115], v21, s[32:35], s44 offen offset:1024 sc1
    v_mfma_f32_16x16x32_bf16 v[68:71], v[32:35], v[112:115], v[68:71]
    ds_read_b64_tr_b16 v[56:57], v6 offset:43008
    buffer_load_dwordx4 a[116:119], v21, s[32:35], s44 offen offset:2048 sc1
    v_mfma_f32_16x16x32_bf16 v[132:135], v[32:35], v[176:179], v[132:135]
    ds_read_b64_tr_b16 v[58:59], v6 offset:44032
    v_mfma_f32_16x16x32_bf16 v[196:199], v[32:35], v[240:243], v[196:199]
    s_waitcnt lgkmcnt(8)
    v_mfma_f32_16x16x32_bf16 v[76:79], v[36:39], v[112:115], v[76:79]
    ds_read_b64_tr_b16 v[60:61], v7 offset:43008
    v_mfma_f32_16x16x32_bf16 v[140:143], v[36:39], v[176:179], v[140:143]
    ds_read_b64_tr_b16 v[62:63], v7 offset:44032
    v_mfma_f32_16x16x32_bf16 v[204:207], v[36:39], v[240:243], v[204:207]
    s_barrier
    v_mfma_f32_16x16x32_bf16 v[68:71], v[40:43], v[120:123], v[68:71]
    ds_read_b64_tr_b16 v[32:33], v4 offset:16384
    v_mfma_f32_16x16x32_bf16 v[132:135], v[40:43], v[184:187], v[132:135]
    ds_read_b64_tr_b16 v[34:35], v4 offset:17408
    s_add_u32 m0, s54, 24576
    v_mfma_f32_16x16x32_bf16 v[196:199], v[40:43], v[248:251], v[196:199]
    buffer_load_dwordx4 v18, s[24:27], 0 offen offset:0 lds
    s_waitcnt lgkmcnt(8)
    v_mfma_f32_16x16x32_bf16 v[76:79], v[44:47], v[120:123], v[76:79]
    ds_read_b64_tr_b16 v[36:37], v5 offset:16384
    v_mfma_f32_16x16x32_bf16 v[140:143], v[44:47], v[184:187], v[140:143]
    ds_read_b64_tr_b16 v[38:39], v5 offset:17408
    v_mfma_f32_16x16x32_bf16 v[204:207], v[44:47], v[248:251], v[204:207]
    buffer_load_dwordx4 v18, s[24:27], s49 offen offset:1024 lds
    v_mfma_f32_16x16x32_bf16 v[68:71], v[48:51], a[24:27], v[68:71]
    ds_read_b64_tr_b16 v[40:41], v4 offset:18432
    v_mfma_f32_16x16x32_bf16 v[132:135], v[48:51], a[56:59], v[132:135]
    ds_read_b64_tr_b16 v[42:43], v4 offset:19456
    v_mfma_f32_16x16x32_bf16 v[196:199], v[48:51], a[88:91], v[196:199]
    s_waitcnt lgkmcnt(8)
    v_mfma_f32_16x16x32_bf16 v[76:79], v[52:55], a[24:27], v[76:79]
    ds_read_b64_tr_b16 v[44:45], v5 offset:18432
    v_mfma_f32_16x16x32_bf16 v[140:143], v[52:55], a[56:59], v[140:143]
    ds_read_b64_tr_b16 v[46:47], v5 offset:19456
    s_waitcnt vmcnt(13)
    s_mov_b64 exec, 1
    buffer_store_dword v11, v9, s[32:35], s70 offen offset:16 sc1
    s_mov_b64 exec, -1
    v_mfma_f32_16x16x32_bf16 v[204:207], v[52:55], a[88:91], v[204:207]
    buffer_load_dwordx4 v18, s[24:27], s50 offen offset:2048 lds
    v_mfma_f32_16x16x32_bf16 v[68:71], v[56:59], a[28:31], v[68:71]
    ds_read_b64_tr_b16 v[48:49], v6 offset:16384
    v_mfma_f32_16x16x32_bf16 v[132:135], v[56:59], a[60:63], v[132:135]
    ds_read_b64_tr_b16 v[50:51], v6 offset:17408
    v_mfma_f32_16x16x32_bf16 v[196:199], v[56:59], a[92:95], v[196:199]
    s_waitcnt lgkmcnt(8)
    v_mfma_f32_16x16x32_bf16 v[76:79], v[60:63], a[28:31], v[76:79]
    ds_read_b64_tr_b16 v[52:53], v7 offset:16384
    v_mfma_f32_16x16x32_bf16 v[140:143], v[60:63], a[60:63], v[140:143]
    ds_read_b64_tr_b16 v[54:55], v7 offset:17408
    v_mfma_f32_16x16x32_bf16 v[204:207], v[60:63], a[92:95], v[204:207]
    buffer_load_dwordx4 v18, s[24:27], s51 offen offset:3072 lds
    v_add_u32 v18, 32768, v18
    v_mfma_f32_16x16x32_bf16 v[84:87], v[32:35], v[64:67], 0
    ds_read_b64_tr_b16 v[56:57], v6 offset:18432
    v_mfma_f32_16x16x32_bf16 v[148:151], v[32:35], v[128:131], 0
    ds_read_b64_tr_b16 v[58:59], v6 offset:19456
    s_add_u32 m0, s54, 65536
    v_mfma_f32_16x16x32_bf16 v[212:215], v[32:35], v[192:195], 0
    buffer_load_dwordx4 v18, s[24:27], 0 offen offset:0 lds
    s_waitcnt lgkmcnt(8)
    v_add_u32 v8, 12288, v8
    v_mfma_f32_16x16x32_bf16 v[92:95], v[36:39], v[64:67], 0
    ds_read_b64_tr_b16 v[60:61], v7 offset:18432
    v_cvt_pk_bf16_f32 v100, v68, v69
    v_mfma_f32_16x16x32_bf16 v[156:159], v[36:39], v[128:131], 0
    ds_read_b64_tr_b16 v[62:63], v7 offset:19456
    buffer_load_dword v29, v10, s[32:35], s66 offen sc1
    v_cvt_pk_bf16_f32 v101, v70, v71
    v_mfma_f32_16x16x32_bf16 v[220:223], v[36:39], v[192:195], 0
    v_cvt_pk_bf16_f32 v102, v76, v77
    v_cvt_pk_bf16_f32 v103, v78, v79
    v_mfma_f32_16x16x32_bf16 v[84:87], v[40:43], v[72:75], v[84:87]
    ds_read_b64_tr_b16 v[32:33], v4 offset:57344
    v_mfma_f32_16x16x32_bf16 v[148:151], v[40:43], v[136:139], v[148:151]
    ds_read_b64_tr_b16 v[34:35], v4 offset:58368
    v_mfma_f32_16x16x32_bf16 v[212:215], v[40:43], v[200:203], v[212:215]
    buffer_load_dwordx4 v18, s[24:27], s49 offen offset:1024 lds
    s_waitcnt lgkmcnt(8)
    v_mfma_f32_16x16x32_bf16 v[92:95], v[44:47], v[72:75], v[92:95]
    ds_read_b64_tr_b16 v[36:37], v5 offset:57344
    v_mfma_f32_16x16x32_bf16 v[156:159], v[44:47], v[136:139], v[156:159]
    ds_read_b64_tr_b16 v[38:39], v5 offset:58368
    v_mfma_f32_16x16x32_bf16 v[220:223], v[44:47], v[200:203], v[220:223]
    buffer_store_dwordx4 v[100:103], v8, s[32:35], s71 offen offset:0 sc1
    v_cvt_pk_bf16_f32 v164, v132, v133
    v_mfma_f32_16x16x32_bf16 v[84:87], v[48:51], a[0:3], v[84:87]
    ds_read_b64_tr_b16 v[40:41], v4 offset:59392
    v_cvt_pk_bf16_f32 v165, v134, v135
    v_mfma_f32_16x16x32_bf16 v[148:151], v[48:51], a[32:35], v[148:151]
    ds_read_b64_tr_b16 v[42:43], v4 offset:60416
    v_cvt_pk_bf16_f32 v166, v140, v141
    v_mfma_f32_16x16x32_bf16 v[212:215], v[48:51], a[64:67], v[212:215]
    buffer_load_dwordx4 v18, s[24:27], s50 offen offset:2048 lds
    s_waitcnt lgkmcnt(8)
    v_cvt_pk_bf16_f32 v167, v142, v143
    v_mfma_f32_16x16x32_bf16 v[92:95], v[52:55], a[0:3], v[92:95]
    ds_read_b64_tr_b16 v[44:45], v5 offset:59392
    v_mfma_f32_16x16x32_bf16 v[156:159], v[52:55], a[32:35], v[156:159]
    ds_read_b64_tr_b16 v[46:47], v5 offset:60416
    v_mfma_f32_16x16x32_bf16 v[220:223], v[52:55], a[64:67], v[220:223]
    buffer_load_dwordx4 v18, s[24:27], s51 offen offset:3072 lds
    v_add_u32 v18, 32768, v18
    v_mfma_f32_16x16x32_bf16 v[84:87], v[56:59], a[4:7], v[84:87]
    ds_read_b64_tr_b16 v[48:49], v6 offset:57344
    v_mfma_f32_16x16x32_bf16 v[148:151], v[56:59], a[36:39], v[148:151]
    ds_read_b64_tr_b16 v[50:51], v6 offset:58368
    v_mfma_f32_16x16x32_bf16 v[212:215], v[56:59], a[68:71], v[212:215]
    buffer_store_dwordx4 v[164:167], v8, s[32:35], s71 offen offset:1024 sc1
    s_waitcnt lgkmcnt(8)
    v_cvt_pk_bf16_f32 v228, v196, v197
    v_mfma_f32_16x16x32_bf16 v[92:95], v[60:63], a[4:7], v[92:95]
    ds_read_b64_tr_b16 v[52:53], v7 offset:57344
    v_cvt_pk_bf16_f32 v229, v198, v199
    v_mfma_f32_16x16x32_bf16 v[156:159], v[60:63], a[36:39], v[156:159]
    ds_read_b64_tr_b16 v[54:55], v7 offset:58368
    v_cvt_pk_bf16_f32 v230, v204, v205
    v_mfma_f32_16x16x32_bf16 v[220:223], v[60:63], a[68:71], v[220:223]
    v_cvt_pk_bf16_f32 v231, v206, v207
    v_mfma_f32_16x16x32_bf16 v[84:87], v[32:35], v[80:83], v[84:87]
    ds_read_b64_tr_b16 v[56:57], v6 offset:59392
    v_mfma_f32_16x16x32_bf16 v[148:151], v[32:35], v[144:147], v[148:151]
    ds_read_b64_tr_b16 v[58:59], v6 offset:60416
    v_mfma_f32_16x16x32_bf16 v[212:215], v[32:35], v[208:211], v[212:215]
    buffer_store_dwordx4 v[228:231], v8, s[32:35], s71 offen offset:2048 sc1
    s_waitcnt lgkmcnt(8)
    v_mfma_f32_16x16x32_bf16 v[92:95], v[36:39], v[80:83], v[92:95]
    ds_read_b64_tr_b16 v[60:61], v7 offset:59392
    v_mfma_f32_16x16x32_bf16 v[156:159], v[36:39], v[144:147], v[156:159]
    ds_read_b64_tr_b16 v[62:63], v7 offset:60416
    v_mfma_f32_16x16x32_bf16 v[220:223], v[36:39], v[208:211], v[220:223]
    s_waitcnt vmcnt(20)
    s_barrier
    v_mfma_f32_16x16x32_bf16 v[84:87], v[40:43], v[88:91], v[84:87]
    ds_read_b64_tr_b16 v[32:33], v4 offset:0
    v_mfma_f32_16x16x32_bf16 v[148:151], v[40:43], v[152:155], v[148:151]
    ds_read_b64_tr_b16 v[34:35], v4 offset:1024
    s_add_u32 m0, s54, 57344
    v_mfma_f32_16x16x32_bf16 v[212:215], v[40:43], v[216:219], v[212:215]
    buffer_load_dwordx4 v18, s[24:27], 0 offen offset:0 lds
    s_waitcnt lgkmcnt(8)
    v_mfma_f32_16x16x32_bf16 v[92:95], v[44:47], v[88:91], v[92:95]
    ds_read_b64_tr_b16 v[36:37], v5 offset:0
    v_mfma_f32_16x16x32_bf16 v[156:159], v[44:47], v[152:155], v[156:159]
    ds_read_b64_tr_b16 v[38:39], v5 offset:1024
    v_mfma_f32_16x16x32_bf16 v[220:223], v[44:47], v[216:219], v[220:223]
    buffer_load_dwordx4 v18, s[24:27], s49 offen offset:1024 lds
    v_mfma_f32_16x16x32_bf16 v[84:87], v[48:51], a[8:11], v[84:87]
    ds_read_b64_tr_b16 v[40:41], v4 offset:2048
    v_mfma_f32_16x16x32_bf16 v[148:151], v[48:51], a[40:43], v[148:151]
    ds_read_b64_tr_b16 v[42:43], v4 offset:3072
    v_mfma_f32_16x16x32_bf16 v[212:215], v[48:51], a[72:75], v[212:215]
    s_waitcnt lgkmcnt(8)
    v_mfma_f32_16x16x32_bf16 v[92:95], v[52:55], a[8:11], v[92:95]
    ds_read_b64_tr_b16 v[44:45], v5 offset:2048
    v_mfma_f32_16x16x32_bf16 v[156:159], v[52:55], a[40:43], v[156:159]
    ds_read_b64_tr_b16 v[46:47], v5 offset:3072
    v_mfma_f32_16x16x32_bf16 v[220:223], v[52:55], a[72:75], v[220:223]
    buffer_load_dwordx4 v18, s[24:27], s50 offen offset:2048 lds
    v_mfma_f32_16x16x32_bf16 v[84:87], v[56:59], a[12:15], v[84:87]
    ds_read_b64_tr_b16 v[48:49], v6 offset:0
    v_mfma_f32_16x16x32_bf16 v[148:151], v[56:59], a[44:47], v[148:151]
    ds_read_b64_tr_b16 v[50:51], v6 offset:1024
    v_mfma_f32_16x16x32_bf16 v[212:215], v[56:59], a[76:79], v[212:215]
    s_waitcnt lgkmcnt(8)
    v_mfma_f32_16x16x32_bf16 v[92:95], v[60:63], a[12:15], v[92:95]
    ds_read_b64_tr_b16 v[52:53], v7 offset:0
    v_mfma_f32_16x16x32_bf16 v[156:159], v[60:63], a[44:47], v[156:159]
    ds_read_b64_tr_b16 v[54:55], v7 offset:1024
    v_mfma_f32_16x16x32_bf16 v[220:223], v[60:63], a[76:79], v[220:223]
    buffer_load_dwordx4 v18, s[24:27], s51 offen offset:3072 lds
    v_add_u32 v18, s58, v19
    v_mfma_f32_16x16x32_bf16 v[84:87], v[32:35], v[96:99], v[84:87]
    ds_read_b64_tr_b16 v[56:57], v6 offset:2048
    v_mfma_f32_16x16x32_bf16 v[148:151], v[32:35], v[160:163], v[148:151]
    ds_read_b64_tr_b16 v[58:59], v6 offset:3072
    s_add_u32 m0, s54, 32768
    v_mfma_f32_16x16x32_bf16 v[212:215], v[32:35], v[224:227], v[212:215]
    buffer_load_dwordx4 v18, s[24:27], 0 offen offset:0 lds
    s_waitcnt lgkmcnt(8)
    v_mfma_f32_16x16x32_bf16 v[92:95], v[36:39], v[96:99], v[92:95]
    ds_read_b64_tr_b16 v[60:61], v7 offset:2048
    v_mfma_f32_16x16x32_bf16 v[156:159], v[36:39], v[160:163], v[156:159]
    ds_read_b64_tr_b16 v[62:63], v7 offset:3072
    v_mfma_f32_16x16x32_bf16 v[220:223], v[36:39], v[224:227], v[220:223]
    v_mfma_f32_16x16x32_bf16 v[84:87], v[40:43], v[104:107], v[84:87]
    ds_read_b64_tr_b16 v[32:33], v4 offset:24576
    v_mfma_f32_16x16x32_bf16 v[148:151], v[40:43], v[168:171], v[148:151]
    ds_read_b64_tr_b16 v[34:35], v4 offset:25600
    v_mfma_f32_16x16x32_bf16 v[212:215], v[40:43], v[232:235], v[212:215]
    buffer_load_dwordx4 v18, s[24:27], s49 offen offset:1024 lds
    s_waitcnt lgkmcnt(8)
    v_mfma_f32_16x16x32_bf16 v[92:95], v[44:47], v[104:107], v[92:95]
    ds_read_b64_tr_b16 v[36:37], v5 offset:24576
    v_mfma_f32_16x16x32_bf16 v[156:159], v[44:47], v[168:171], v[156:159]
    ds_read_b64_tr_b16 v[38:39], v5 offset:25600
    v_mfma_f32_16x16x32_bf16 v[220:223], v[44:47], v[232:235], v[220:223]
    v_mfma_f32_16x16x32_bf16 v[84:87], v[48:51], a[16:19], v[84:87]
    ds_read_b64_tr_b16 v[40:41], v4 offset:26624
    v_mfma_f32_16x16x32_bf16 v[148:151], v[48:51], a[48:51], v[148:151]
    ds_read_b64_tr_b16 v[42:43], v4 offset:27648
    v_mfma_f32_16x16x32_bf16 v[212:215], v[48:51], a[80:83], v[212:215]
    buffer_load_dwordx4 v18, s[24:27], s50 offen offset:2048 lds
    s_waitcnt vmcnt(13)
    s_waitcnt lgkmcnt(8)
    v_cmp_ne_u32 s[76:77], 1, v29
    v_mfma_f32_16x16x32_bf16 v[92:95], v[52:55], a[16:19], v[92:95]
    ds_read_b64_tr_b16 v[44:45], v5 offset:26624
    s_lshl_b64 s[76:77], s[76:77], 32
    s_cbranch_scc1 L_fwaite
L_foke:
    v_mfma_f32_16x16x32_bf16 v[156:159], v[52:55], a[48:51], v[156:159]
    ds_read_b64_tr_b16 v[46:47], v5 offset:27648
    v_mfma_f32_16x16x32_bf16 v[220:223], v[52:55], a[80:83], v[220:223]
    buffer_load_dwordx4 v18, s[24:27], s51 offen offset:3072 lds
    v_add_u32 v18, 32768, v18
    v_mfma_f32_16x16x32_bf16 v[84:87], v[56:59], a[20:23], v[84:87]
    ds_read_b64_tr_b16 v[48:49], v6 offset:24576
    v_mfma_f32_16x16x32_bf16 v[148:151], v[56:59], a[52:55], v[148:151]
    ds_read_b64_tr_b16 v[50:51], v6 offset:25600
    v_mfma_f32_16x16x32_bf16 v[212:215], v[56:59], a[84:87], v[212:215]
    buffer_load_dwordx4 a[120:123], v21, s[32:35], s45 offen offset:0 sc1
    s_waitcnt lgkmcnt(8)
    v_mfma_f32_16x16x32_bf16 v[92:95], v[60:63], a[20:23], v[92:95]
    ds_read_b64_tr_b16 v[52:53], v7 offset:24576
    v_mfma_f32_16x16x32_bf16 v[156:159], v[60:63], a[52:55], v[156:159]
    ds_read_b64_tr_b16 v[54:55], v7 offset:25600
    v_mfma_f32_16x16x32_bf16 v[220:223], v[60:63], a[84:87], v[220:223]
    buffer_load_dwordx4 a[124:127], v21, s[32:35], s45 offen offset:1024 sc1
    v_mfma_f32_16x16x32_bf16 v[84:87], v[32:35], v[112:115], v[84:87]
    ds_read_b64_tr_b16 v[56:57], v6 offset:26624
    buffer_load_dwordx4 a[128:131], v21, s[32:35], s45 offen offset:2048 sc1
    v_mfma_f32_16x16x32_bf16 v[148:151], v[32:35], v[176:179], v[148:151]
    ds_read_b64_tr_b16 v[58:59], v6 offset:27648
    v_mfma_f32_16x16x32_bf16 v[212:215], v[32:35], v[240:243], v[212:215]
    s_waitcnt lgkmcnt(8)
    v_mfma_f32_16x16x32_bf16 v[92:95], v[36:39], v[112:115], v[92:95]
    ds_read_b64_tr_b16 v[60:61], v7 offset:26624
    v_mfma_f32_16x16x32_bf16 v[156:159], v[36:39], v[176:179], v[156:159]
    ds_read_b64_tr_b16 v[62:63], v7 offset:27648
    v_mfma_f32_16x16x32_bf16 v[220:223], v[36:39], v[240:243], v[220:223]
    s_barrier
    v_mfma_f32_16x16x32_bf16 v[84:87], v[40:43], v[120:123], v[84:87]
    ds_read_b64_tr_b16 v[32:33], v4 offset:32768
    v_mfma_f32_16x16x32_bf16 v[148:151], v[40:43], v[184:187], v[148:151]
    ds_read_b64_tr_b16 v[34:35], v4 offset:33792
    s_add_u32 m0, s54, 73728
    v_mfma_f32_16x16x32_bf16 v[212:215], v[40:43], v[248:251], v[212:215]
    buffer_load_dwordx4 v18, s[24:27], 0 offen offset:0 lds
    s_waitcnt lgkmcnt(8)
    v_mfma_f32_16x16x32_bf16 v[92:95], v[44:47], v[120:123], v[92:95]
    ds_read_b64_tr_b16 v[36:37], v5 offset:32768
    v_mfma_f32_16x16x32_bf16 v[156:159], v[44:47], v[184:187], v[156:159]
    ds_read_b64_tr_b16 v[38:39], v5 offset:33792
    v_mfma_f32_16x16x32_bf16 v[220:223], v[44:47], v[248:251], v[220:223]
    buffer_load_dwordx4 v18, s[24:27], s49 offen offset:1024 lds
    v_mfma_f32_16x16x32_bf16 v[84:87], v[48:51], a[24:27], v[84:87]
    ds_read_b64_tr_b16 v[40:41], v4 offset:34816
    v_mfma_f32_16x16x32_bf16 v[148:151], v[48:51], a[56:59], v[148:151]
    ds_read_b64_tr_b16 v[42:43], v4 offset:35840
    v_mfma_f32_16x16x32_bf16 v[212:215], v[48:51], a[88:91], v[212:215]
    buffer_load_dword v29, v10, s[32:35], s66 offen sc1
    s_waitcnt lgkmcnt(8)
    v_mfma_f32_16x16x32_bf16 v[92:95], v[52:55], a[24:27], v[92:95]
    ds_read_b64_tr_b16 v[44:45], v5 offset:34816
    v_mfma_f32_16x16x32_bf16 v[156:159], v[52:55], a[56:59], v[156:159]
    ds_read_b64_tr_b16 v[46:47], v5 offset:35840
    s_waitcnt vmcnt(14)
    s_mov_b64 exec, 1
    buffer_store_dword v11, v9, s[32:35], s71 offen offset:20 sc1
    s_mov_b64 exec, -1
    v_mfma_f32_16x16x32_bf16 v[220:223], v[52:55], a[88:91], v[220:223]
    buffer_load_dwordx4 v18, s[24:27], s50 offen offset:2048 lds
    v_mfma_f32_16x16x32_bf16 v[84:87], v[56:59], a[28:31], v[84:87]
    ds_read_b64_tr_b16 v[48:49], v6 offset:32768
    v_mfma_f32_16x16x32_bf16 v[148:151], v[56:59], a[60:63], v[148:151]
    ds_read_b64_tr_b16 v[50:51], v6 offset:33792
    v_mfma_f32_16x16x32_bf16 v[212:215], v[56:59], a[92:95], v[212:215]
    s_waitcnt lgkmcnt(8)
    v_mfma_f32_16x16x32_bf16 v[92:95], v[60:63], a[28:31], v[92:95]
    ds_read_b64_tr_b16 v[52:53], v7 offset:32768
    v_mfma_f32_16x16x32_bf16 v[156:159], v[60:63], a[60:63], v[156:159]
    ds_read_b64_tr_b16 v[54:55], v7 offset:33792
    v_mfma_f32_16x16x32_bf16 v[220:223], v[60:63], a[92:95], v[220:223]
    buffer_load_dwordx4 v18, s[24:27], s51 offen offset:3072 lds
    v_add_u32 v18, 32768, v18
    v_mfma_f32_16x16x32_bf16 v[68:71], v[32:35], v[64:67], 0
    ds_read_b64_tr_b16 v[56:57], v6 offset:34816
    v_mfma_f32_16x16x32_bf16 v[132:135], v[32:35], v[128:131], 0
    ds_read_b64_tr_b16 v[58:59], v6 offset:35840
    s_add_u32 m0, s54, 16384
    v_mfma_f32_16x16x32_bf16 v[196:199], v[32:35], v[192:195], 0
    buffer_load_dwordx4 v18, s[24:27], 0 offen offset:0 lds
    s_waitcnt lgkmcnt(8)
    v_add_u32 v8, 12288, v8
    v_mfma_f32_16x16x32_bf16 v[76:79], v[36:39], v[64:67], 0
    ds_read_b64_tr_b16 v[60:61], v7 offset:34816
    v_cvt_pk_bf16_f32 v100, v84, v85
    v_mfma_f32_16x16x32_bf16 v[140:143], v[36:39], v[128:131], 0
    ds_read_b64_tr_b16 v[62:63], v7 offset:35840
    v_cvt_pk_bf16_f32 v101, v86, v87
    v_mfma_f32_16x16x32_bf16 v[204:207], v[36:39], v[192:195], 0
    v_cvt_pk_bf16_f32 v102, v92, v93
    v_cvt_pk_bf16_f32 v103, v94, v95
    v_mfma_f32_16x16x32_bf16 v[68:71], v[40:43], v[72:75], v[68:71]
    ds_read_b64_tr_b16 v[32:33], v4 offset:8192
    v_mfma_f32_16x16x32_bf16 v[132:135], v[40:43], v[136:139], v[132:135]
    ds_read_b64_tr_b16 v[34:35], v4 offset:9216
    v_mfma_f32_16x16x32_bf16 v[196:199], v[40:43], v[200:203], v[196:199]
    buffer_load_dwordx4 v18, s[24:27], s49 offen offset:1024 lds
    s_waitcnt lgkmcnt(8)
    v_mfma_f32_16x16x32_bf16 v[76:79], v[44:47], v[72:75], v[76:79]
    ds_read_b64_tr_b16 v[36:37], v5 offset:8192
    v_mfma_f32_16x16x32_bf16 v[140:143], v[44:47], v[136:139], v[140:143]
    ds_read_b64_tr_b16 v[38:39], v5 offset:9216
    v_mfma_f32_16x16x32_bf16 v[204:207], v[44:47], v[200:203], v[204:207]
    buffer_store_dwordx4 v[100:103], v8, s[32:35], s72 offen offset:0 sc1
    v_cvt_pk_bf16_f32 v164, v148, v149
    v_mfma_f32_16x16x32_bf16 v[68:71], v[48:51], a[0:3], v[68:71]
    ds_read_b64_tr_b16 v[40:41], v4 offset:10240
    v_cvt_pk_bf16_f32 v165, v150, v151
    v_mfma_f32_16x16x32_bf16 v[132:135], v[48:51], a[32:35], v[132:135]
    ds_read_b64_tr_b16 v[42:43], v4 offset:11264
    v_cvt_pk_bf16_f32 v166, v156, v157
    v_mfma_f32_16x16x32_bf16 v[196:199], v[48:51], a[64:67], v[196:199]
    buffer_load_dwordx4 v18, s[24:27], s50 offen offset:2048 lds
    s_waitcnt lgkmcnt(8)
    v_cvt_pk_bf16_f32 v167, v158, v159
    v_mfma_f32_16x16x32_bf16 v[76:79], v[52:55], a[0:3], v[76:79]
    ds_read_b64_tr_b16 v[44:45], v5 offset:10240
    v_mfma_f32_16x16x32_bf16 v[140:143], v[52:55], a[32:35], v[140:143]
    ds_read_b64_tr_b16 v[46:47], v5 offset:11264
    v_mfma_f32_16x16x32_bf16 v[204:207], v[52:55], a[64:67], v[204:207]
    buffer_load_dwordx4 v18, s[24:27], s51 offen offset:3072 lds
    v_add_u32 v18, 32768, v18
    v_mfma_f32_16x16x32_bf16 v[68:71], v[56:59], a[4:7], v[68:71]
    ds_read_b64_tr_b16 v[48:49], v6 offset:8192
    v_mfma_f32_16x16x32_bf16 v[132:135], v[56:59], a[36:39], v[132:135]
    ds_read_b64_tr_b16 v[50:51], v6 offset:9216
    v_mfma_f32_16x16x32_bf16 v[196:199], v[56:59], a[68:71], v[196:199]
    buffer_store_dwordx4 v[164:167], v8, s[32:35], s72 offen offset:1024 sc1
    s_waitcnt lgkmcnt(8)
    v_cvt_pk_bf16_f32 v228, v212, v213
    v_mfma_f32_16x16x32_bf16 v[76:79], v[60:63], a[4:7], v[76:79]
    ds_read_b64_tr_b16 v[52:53], v7 offset:8192
    v_cvt_pk_bf16_f32 v229, v214, v215
    v_mfma_f32_16x16x32_bf16 v[140:143], v[60:63], a[36:39], v[140:143]
    ds_read_b64_tr_b16 v[54:55], v7 offset:9216
    v_cvt_pk_bf16_f32 v230, v220, v221
    v_mfma_f32_16x16x32_bf16 v[204:207], v[60:63], a[68:71], v[204:207]
    v_cvt_pk_bf16_f32 v231, v222, v223
    v_mfma_f32_16x16x32_bf16 v[68:71], v[32:35], v[80:83], v[68:71]
    ds_read_b64_tr_b16 v[56:57], v6 offset:10240
    v_mfma_f32_16x16x32_bf16 v[132:135], v[32:35], v[144:147], v[132:135]
    ds_read_b64_tr_b16 v[58:59], v6 offset:11264
    v_mfma_f32_16x16x32_bf16 v[196:199], v[32:35], v[208:211], v[196:199]
    buffer_store_dwordx4 v[228:231], v8, s[32:35], s72 offen offset:2048 sc1
    s_waitcnt lgkmcnt(8)
    v_mfma_f32_16x16x32_bf16 v[76:79], v[36:39], v[80:83], v[76:79]
    ds_read_b64_tr_b16 v[60:61], v7 offset:10240
    v_mfma_f32_16x16x32_bf16 v[140:143], v[36:39], v[144:147], v[140:143]
    ds_read_b64_tr_b16 v[62:63], v7 offset:11264
    v_mfma_f32_16x16x32_bf16 v[204:207], v[36:39], v[208:211], v[204:207]
    s_waitcnt vmcnt(20)
    s_barrier
    v_mfma_f32_16x16x32_bf16 v[68:71], v[40:43], v[88:91], v[68:71]
    ds_read_b64_tr_b16 v[32:33], v4 offset:49152
    v_mfma_f32_16x16x32_bf16 v[132:135], v[40:43], v[152:155], v[132:135]
    ds_read_b64_tr_b16 v[34:35], v4 offset:50176
    s_add_u32 m0, s54, 40960
    v_mfma_f32_16x16x32_bf16 v[196:199], v[40:43], v[216:219], v[196:199]
    buffer_load_dwordx4 v18, s[24:27], 0 offen offset:0 lds
    s_waitcnt lgkmcnt(8)
    v_mfma_f32_16x16x32_bf16 v[76:79], v[44:47], v[88:91], v[76:79]
    ds_read_b64_tr_b16 v[36:37], v5 offset:49152
    v_mfma_f32_16x16x32_bf16 v[140:143], v[44:47], v[152:155], v[140:143]
    ds_read_b64_tr_b16 v[38:39], v5 offset:50176
    v_mfma_f32_16x16x32_bf16 v[204:207], v[44:47], v[216:219], v[204:207]
    v_mfma_f32_16x16x32_bf16 v[68:71], v[48:51], a[8:11], v[68:71]
    ds_read_b64_tr_b16 v[40:41], v4 offset:51200
    v_mfma_f32_16x16x32_bf16 v[132:135], v[48:51], a[40:43], v[132:135]
    ds_read_b64_tr_b16 v[42:43], v4 offset:52224
    v_mfma_f32_16x16x32_bf16 v[196:199], v[48:51], a[72:75], v[196:199]
    s_waitcnt lgkmcnt(8)
    v_mfma_f32_16x16x32_bf16 v[76:79], v[52:55], a[8:11], v[76:79]
    ds_read_b64_tr_b16 v[44:45], v5 offset:51200
    v_mfma_f32_16x16x32_bf16 v[140:143], v[52:55], a[40:43], v[140:143]
    ds_read_b64_tr_b16 v[46:47], v5 offset:52224
    v_mfma_f32_16x16x32_bf16 v[204:207], v[52:55], a[72:75], v[204:207]
    buffer_load_dwordx4 v18, s[24:27], s49 offen offset:1024 lds
    v_mfma_f32_16x16x32_bf16 v[68:71], v[56:59], a[12:15], v[68:71]
    ds_read_b64_tr_b16 v[48:49], v6 offset:49152
    v_mfma_f32_16x16x32_bf16 v[132:135], v[56:59], a[44:47], v[132:135]
    ds_read_b64_tr_b16 v[50:51], v6 offset:50176
    v_mfma_f32_16x16x32_bf16 v[196:199], v[56:59], a[76:79], v[196:199]
    s_waitcnt vmcnt(12)
    s_waitcnt lgkmcnt(8)
    v_cmp_ne_u32 s[76:77], 1, v29
    v_mfma_f32_16x16x32_bf16 v[76:79], v[60:63], a[12:15], v[76:79]
    ds_read_b64_tr_b16 v[52:53], v7 offset:49152
    s_lshl_b64 s[76:77], s[76:77], 24
    s_cbranch_scc1 L_fwaitf
L_fokf:
    v_mfma_f32_16x16x32_bf16 v[140:143], v[60:63], a[44:47], v[140:143]
    ds_read_b64_tr_b16 v[54:55], v7 offset:50176
    v_mfma_f32_16x16x32_bf16 v[204:207], v[60:63], a[76:79], v[204:207]
    buffer_load_dwordx4 a[132:135], v21, s[32:35], s46 offen offset:0 sc1
    v_mfma_f32_16x16x32_bf16 v[68:71], v[32:35], v[96:99], v[68:71]
    ds_read_b64_tr_b16 v[56:57], v6 offset:51200
    v_mfma_f32_16x16x32_bf16 v[132:135], v[32:35], v[160:163], v[132:135]
    ds_read_b64_tr_b16 v[58:59], v6 offset:52224
    v_mfma_f32_16x16x32_bf16 v[196:199], v[32:35], v[224:227], v[196:199]
    buffer_load_dwordx4 v18, s[24:27], s50 offen offset:2048 lds
    s_waitcnt lgkmcnt(8)
    v_mfma_f32_16x16x32_bf16 v[76:79], v[36:39], v[96:99], v[76:79]
    ds_read_b64_tr_b16 v[60:61], v7 offset:51200
    v_mfma_f32_16x16x32_bf16 v[140:143], v[36:39], v[160:163], v[140:143]
    ds_read_b64_tr_b16 v[62:63], v7 offset:52224
    v_mfma_f32_16x16x32_bf16 v[204:207], v[36:39], v[224:227], v[204:207]
    buffer_load_dwordx4 a[136:139], v21, s[32:35], s46 offen offset:1024 sc1
    v_mfma_f32_16x16x32_bf16 v[68:71], v[40:43], v[104:107], v[68:71]
    ds_read_b64_tr_b16 v[32:33], v4 offset:40960
    buffer_load_dwordx4 a[140:143], v21, s[32:35], s46 offen offset:2048 sc1
    v_mfma_f32_16x16x32_bf16 v[132:135], v[40:43], v[168:171], v[132:135]
    ds_read_b64_tr_b16 v[34:35], v4 offset:41984
    v_mfma_f32_16x16x32_bf16 v[196:199], v[40:43], v[232:235], v[196:199]
    s_waitcnt lgkmcnt(8)
    v_mfma_f32_16x16x32_bf16 v[76:79], v[44:47], v[104:107], v[76:79]
    ds_read_b64_tr_b16 v[36:37], v5 offset:40960
    v_mfma_f32_16x16x32_bf16 v[140:143], v[44:47], v[168:171], v[140:143]
    ds_read_b64_tr_b16 v[38:39], v5 offset:41984
    v_mfma_f32_16x16x32_bf16 v[204:207], v[44:47], v[232:235], v[204:207]
    v_mfma_f32_16x16x32_bf16 v[68:71], v[48:51], a[16:19], v[68:71]
    ds_read_b64_tr_b16 v[40:41], v4 offset:43008
    v_mfma_f32_16x16x32_bf16 v[132:135], v[48:51], a[48:51], v[132:135]
    ds_read_b64_tr_b16 v[42:43], v4 offset:44032
    v_mfma_f32_16x16x32_bf16 v[196:199], v[48:51], a[80:83], v[196:199]
    buffer_load_dwordx4 v18, s[24:27], s51 offen offset:3072 lds
    s_waitcnt lgkmcnt(8)
    v_mfma_f32_16x16x32_bf16 v[76:79], v[52:55], a[16:19], v[76:79]
    ds_read_b64_tr_b16 v[44:45], v5 offset:43008
    v_mfma_f32_16x16x32_bf16 v[140:143], v[52:55], a[48:51], v[140:143]
    ds_read_b64_tr_b16 v[46:47], v5 offset:44032
    v_mfma_f32_16x16x32_bf16 v[204:207], v[52:55], a[80:83], v[204:207]
    v_mfma_f32_16x16x32_bf16 v[68:71], v[56:59], a[20:23], v[68:71]
    ds_read_b64_tr_b16 v[48:49], v6 offset:40960
    v_mfma_f32_16x16x32_bf16 v[132:135], v[56:59], a[52:55], v[132:135]
    ds_read_b64_tr_b16 v[50:51], v6 offset:41984
    v_mfma_f32_16x16x32_bf16 v[196:199], v[56:59], a[84:87], v[196:199]
    buffer_load_dword v29, v10, s[32:35], s66 offen sc1
    s_waitcnt lgkmcnt(8)
    v_mfma_f32_16x16x32_bf16 v[76:79], v[60:63], a[20:23], v[76:79]
    ds_read_b64_tr_b16 v[52:53], v7 offset:40960
    v_mfma_f32_16x16x32_bf16 v[140:143], v[60:63], a[52:55], v[140:143]
    ds_read_b64_tr_b16 v[54:55], v7 offset:41984
    v_mfma_f32_16x16x32_bf16 v[204:207], v[60:63], a[84:87], v[204:207]
    v_mfma_f32_16x16x32_bf16 v[68:71], v[32:35], v[112:115], v[68:71]
    ds_read_b64_tr_b16 v[56:57], v6 offset:43008
    v_mfma_f32_16x16x32_bf16 v[132:135], v[32:35], v[176:179], v[132:135]
    ds_read_b64_tr_b16 v[58:59], v6 offset:44032
    v_mfma_f32_16x16x32_bf16 v[196:199], v[32:35], v[240:243], v[196:199]
    s_waitcnt lgkmcnt(8)
    v_mfma_f32_16x16x32_bf16 v[76:79], v[36:39], v[112:115], v[76:79]
    ds_read_b64_tr_b16 v[60:61], v7 offset:43008
    v_mfma_f32_16x16x32_bf16 v[140:143], v[36:39], v[176:179], v[140:143]
    ds_read_b64_tr_b16 v[62:63], v7 offset:44032
    v_mfma_f32_16x16x32_bf16 v[204:207], v[36:39], v[240:243], v[204:207]
    s_waitcnt vmcnt(15)
    s_barrier
    v_mfma_f32_16x16x32_bf16 v[68:71], v[40:43], v[120:123], v[68:71]
    ds_read_b64_tr_b16 v[32:33], v4 offset:16384
    v_mfma_f32_16x16x32_bf16 v[132:135], v[40:43], v[184:187], v[132:135]
    ds_read_b64_tr_b16 v[34:35], v4 offset:17408
    v_mfma_f32_16x16x32_bf16 v[196:199], v[40:43], v[248:251], v[196:199]
    s_waitcnt lgkmcnt(8)
    v_mfma_f32_16x16x32_bf16 v[76:79], v[44:47], v[120:123], v[76:79]
    ds_read_b64_tr_b16 v[36:37], v5 offset:16384
    v_mfma_f32_16x16x32_bf16 v[140:143], v[44:47], v[184:187], v[140:143]
    ds_read_b64_tr_b16 v[38:39], v5 offset:17408
    v_mfma_f32_16x16x32_bf16 v[204:207], v[44:47], v[248:251], v[204:207]
    v_mfma_f32_16x16x32_bf16 v[68:71], v[48:51], a[24:27], v[68:71]
    ds_read_b64_tr_b16 v[40:41], v4 offset:18432
    s_waitcnt vmcnt(8)
    s_mov_b64 exec, 1
    buffer_store_dword v11, v9, s[32:35], s72 offen offset:24 sc1
    s_mov_b64 exec, -1
    v_mfma_f32_16x16x32_bf16 v[132:135], v[48:51], a[56:59], v[132:135]
    ds_read_b64_tr_b16 v[42:43], v4 offset:19456
    v_mfma_f32_16x16x32_bf16 v[196:199], v[48:51], a[88:91], v[196:199]
    s_waitcnt lgkmcnt(8)
    v_mfma_f32_16x16x32_bf16 v[76:79], v[52:55], a[24:27], v[76:79]
    ds_read_b64_tr_b16 v[44:45], v5 offset:18432
    v_mfma_f32_16x16x32_bf16 v[140:143], v[52:55], a[56:59], v[140:143]
    ds_read_b64_tr_b16 v[46:47], v5 offset:19456
    v_mfma_f32_16x16x32_bf16 v[204:207], v[52:55], a[88:91], v[204:207]
    v_mfma_f32_16x16x32_bf16 v[68:71], v[56:59], a[28:31], v[68:71]
    ds_read_b64_tr_b16 v[48:49], v6 offset:16384
    v_mfma_f32_16x16x32_bf16 v[132:135], v[56:59], a[60:63], v[132:135]
    ds_read_b64_tr_b16 v[50:51], v6 offset:17408
    v_mfma_f32_16x16x32_bf16 v[196:199], v[56:59], a[92:95], v[196:199]
    s_waitcnt lgkmcnt(8)
    v_mfma_f32_16x16x32_bf16 v[76:79], v[60:63], a[28:31], v[76:79]
    ds_read_b64_tr_b16 v[52:53], v7 offset:16384
    v_mfma_f32_16x16x32_bf16 v[140:143], v[60:63], a[60:63], v[140:143]
    ds_read_b64_tr_b16 v[54:55], v7 offset:17408
    v_mfma_f32_16x16x32_bf16 v[204:207], v[60:63], a[92:95], v[204:207]
    v_mfma_f32_16x16x32_bf16 v[84:87], v[32:35], v[64:67], 0
    ds_read_b64_tr_b16 v[56:57], v6 offset:18432
    v_mfma_f32_16x16x32_bf16 v[148:151], v[32:35], v[128:131], 0
    ds_read_b64_tr_b16 v[58:59], v6 offset:19456
    v_mfma_f32_16x16x32_bf16 v[212:215], v[32:35], v[192:195], 0
    s_waitcnt lgkmcnt(8)
    v_add_u32 v8, 12288, v8
    v_cvt_pk_bf16_f32 v100, v68, v69
    v_mfma_f32_16x16x32_bf16 v[92:95], v[36:39], v[64:67], 0
    ds_read_b64_tr_b16 v[60:61], v7 offset:18432
    v_cvt_pk_bf16_f32 v101, v70, v71
    v_mfma_f32_16x16x32_bf16 v[156:159], v[36:39], v[128:131], 0
    ds_read_b64_tr_b16 v[62:63], v7 offset:19456
    v_cvt_pk_bf16_f32 v102, v76, v77
    v_mfma_f32_16x16x32_bf16 v[220:223], v[36:39], v[192:195], 0
    v_cvt_pk_bf16_f32 v103, v78, v79
    v_mfma_f32_16x16x32_bf16 v[84:87], v[40:43], v[72:75], v[84:87]
    ds_read_b64_tr_b16 v[32:33], v4 offset:57344
    v_mfma_f32_16x16x32_bf16 v[148:151], v[40:43], v[136:139], v[148:151]
    ds_read_b64_tr_b16 v[34:35], v4 offset:58368
    v_mfma_f32_16x16x32_bf16 v[212:215], v[40:43], v[200:203], v[212:215]
    buffer_store_dwordx4 v[100:103], v8, s[32:35], s73 offen offset:0 sc1
    s_waitcnt lgkmcnt(8)
    v_cvt_pk_bf16_f32 v164, v132, v133
    v_mfma_f32_16x16x32_bf16 v[92:95], v[44:47], v[72:75], v[92:95]
    ds_read_b64_tr_b16 v[36:37], v5 offset:57344
    v_cvt_pk_bf16_f32 v165, v134, v135
    v_mfma_f32_16x16x32_bf16 v[156:159], v[44:47], v[136:139], v[156:159]
    ds_read_b64_tr_b16 v[38:39], v5 offset:58368
    v_cvt_pk_bf16_f32 v166, v140, v141
    v_mfma_f32_16x16x32_bf16 v[220:223], v[44:47], v[200:203], v[220:223]
    v_cvt_pk_bf16_f32 v167, v142, v143
    v_mfma_f32_16x16x32_bf16 v[84:87], v[48:51], a[0:3], v[84:87]
    ds_read_b64_tr_b16 v[40:41], v4 offset:59392
    v_mfma_f32_16x16x32_bf16 v[148:151], v[48:51], a[32:35], v[148:151]
    ds_read_b64_tr_b16 v[42:43], v4 offset:60416
    v_mfma_f32_16x16x32_bf16 v[212:215], v[48:51], a[64:67], v[212:215]
    buffer_store_dwordx4 v[164:167], v8, s[32:35], s73 offen offset:1024 sc1
    s_waitcnt lgkmcnt(8)
    v_cvt_pk_bf16_f32 v228, v196, v197
    v_mfma_f32_16x16x32_bf16 v[92:95], v[52:55], a[0:3], v[92:95]
    ds_read_b64_tr_b16 v[44:45], v5 offset:59392
    v_cvt_pk_bf16_f32 v229, v198, v199
    v_mfma_f32_16x16x32_bf16 v[156:159], v[52:55], a[32:35], v[156:159]
    ds_read_b64_tr_b16 v[46:47], v5 offset:60416
    v_cvt_pk_bf16_f32 v230, v204, v205
    v_mfma_f32_16x16x32_bf16 v[220:223], v[52:55], a[64:67], v[220:223]
    v_cvt_pk_bf16_f32 v231, v206, v207
    v_mfma_f32_16x16x32_bf16 v[84:87], v[56:59], a[4:7], v[84:87]
    ds_read_b64_tr_b16 v[48:49], v6 offset:57344
    v_mfma_f32_16x16x32_bf16 v[148:151], v[56:59], a[36:39], v[148:151]
    ds_read_b64_tr_b16 v[50:51], v6 offset:58368
    v_mfma_f32_16x16x32_bf16 v[212:215], v[56:59], a[68:71], v[212:215]
    buffer_store_dwordx4 v[228:231], v8, s[32:35], s73 offen offset:2048 sc1
    s_waitcnt lgkmcnt(8)
    v_mfma_f32_16x16x32_bf16 v[92:95], v[60:63], a[4:7], v[92:95]
    ds_read_b64_tr_b16 v[52:53], v7 offset:57344
    v_mfma_f32_16x16x32_bf16 v[156:159], v[60:63], a[36:39], v[156:159]
    ds_read_b64_tr_b16 v[54:55], v7 offset:58368
    v_mfma_f32_16x16x32_bf16 v[220:223], v[60:63], a[68:71], v[220:223]
    v_mfma_f32_16x16x32_bf16 v[84:87], v[32:35], v[80:83], v[84:87]
    ds_read_b64_tr_b16 v[56:57], v6 offset:59392
    v_mfma_f32_16x16x32_bf16 v[148:151], v[32:35], v[144:147], v[148:151]
    ds_read_b64_tr_b16 v[58:59], v6 offset:60416
    v_mfma_f32_16x16x32_bf16 v[212:215], v[32:35], v[208:211], v[212:215]
    s_waitcnt lgkmcnt(8)
    v_mfma_f32_16x16x32_bf16 v[92:95], v[36:39], v[80:83], v[92:95]
    ds_read_b64_tr_b16 v[60:61], v7 offset:59392
    v_mfma_f32_16x16x32_bf16 v[156:159], v[36:39], v[144:147], v[156:159]
    ds_read_b64_tr_b16 v[62:63], v7 offset:60416
    v_mfma_f32_16x16x32_bf16 v[220:223], v[36:39], v[208:211], v[220:223]
    s_waitcnt vmcnt(5)
    s_barrier
    v_mfma_f32_16x16x32_bf16 v[84:87], v[40:43], v[88:91], v[84:87]
    ds_read_b64_tr_b16 v[32:33], v4 offset:0
    v_mfma_f32_16x16x32_bf16 v[148:151], v[40:43], v[152:155], v[148:151]
    ds_read_b64_tr_b16 v[34:35], v4 offset:1024
    v_mfma_f32_16x16x32_bf16 v[212:215], v[40:43], v[216:219], v[212:215]
    s_waitcnt lgkmcnt(8)
    v_mfma_f32_16x16x32_bf16 v[92:95], v[44:47], v[88:91], v[92:95]
    ds_read_b64_tr_b16 v[36:37], v5 offset:0
    v_mfma_f32_16x16x32_bf16 v[156:159], v[44:47], v[152:155], v[156:159]
    ds_read_b64_tr_b16 v[38:39], v5 offset:1024
    s_waitcnt vmcnt(4)
    v_cmp_ne_u32 s[76:77], 1, v29
    v_mfma_f32_16x16x32_bf16 v[220:223], v[44:47], v[216:219], v[220:223]
    s_lshl_b64 s[76:77], s[76:77], 16
    s_cbranch_scc1 L_fwaita
L_foka:
    v_mfma_f32_16x16x32_bf16 v[84:87], v[48:51], a[8:11], v[84:87]
    ds_read_b64_tr_b16 v[40:41], v4 offset:2048
    s_add_u32 s49, s66, 86016
    v_mfma_f32_16x16x32_bf16 v[148:151], v[48:51], a[40:43], v[148:151]
    ds_read_b64_tr_b16 v[42:43], v4 offset:3072
    v_mfma_f32_16x16x32_bf16 v[212:215], v[48:51], a[72:75], v[212:215]
    s_waitcnt lgkmcnt(8)
    v_mfma_f32_16x16x32_bf16 v[92:95], v[52:55], a[8:11], v[92:95]
    ds_read_b64_tr_b16 v[44:45], v5 offset:2048
    v_mfma_f32_16x16x32_bf16 v[156:159], v[52:55], a[40:43], v[156:159]
    ds_read_b64_tr_b16 v[46:47], v5 offset:3072
    v_mfma_f32_16x16x32_bf16 v[220:223], v[52:55], a[72:75], v[220:223]
    buffer_load_dwordx4 a[144:147], v21, s[32:35], s47 offen offset:0 sc1
    v_mfma_f32_16x16x32_bf16 v[84:87], v[56:59], a[12:15], v[84:87]
    ds_read_b64_tr_b16 v[48:49], v6 offset:0
    v_mfma_f32_16x16x32_bf16 v[148:151], v[56:59], a[44:47], v[148:151]
    ds_read_b64_tr_b16 v[50:51], v6 offset:1024
    v_mfma_f32_16x16x32_bf16 v[212:215], v[56:59], a[76:79], v[212:215]
    s_waitcnt lgkmcnt(8)
    v_mfma_f32_16x16x32_bf16 v[92:95], v[60:63], a[12:15], v[92:95]
    ds_read_b64_tr_b16 v[52:53], v7 offset:0
    v_mfma_f32_16x16x32_bf16 v[156:159], v[60:63], a[44:47], v[156:159]
    ds_read_b64_tr_b16 v[54:55], v7 offset:1024
    v_mfma_f32_16x16x32_bf16 v[220:223], v[60:63], a[76:79], v[220:223]
    buffer_load_dwordx4 a[148:151], v21, s[32:35], s47 offen offset:1024 sc1
    v_mfma_f32_16x16x32_bf16 v[84:87], v[32:35], v[96:99], v[84:87]
    ds_read_b64_tr_b16 v[56:57], v6 offset:2048
    v_mfma_f32_16x16x32_bf16 v[148:151], v[32:35], v[160:163], v[148:151]
    ds_read_b64_tr_b16 v[58:59], v6 offset:3072
    v_mfma_f32_16x16x32_bf16 v[212:215], v[32:35], v[224:227], v[212:215]
    s_waitcnt lgkmcnt(8)
    v_mfma_f32_16x16x32_bf16 v[92:95], v[36:39], v[96:99], v[92:95]
    ds_read_b64_tr_b16 v[60:61], v7 offset:2048
    v_mfma_f32_16x16x32_bf16 v[156:159], v[36:39], v[160:163], v[156:159]
    ds_read_b64_tr_b16 v[62:63], v7 offset:3072
    v_mfma_f32_16x16x32_bf16 v[220:223], v[36:39], v[224:227], v[220:223]
    buffer_load_dwordx4 a[152:155], v21, s[32:35], s47 offen offset:2048 sc1
    v_mfma_f32_16x16x32_bf16 v[84:87], v[40:43], v[104:107], v[84:87]
    ds_read_b64_tr_b16 v[32:33], v4 offset:24576
    v_mfma_f32_16x16x32_bf16 v[148:151], v[40:43], v[168:171], v[148:151]
    ds_read_b64_tr_b16 v[34:35], v4 offset:25600
    v_mfma_f32_16x16x32_bf16 v[212:215], v[40:43], v[232:235], v[212:215]
    s_waitcnt lgkmcnt(8)
    v_mfma_f32_16x16x32_bf16 v[92:95], v[44:47], v[104:107], v[92:95]
    ds_read_b64_tr_b16 v[36:37], v5 offset:24576
    v_mfma_f32_16x16x32_bf16 v[156:159], v[44:47], v[168:171], v[156:159]
    ds_read_b64_tr_b16 v[38:39], v5 offset:25600
    s_waitcnt vmcnt(3)
    s_mov_b64 exec, 1
    buffer_store_dword v11, v9, s[32:35], s73 offen offset:28 sc1
    s_mov_b64 exec, -1
    v_mfma_f32_16x16x32_bf16 v[220:223], v[44:47], v[232:235], v[220:223]
    v_mfma_f32_16x16x32_bf16 v[84:87], v[48:51], a[16:19], v[84:87]
    ds_read_b64_tr_b16 v[40:41], v4 offset:26624
    v_mfma_f32_16x16x32_bf16 v[148:151], v[48:51], a[48:51], v[148:151]
    ds_read_b64_tr_b16 v[42:43], v4 offset:27648
    v_mfma_f32_16x16x32_bf16 v[212:215], v[48:51], a[80:83], v[212:215]
    s_waitcnt lgkmcnt(8)
    v_mfma_f32_16x16x32_bf16 v[92:95], v[52:55], a[16:19], v[92:95]
    ds_read_b64_tr_b16 v[44:45], v5 offset:26624
    v_mfma_f32_16x16x32_bf16 v[156:159], v[52:55], a[48:51], v[156:159]
    ds_read_b64_tr_b16 v[46:47], v5 offset:27648
    v_mfma_f32_16x16x32_bf16 v[220:223], v[52:55], a[80:83], v[220:223]
    v_mfma_f32_16x16x32_bf16 v[84:87], v[56:59], a[20:23], v[84:87]
    ds_read_b64_tr_b16 v[48:49], v6 offset:24576
    v_mfma_f32_16x16x32_bf16 v[148:151], v[56:59], a[52:55], v[148:151]
    ds_read_b64_tr_b16 v[50:51], v6 offset:25600
    v_mfma_f32_16x16x32_bf16 v[212:215], v[56:59], a[84:87], v[212:215]
    s_waitcnt lgkmcnt(8)
    v_mfma_f32_16x16x32_bf16 v[92:95], v[60:63], a[20:23], v[92:95]
    ds_read_b64_tr_b16 v[52:53], v7 offset:24576
    v_mfma_f32_16x16x32_bf16 v[156:159], v[60:63], a[52:55], v[156:159]
    ds_read_b64_tr_b16 v[54:55], v7 offset:25600
    v_mfma_f32_16x16x32_bf16 v[220:223], v[60:63], a[84:87], v[220:223]
    v_mfma_f32_16x16x32_bf16 v[84:87], v[32:35], v[112:115], v[84:87]
    ds_read_b64_tr_b16 v[56:57], v6 offset:26624
    v_mfma_f32_16x16x32_bf16 v[148:151], v[32:35], v[176:179], v[148:151]
    ds_read_b64_tr_b16 v[58:59], v6 offset:27648
    v_mfma_f32_16x16x32_bf16 v[212:215], v[32:35], v[240:243], v[212:215]
    s_waitcnt lgkmcnt(8)
    v_mfma_f32_16x16x32_bf16 v[92:95], v[36:39], v[112:115], v[92:95]
    ds_read_b64_tr_b16 v[60:61], v7 offset:26624
    v_mfma_f32_16x16x32_bf16 v[156:159], v[36:39], v[176:179], v[156:159]
    ds_read_b64_tr_b16 v[62:63], v7 offset:27648
    v_mfma_f32_16x16x32_bf16 v[220:223], v[36:39], v[240:243], v[220:223]
    v_mfma_f32_16x16x32_bf16 v[84:87], v[40:43], v[120:123], v[84:87]
    v_mfma_f32_16x16x32_bf16 v[148:151], v[40:43], v[184:187], v[148:151]
    v_mfma_f32_16x16x32_bf16 v[212:215], v[40:43], v[248:251], v[212:215]
    s_waitcnt lgkmcnt(6)
    v_mfma_f32_16x16x32_bf16 v[92:95], v[44:47], v[120:123], v[92:95]
    v_mfma_f32_16x16x32_bf16 v[156:159], v[44:47], v[184:187], v[156:159]
    v_mfma_f32_16x16x32_bf16 v[220:223], v[44:47], v[248:251], v[220:223]
    v_mfma_f32_16x16x32_bf16 v[84:87], v[48:51], a[24:27], v[84:87]
    v_mfma_f32_16x16x32_bf16 v[148:151], v[48:51], a[56:59], v[148:151]
    v_mfma_f32_16x16x32_bf16 v[212:215], v[48:51], a[88:91], v[212:215]
    s_waitcnt lgkmcnt(2)
    v_mfma_f32_16x16x32_bf16 v[92:95], v[52:55], a[24:27], v[92:95]
    v_mfma_f32_16x16x32_bf16 v[156:159], v[52:55], a[56:59], v[156:159]
    v_mfma_f32_16x16x32_bf16 v[220:223], v[52:55], a[88:91], v[220:223]
    v_mfma_f32_16x16x32_bf16 v[84:87], v[56:59], a[28:31], v[84:87]
    v_mfma_f32_16x16x32_bf16 v[148:151], v[56:59], a[60:63], v[148:151]
    v_mfma_f32_16x16x32_bf16 v[212:215], v[56:59], a[92:95], v[212:215]
    s_waitcnt lgkmcnt(0)
    v_mfma_f32_16x16x32_bf16 v[92:95], v[60:63], a[28:31], v[92:95]
    v_mfma_f32_16x16x32_bf16 v[156:159], v[60:63], a[60:63], v[156:159]
    buffer_load_dword v29, v10, s[32:35], s66 offen sc1
    v_mfma_f32_16x16x32_bf16 v[220:223], v[60:63], a[92:95], v[220:223]
    v_mfma_f32_16x16x32_bf16 v[84:87], v[14:17], a[96:99], v[84:87]
    v_mfma_f32_16x16x32_bf16 v[92:95], v[12:15], a[96:99], v[92:95]
    v_mfma_f32_16x16x32_bf16 v[148:151], v[14:17], a[100:103], v[148:151]
    v_mfma_f32_16x16x32_bf16 v[156:159], v[12:15], a[100:103], v[156:159]
    v_mfma_f32_16x16x32_bf16 v[212:215], v[14:17], a[104:107], v[212:215]
    v_mfma_f32_16x16x32_bf16 v[220:223], v[12:15], a[104:107], v[220:223]
    v_mfma_f32_16x16x32_bf16 v[84:87], v[14:17], a[108:111], v[84:87]
    v_mfma_f32_16x16x32_bf16 v[92:95], v[12:15], a[108:111], v[92:95]
    v_mfma_f32_16x16x32_bf16 v[148:151], v[14:17], a[112:115], v[148:151]
    v_mfma_f32_16x16x32_bf16 v[156:159], v[12:15], a[112:115], v[156:159]
    v_mfma_f32_16x16x32_bf16 v[212:215], v[14:17], a[116:119], v[212:215]
    v_mfma_f32_16x16x32_bf16 v[220:223], v[12:15], a[116:119], v[220:223]
    v_mfma_f32_16x16x32_bf16 v[84:87], v[14:17], a[120:123], v[84:87]
    v_mfma_f32_16x16x32_bf16 v[92:95], v[12:15], a[120:123], v[92:95]
    v_mfma_f32_16x16x32_bf16 v[148:151], v[14:17], a[124:127], v[148:151]
    v_mfma_f32_16x16x32_bf16 v[156:159], v[12:15], a[124:127], v[156:159]
    v_mfma_f32_16x16x32_bf16 v[212:215], v[14:17], a[128:131], v[212:215]
    v_mfma_f32_16x16x32_bf16 v[220:223], v[12:15], a[128:131], v[220:223]
    v_mfma_f32_16x16x32_bf16 v[84:87], v[14:17], a[132:135], v[84:87]
    v_mfma_f32_16x16x32_bf16 v[92:95], v[12:15], a[132:135], v[92:95]
    v_mfma_f32_16x16x32_bf16 v[148:151], v[14:17], a[136:139], v[148:151]
    v_mfma_f32_16x16x32_bf16 v[156:159], v[12:15], a[136:139], v[156:159]
    v_mfma_f32_16x16x32_bf16 v[212:215], v[14:17], a[140:143], v[212:215]
    v_mfma_f32_16x16x32_bf16 v[220:223], v[12:15], a[140:143], v[220:223]
    s_waitcnt vmcnt(4)
    v_mfma_f32_16x16x32_bf16 v[84:87], v[14:17], a[144:147], v[84:87]
    v_mfma_f32_16x16x32_bf16 v[92:95], v[12:15], a[144:147], v[92:95]
    s_waitcnt vmcnt(3)
    v_mfma_f32_16x16x32_bf16 v[148:151], v[14:17], a[148:151], v[148:151]
    v_mfma_f32_16x16x32_bf16 v[156:159], v[12:15], a[148:151], v[156:159]
    s_waitcnt vmcnt(0)
    v_cmp_ne_u32 s[76:77], 1, v29
    v_mfma_f32_16x16x32_bf16 v[212:215], v[14:17], a[152:155], v[212:215]
    s_cmp_lg_u64 s[76:77], 0
    s_cbranch_scc1 L_fwaitb
L_fokb:
    v_mfma_f32_16x16x32_bf16 v[220:223], v[12:15], a[152:155], v[220:223]
    buffer_load_dwordx4 a[156:159], v21, s[32:35], s48 offen offset:0 sc1
    buffer_load_dwordx4 a[160:163], v21, s[32:35], s48 offen offset:1024 sc1
    buffer_load_dwordx4 a[164:167], v21, s[32:35], s48 offen offset:2048 sc1
    buffer_load_dwordx4 a[168:171], v21, s[32:35], s49 offen offset:0 sc1
    buffer_load_dwordx4 a[172:175], v21, s[32:35], s49 offen offset:1024 sc1
    buffer_load_dwordx4 a[176:179], v21, s[32:35], s49 offen offset:2048 sc1
    s_waitcnt vmcnt(5)
    v_mfma_f32_16x16x32_bf16 v[84:87], v[14:17], a[156:159], v[84:87]
    v_mfma_f32_16x16x32_bf16 v[92:95], v[12:15], a[156:159], v[92:95]
    s_waitcnt vmcnt(2)
    v_mfma_f32_16x16x32_bf16 v[84:87], v[14:17], a[168:171], v[84:87]
    v_mfma_f32_16x16x32_bf16 v[92:95], v[12:15], a[168:171], v[92:95]
    v_mfma_f32_16x16x32_bf16 v[148:151], v[14:17], a[160:163], v[148:151]
    v_mfma_f32_16x16x32_bf16 v[156:159], v[12:15], a[160:163], v[156:159]
    s_waitcnt vmcnt(1)
    v_cvt_pk_bf16_f32 v84, v84, v85
    v_cvt_pk_bf16_f32 v85, v86, v87
    v_mfma_f32_16x16x32_bf16 v[148:151], v[14:17], a[172:175], v[148:151]
    v_cvt_pk_bf16_f32 v86, v92, v93
    v_cvt_pk_bf16_f32 v87, v94, v95
    v_mfma_f32_16x16x32_bf16 v[156:159], v[12:15], a[172:175], v[156:159]
    v_permlane16_swap_b32 v84, v86
    v_permlane16_swap_b32 v85, v87
    v_mfma_f32_16x16x32_bf16 v[212:215], v[14:17], a[164:167], v[212:215]
    buffer_store_dwordx4 v[84:87], v20, s[28:31], s40 offen sc1
    v_mfma_f32_16x16x32_bf16 v[220:223], v[12:15], a[164:167], v[220:223]
    s_waitcnt vmcnt(1)
    v_cvt_pk_bf16_f32 v148, v148, v149
    v_cvt_pk_bf16_f32 v149, v150, v151
    v_mfma_f32_16x16x32_bf16 v[212:215], v[14:17], a[176:179], v[212:215]
    v_cvt_pk_bf16_f32 v150, v156, v157
    v_cvt_pk_bf16_f32 v151, v158, v159
    v_mfma_f32_16x16x32_bf16 v[220:223], v[12:15], a[176:179], v[220:223]
    v_permlane16_swap_b32 v148, v150
    v_permlane16_swap_b32 v149, v151
    buffer_store_dwordx4 v[148:151], v20, s[28:31], s41 offen sc1
    s_nop 1
    v_cvt_pk_bf16_f32 v212, v212, v213
    v_cvt_pk_bf16_f32 v213, v214, v215
    s_nop 0
    v_cvt_pk_bf16_f32 v214, v220, v221
    v_cvt_pk_bf16_f32 v215, v222, v223
    s_nop 0
    v_permlane16_swap_b32 v212, v214
    v_permlane16_swap_b32 v213, v215
    buffer_store_dwordx4 v[212:215], v20, s[28:31], s42 offen sc1
L_end:
    s_endpgm
L_cwait:
    s_mov_b32 s74, 0
L_cw1:
    global_load_dword v29, v28, s[36:37] sc1
    s_waitcnt vmcnt(0)
    v_readfirstlane_b32 s55, v29
    s_add_u32 s74, s74, 1
    s_cmp_gt_u32 s74, 200000
    s_cbranch_scc1 L_cok
    s_cmp_ge_u32 s55, 8
    s_cbranch_scc0 L_cw1
    s_branch L_cok
L_fwaita:
    s_mov_b32 s55, 0
L_fw1a:
    buffer_load_dword v29, v10, s[32:35], s66 offen sc1
    s_add_u32 s55, s55, 1
    s_cmp_gt_u32 s55, 200000
    s_waitcnt vmcnt(0)
    s_cbranch_scc1 L_foka
    v_cmp_ne_u32 s[76:77], 1, v29
    s_nop 0
    s_lshl_b64 s[76:77], s[76:77], 16
    s_cbranch_scc1 L_fw1a
    s_branch L_foka
L_fwaitb:
    s_mov_b32 s55, 0
L_fw1b:
    buffer_load_dword v29, v10, s[32:35], s66 offen sc1
    s_add_u32 s55, s55, 1
    s_cmp_gt_u32 s55, 200000
    s_waitcnt vmcnt(0)
    s_cbranch_scc1 L_fokb
    v_cmp_ne_u32 s[76:77], 1, v29
    s_nop 0
    s_cmp_lg_u64 s[76:77], 0
    s_cbranch_scc1 L_fw1b
    s_branch L_fokb
L_fwaitc:
    s_mov_b32 s55, 0
L_fw1c:
    buffer_load_dword v29, v10, s[32:35], s66 offen sc1
    s_add_u32 s55, s55, 1
    s_cmp_gt_u32 s55, 200000
    s_waitcnt vmcnt(0)
    s_cbranch_scc1 L_fokc
    v_cmp_ne_u32 s[76:77], 1, v29
    s_nop 0
    s_lshl_b64 s[76:77], s[76:77], 48
    s_cbranch_scc1 L_fw1c
    s_branch L_fokc
L_fwaitd:
    s_mov_b32 s55, 0
L_fw1d:
    buffer_load_dword v29, v10, s[32:35], s66 offen sc1
    s_add_u32 s55, s55, 1
    s_cmp_gt_u32 s55, 200000
    s_waitcnt vmcnt(0)
    s_cbranch_scc1 L_fokd
    v_cmp_ne_u32 s[76:77], 1, v29
    s_nop 0
    s_lshl_b64 s[76:77], s[76:77], 40
    s_cbranch_scc1 L_fw1d
    s_branch L_fokd
L_fwaite:
    s_mov_b32 s55, 0
L_fw1e:
    buffer_load_dword v29, v10, s[32:35], s66 offen sc1
    s_add_u32 s55, s55, 1
    s_cmp_gt_u32 s55, 200000
    s_waitcnt vmcnt(0)
    s_cbranch_scc1 L_foke
    v_cmp_ne_u32 s[76:77], 1, v29
    s_nop 0
    s_lshl_b64 s[76:77], s[76:77], 32
    s_cbranch_scc1 L_fw1e
    s_branch L_foke
L_fwaitf:
    s_mov_b32 s55, 0
L_fw1f:
    buffer_load_dword v29, v10, s[32:35], s66 offen sc1
    s_add_u32 s55, s55, 1
    s_cmp_gt_u32 s55, 200000
    s_waitcnt vmcnt(0)
    s_cbranch_scc1 L_fokf
    v_cmp_ne_u32 s[76:77], 1, v29
    s_nop 0
    s_lshl_b64 s[76:77], s[76:77], 24
    s_cbranch_scc1 L_fw1f
    s_branch L_fokf
L_slow:
    s_nop 7
    s_nop 7
    s_waitcnt vmcnt(0) lgkmcnt(0)
    s_lshl_b32 s74, s4, 1
    s_add_u32 s74, s74, s6
    s_lshl_b32 s74, s74, 3
    s_add_u32 s74, s74, s3
    s_lshl_b32 s74, s74, 17
    s_add_u32 s74, s74, 1024
    v_and_b32 v1, 31, v0
    v_lshlrev_b32 v1, 8, v1
    v_lshrrev_b32 v2, 5, v0
    v_lshl_add_u32 v1, v2, 4, v1
    v_add_u32 v52, s74, v1
    s_lshl_b32 s74, s7, 11
    v_and_b32 v53, 0xfffe1fff, v21
    v_subrev_u32 v53, s74, v53
    v_add_u32 v54, 2048, v53
    s_lshl_b32 s74, s7, 12
    v_add_u32 v55, s74, v16
    v_add_u32 v56, s74, v17
    v_mov_b32 v48, 0xff800000
    v_mov_b32 v49, 0xff800000
    v_mov_b32 v50, 0xff800000
    s_mov_b32 s75, 0
L_s1:
    buffer_load_dwordx4 a[160:163], v52, s[16:19], s75 offen offset:0
    buffer_load_dwordx4 a[164:167], v52, s[16:19], s75 offen offset:32
    buffer_load_dwordx4 a[168:171], v52, s[16:19], s75 offen offset:64
    buffer_load_dwordx4 a[172:175], v52, s[16:19], s75 offen offset:96
    buffer_load_dwordx4 a[176:179], v52, s[16:19], s75 offen offset:128
    buffer_load_dwordx4 a[180:183], v52, s[16:19], s75 offen offset:160
    buffer_load_dwordx4 a[184:187], v52, s[16:19], s75 offen offset:192
    buffer_load_dwordx4 a[188:191], v52, s[16:19], s75 offen offset:224
    s_waitcnt vmcnt(7)
    v_mfma_f32_32x32x16_bf16 v[32:47], a[160:163], a[0:3], 0
    s_waitcnt vmcnt(6)
    v_mfma_f32_32x32x16_bf16 v[32:47], a[164:167], a[4:7], v[32:47]
    s_waitcnt vmcnt(5)
    v_mfma_f32_32x32x16_bf16 v[32:47], a[168:171], a[8:11], v[32:47]
    s_waitcnt vmcnt(4)
    v_mfma_f32_32x32x16_bf16 v[32:47], a[172:175], a[12:15], v[32:47]
    s_waitcnt vmcnt(3)
    v_mfma_f32_32x32x16_bf16 v[32:47], a[176:179], a[16:19], v[32:47]
    s_waitcnt vmcnt(2)
    v_mfma_f32_32x32x16_bf16 v[32:47], a[180:183], a[20:23], v[32:47]
    s_waitcnt vmcnt(1)
    v_mfma_f32_32x32x16_bf16 v[32:47], a[184:187], a[24:27], v[32:47]
    s_waitcnt vmcnt(0)
    v_mfma_f32_32x32x16_bf16 v[32:47], a[188:191], a[28:31], v[32:47]
    s_nop 7
    s_nop 3
    v_max3_f32 v48, v48, v32, v33
    v_max3_f32 v48, v48, v34, v35
    v_max3_f32 v48, v48, v36, v37
    v_max3_f32 v48, v48, v38, v39
    v_max3_f32 v48, v48, v40, v41
    v_max3_f32 v48, v48, v42, v43
    v_max3_f32 v48, v48, v44, v45
    v_max3_f32 v48, v48, v46, v47
    v_mfma_f32_32x32x16_bf16 v[32:47], a[160:163], a[32:35], 0
    v_mfma_f32_32x32x16_bf16 v[32:47], a[164:167], a[36:39], v[32:47]
    v_mfma_f32_32x32x16_bf16 v[32:47], a[168:171], a[40:43], v[32:47]
    v_mfma_f32_32x32x16_bf16 v[32:47], a[172:175], a[44:47], v[32:47]
    v_mfma_f32_32x32x16_bf16 v[32:47], a[176:179], a[48:51], v[32:47]
    v_mfma_f32_32x32x16_bf16 v[32:47], a[180:183], a[52:55], v[32:47]
    v_mfma_f32_32x32x16_bf16 v[32:47], a[184:187], a[56:59], v[32:47]
    v_mfma_f32_32x32x16_bf16 v[32:47], a[188:191], a[60:63], v[32:47]
    s_nop 7
    s_nop 3
    v_max3_f32 v49, v49, v32, v33
    v_max3_f32 v49, v49, v34, v35
    v_max3_f32 v49, v49, v36, v37
    v_max3_f32 v49, v49, v38, v39
    v_max3_f32 v49, v49, v40, v41
    v_max3_f32 v49, v49, v42, v43
    v_max3_f32 v49, v49, v44, v45
    v_max3_f32 v49, v49, v46, v47
    v_mfma_f32_32x32x16_bf16 v[32:47], a[160:163], a[64:67], 0
    v_mfma_f32_32x32x16_bf16 v[32:47], a[164:167], a[68:71], v[32:47]
    v_mfma_f32_32x32x16_bf16 v[32:47], a[168:171], a[72:75], v[32:47]
    v_mfma_f32_32x32x16_bf16 v[32:47], a[172:175], a[76:79], v[32:47]
    v_mfma_f32_32x32x16_bf16 v[32:47], a[176:179], a[80:83], v[32:47]
    v_mfma_f32_32x32x16_bf16 v[32:47], a[180:183], a[84:87], v[32:47]
    v_mfma_f32_32x32x16_bf16 v[32:47], a[184:187], a[88:91], v[32:47]
    v_mfma_f32_32x32x16_bf16 v[32:47], a[188:191], a[92:95], v[32:47]
    s_nop 7
    s_nop 3
    v_max3_f32 v50, v50, v32, v33
    v_max3_f32 v50, v50, v34, v35
    v_max3_f32 v50, v50, v36, v37
    v_max3_f32 v50, v50, v38, v39
    v_max3_f32 v50, v50, v40, v41
    v_max3_f32 v50, v50, v42, v43
    v_max3_f32 v50, v50, v44, v45
    v_max3_f32 v50, v50, v46, v47
    s_add_u32 s75, s75, 8192
    s_cmp_lt_u32 s75, 0x20000
    s_cbranch_scc1 L_s1
    v_mov_b32 v1, v48
    s_nop 1
    v_permlane32_swap_b32 v1, v48
    v_max_f32 v48, v48, v1
    v_mov_b32 v24, 0
    v_mov_b32 v1, v49
    s_nop 1
    v_permlane32_swap_b32 v1, v49
    v_max_f32 v49, v49, v1
    v_mov_b32 v25, 0
    v_mov_b32 v1, v50
    s_nop 1
    v_permlane32_swap_b32 v1, v50
    v_max_f32 v50, v50, v1
    v_mov_b32 v26, 0
    v_mov_b32 v64, 0
    v_mov_b32 v65, 0
    v_mov_b32 v66, 0
    v_mov_b32 v67, 0
    v_mov_b32 v68, 0
    v_mov_b32 v69, 0
    v_mov_b32 v70, 0
    v_mov_b32 v71, 0
    v_mov_b32 v72, 0
    v_mov_b32 v73, 0
    v_mov_b32 v74, 0
    v_mov_b32 v75, 0
    v_mov_b32 v76, 0
    v_mov_b32 v77, 0
    v_mov_b32 v78, 0
    v_mov_b32 v79, 0
    v_mov_b32 v80, 0
    v_mov_b32 v81, 0
    v_mov_b32 v82, 0
    v_mov_b32 v83, 0
    v_mov_b32 v84, 0
    v_mov_b32 v85, 0
    v_mov_b32 v86, 0
    v_mov_b32 v87, 0
    v_mov_b32 v88, 0
    v_mov_b32 v89, 0
    v_mov_b32 v90, 0
    v_mov_b32 v91, 0
    v_mov_b32 v92, 0
    v_mov_b32 v93, 0
    v_mov_b32 v94, 0
    v_mov_b32 v95, 0
    v_mov_b32 v96, 0
    v_mov_b32 v97, 0
    v_mov_b32 v98, 0
    v_mov_b32 v99, 0
    v_mov_b32 v100, 0
    v_mov_b32 v101, 0
    v_mov_b32 v102, 0
    v_mov_b32 v103, 0
    v_mov_b32 v104, 0
    v_mov_b32 v105, 0
    v_mov_b32 v106, 0
    v_mov_b32 v107, 0
    v_mov_b32 v108, 0
    v_mov_b32 v109, 0
    v_mov_b32 v110, 0
    v_mov_b32 v111, 0
    v_mov_b32 v112, 0
    v_mov_b32 v113, 0
    v_mov_b32 v114, 0
    v_mov_b32 v115, 0
    v_mov_b32 v116, 0
    v_mov_b32 v117, 0
    v_mov_b32 v118, 0
    v_mov_b32 v119, 0
    v_mov_b32 v120, 0
    v_mov_b32 v121, 0
    v_mov_b32 v122, 0
    v_mov_b32 v123, 0
    v_mov_b32 v124, 0
    v_mov_b32 v125, 0
    v_mov_b32 v126, 0
    v_mov_b32 v127, 0
    v_mov_b32 v128, 0
    v_mov_b32 v129, 0
    v_mov_b32 v130, 0
    v_mov_b32 v131, 0
    v_mov_b32 v132, 0
    v_mov_b32 v133, 0
    v_mov_b32 v134, 0
    v_mov_b32 v135, 0
    v_mov_b32 v136, 0
    v_mov_b32 v137, 0
    v_mov_b32 v138, 0
    v_mov_b32 v139, 0
    v_mov_b32 v140, 0
    v_mov_b32 v141, 0
    v_mov_b32 v142, 0
    v_mov_b32 v143, 0
    v_mov_b32 v144, 0
    v_mov_b32 v145, 0
    v_mov_b32 v146, 0
    v_mov_b32 v147, 0
    v_mov_b32 v148, 0
    v_mov_b32 v149, 0
    v_mov_b32 v150, 0
    v_mov_b32 v151, 0
    v_mov_b32 v152, 0
    v_mov_b32 v153, 0
    v_mov_b32 v154, 0
    v_mov_b32 v155, 0
    v_mov_b32 v156, 0
    v_mov_b32 v157, 0
    v_mov_b32 v158, 0
    v_mov_b32 v159, 0
    v_mov_b32 v160, 0
    v_mov_b32 v161, 0
    v_mov_b32 v162, 0
    v_mov_b32 v163, 0
    v_mov_b32 v164, 0
    v_mov_b32 v165, 0
    v_mov_b32 v166, 0
    v_mov_b32 v167, 0
    v_mov_b32 v168, 0
    v_mov_b32 v169, 0
    v_mov_b32 v170, 0
    v_mov_b32 v171, 0
    v_mov_b32 v172, 0
    v_mov_b32 v173, 0
    v_mov_b32 v174, 0
    v_mov_b32 v175, 0
    v_mov_b32 v176, 0
    v_mov_b32 v177, 0
    v_mov_b32 v178, 0
    v_mov_b32 v179, 0
    v_mov_b32 v180, 0
    v_mov_b32 v181, 0
    v_mov_b32 v182, 0
    v_mov_b32 v183, 0
    v_mov_b32 v184, 0
    v_mov_b32 v185, 0
    v_mov_b32 v186, 0
    v_mov_b32 v187, 0
    v_mov_b32 v188, 0
    v_mov_b32 v189, 0
    v_mov_b32 v190, 0
    v_mov_b32 v191, 0
    v_mov_b32 v192, 0
    v_mov_b32 v193, 0
    v_mov_b32 v194, 0
    v_mov_b32 v195, 0
    v_mov_b32 v196, 0
    v_mov_b32 v197, 0
    v_mov_b32 v198, 0
    v_mov_b32 v199, 0
    v_mov_b32 v200, 0
    v_mov_b32 v201, 0
    v_mov_b32 v202, 0
    v_mov_b32 v203, 0
    v_mov_b32 v204, 0
    v_mov_b32 v205, 0
    v_mov_b32 v206, 0
    v_mov_b32 v207, 0
    v_mov_b32 v208, 0
    v_mov_b32 v209, 0
    v_mov_b32 v210, 0
    v_mov_b32 v211, 0
    v_mov_b32 v212, 0
    v_mov_b32 v213, 0
    v_mov_b32 v214, 0
    v_mov_b32 v215, 0
    v_mov_b32 v216, 0
    v_mov_b32 v217, 0
    v_mov_b32 v218, 0
    v_mov_b32 v219, 0
    v_mov_b32 v220, 0
    v_mov_b32 v221, 0
    v_mov_b32 v222, 0
    v_mov_b32 v223, 0
    v_mov_b32 v224, 0
    v_mov_b32 v225, 0
    v_mov_b32 v226, 0
    v_mov_b32 v227, 0
    v_mov_b32 v228, 0
    v_mov_b32 v229, 0
    v_mov_b32 v230, 0
    v_mov_b32 v231, 0
    v_mov_b32 v232, 0
    v_mov_b32 v233, 0
    v_mov_b32 v234, 0
    v_mov_b32 v235, 0
    v_mov_b32 v236, 0
    v_mov_b32 v237, 0
    v_mov_b32 v238, 0
    v_mov_b32 v239, 0
    v_mov_b32 v240, 0
    v_mov_b32 v241, 0
    v_mov_b32 v242, 0
    v_mov_b32 v243, 0
    v_mov_b32 v244, 0
    v_mov_b32 v245, 0
    v_mov_b32 v246, 0
    v_mov_b32 v247, 0
    v_mov_b32 v248, 0
    v_mov_b32 v249, 0
    v_mov_b32 v250, 0
    v_mov_b32 v251, 0
    v_mov_b32 v252, 0
    v_mov_b32 v253, 0
    v_mov_b32 v254, 0
    v_mov_b32 v255, 0
    s_mov_b32 s75, 0
L_s2:
    buffer_load_dwordx4 a[160:163], v52, s[16:19], s75 offen offset:0
    buffer_load_dwordx4 a[164:167], v52, s[16:19], s75 offen offset:32
    buffer_load_dwordx4 a[168:171], v52, s[16:19], s75 offen offset:64
    buffer_load_dwordx4 a[172:175], v52, s[16:19], s75 offen offset:96
    buffer_load_dwordx4 a[176:179], v52, s[16:19], s75 offen offset:128
    buffer_load_dwordx4 a[180:183], v52, s[16:19], s75 offen offset:160
    buffer_load_dwordx4 a[184:187], v52, s[16:19], s75 offen offset:192
    buffer_load_dwordx4 a[188:191], v52, s[16:19], s75 offen offset:224
    s_add_u32 m0, s52, 40960
    s_nop 0
    buffer_load_dwordx4 v53, s[20:23], s45 offen offset:0 lds
    buffer_load_dwordx4 v53, s[20:23], s46 offen offset:1024 lds
    buffer_load_dwordx4 v53, s[20:23], s47 offen offset:2048 lds
    buffer_load_dwordx4 v53, s[20:23], s48 offen offset:3072 lds
    s_add_u32 m0, s52, 49152
    s_nop 0
    buffer_load_dwordx4 v54, s[20:23], s45 offen offset:0 lds
    buffer_load_dwordx4 v54, s[20:23], s46 offen offset:1024 lds
    buffer_load_dwordx4 v54, s[20:23], s47 offen offset:2048 lds
    buffer_load_dwordx4 v54, s[20:23], s48 offen offset:3072 lds
    v_add_u32 v53, 8192, v53
    v_add_u32 v54, 8192, v54
    s_waitcnt vmcnt(0)
    ds_read_b64_tr_b16 a[192:193], v55 offset:24576
    ds_read_b64_tr_b16 a[194:195], v55 offset:32768
    ds_read_b64_tr_b16 a[196:197], v56 offset:24576
    ds_read_b64_tr_b16 a[198:199], v56 offset:32768
    ds_read_b64_tr_b16 a[200:201], v55 offset:25600
    ds_read_b64_tr_b16 a[202:203], v55 offset:33792
    ds_read_b64_tr_b16 a[204:205], v56 offset:25600
    ds_read_b64_tr_b16 a[206:207], v56 offset:33792
    ds_read_b64_tr_b16 a[208:209], v55 offset:26624
    ds_read_b64_tr_b16 a[210:211], v55 offset:34816
    ds_read_b64_tr_b16 a[212:213], v56 offset:26624
    ds_read_b64_tr_b16 a[214:215], v56 offset:34816
    ds_read_b64_tr_b16 a[216:217], v55 offset:27648
    ds_read_b64_tr_b16 a[218:219], v55 offset:35840
    ds_read_b64_tr_b16 a[220:221], v56 offset:27648
    ds_read_b64_tr_b16 a[222:223], v56 offset:35840
    s_waitcnt lgkmcnt(0)
    v_mfma_f32_32x32x16_bf16 v[32:47], a[160:163], a[0:3], 0
    v_mfma_f32_32x32x16_bf16 v[32:47], a[164:167], a[4:7], v[32:47]
    v_mfma_f32_32x32x16_bf16 v[32:47], a[168:171], a[8:11], v[32:47]
    v_mfma_f32_32x32x16_bf16 v[32:47], a[172:175], a[12:15], v[32:47]
    v_mfma_f32_32x32x16_bf16 v[32:47], a[176:179], a[16:19], v[32:47]
    v_mfma_f32_32x32x16_bf16 v[32:47], a[180:183], a[20:23], v[32:47]
    v_mfma_f32_32x32x16_bf16 v[32:47], a[184:187], a[24:27], v[32:47]
    v_mfma_f32_32x32x16_bf16 v[32:47], a[188:191], a[28:31], v[32:47]
    s_nop 7
    s_nop 3
    v_sub_f32 v32, v32, v48
    v_sub_f32 v33, v33, v48
    v_sub_f32 v34, v34, v48
    v_sub_f32 v35, v35, v48
    v_sub_f32 v36, v36, v48
    v_sub_f32 v37, v37, v48
    v_sub_f32 v38, v38, v48
    v_sub_f32 v39, v39, v48
    v_sub_f32 v40, v40, v48
    v_sub_f32 v41, v41, v48
    v_sub_f32 v42, v42, v48
    v_sub_f32 v43, v43, v48
    v_sub_f32 v44, v44, v48
    v_sub_f32 v45, v45, v48
    v_sub_f32 v46, v46, v48
    v_sub_f32 v47, v47, v48
    v_exp_f32 v32, v32
    v_exp_f32 v33, v33
    v_add_f32 v24, v24, v32
    v_exp_f32 v34, v34
    v_add_f32 v24, v24, v33
    v_cvt_pk_bf16_f32 v32, v32, v33
    v_exp_f32 v35, v35
    v_add_f32 v24, v24, v34
    v_exp_f32 v36, v36
    v_add_f32 v24, v24, v35
    v_cvt_pk_bf16_f32 v33, v34, v35
    v_exp_f32 v37, v37
    v_add_f32 v24, v24, v36
    v_exp_f32 v38, v38
    v_add_f32 v24, v24, v37
    v_cvt_pk_bf16_f32 v34, v36, v37
    v_exp_f32 v39, v39
    v_add_f32 v24, v24, v38
    v_exp_f32 v40, v40
    v_add_f32 v24, v24, v39
    v_cvt_pk_bf16_f32 v35, v38, v39
    v_exp_f32 v41, v41
    v_add_f32 v24, v24, v40
    v_exp_f32 v42, v42
    v_add_f32 v24, v24, v41
    v_cvt_pk_bf16_f32 v40, v40, v41
    v_exp_f32 v43, v43
    v_add_f32 v24, v24, v42
    v_exp_f32 v44, v44
    v_add_f32 v24, v24, v43
    v_cvt_pk_bf16_f32 v41, v42, v43
    v_exp_f32 v45, v45
    v_add_f32 v24, v24, v44
    v_exp_f32 v46, v46
    v_add_f32 v24, v24, v45
    v_cvt_pk_bf16_f32 v42, v44, v45
    v_exp_f32 v47, v47
    v_add_f32 v24, v24, v46
    v_add_f32 v24, v24, v47
    v_cvt_pk_bf16_f32 v43, v46, v47
    v_mfma_f32_32x32x16_bf16 v[64:79], a[192:195], v[32:35], v[64:79]
    v_mfma_f32_32x32x16_bf16 v[80:95], a[196:199], v[32:35], v[80:95]
    v_mfma_f32_32x32x16_bf16 v[96:111], a[200:203], v[32:35], v[96:111]
    v_mfma_f32_32x32x16_bf16 v[112:127], a[204:207], v[32:35], v[112:127]
    v_mfma_f32_32x32x16_bf16 v[64:79], a[208:211], v[40:43], v[64:79]
    v_mfma_f32_32x32x16_bf16 v[80:95], a[212:215], v[40:43], v[80:95]
    v_mfma_f32_32x32x16_bf16 v[96:111], a[216:219], v[40:43], v[96:111]
    v_mfma_f32_32x32x16_bf16 v[112:127], a[220:223], v[40:43], v[112:127]
    v_mfma_f32_32x32x16_bf16 v[32:47], a[160:163], a[32:35], 0
    v_mfma_f32_32x32x16_bf16 v[32:47], a[164:167], a[36:39], v[32:47]
    v_mfma_f32_32x32x16_bf16 v[32:47], a[168:171], a[40:43], v[32:47]
    v_mfma_f32_32x32x16_bf16 v[32:47], a[172:175], a[44:47], v[32:47]
    v_mfma_f32_32x32x16_bf16 v[32:47], a[176:179], a[48:51], v[32:47]
    v_mfma_f32_32x32x16_bf16 v[32:47], a[180:183], a[52:55], v[32:47]
    v_mfma_f32_32x32x16_bf16 v[32:47], a[184:187], a[56:59], v[32:47]
    v_mfma_f32_32x32x16_bf16 v[32:47], a[188:191], a[60:63], v[32:47]
    s_nop 7
    s_nop 3
    v_sub_f32 v32, v32, v49
    v_sub_f32 v33, v33, v49
    v_sub_f32 v34, v34, v49
    v_sub_f32 v35, v35, v49
    v_sub_f32 v36, v36, v49
    v_sub_f32 v37, v37, v49
    v_sub_f32 v38, v38, v49
    v_sub_f32 v39, v39, v49
    v_sub_f32 v40, v40, v49
    v_sub_f32 v41, v41, v49
    v_sub_f32 v42, v42, v49
    v_sub_f32 v43, v43, v49
    v_sub_f32 v44, v44, v49
    v_sub_f32 v45, v45, v49
    v_sub_f32 v46, v46, v49
    v_sub_f32 v47, v47, v49
    v_exp_f32 v32, v32
    v_exp_f32 v33, v33
    v_add_f32 v25, v25, v32
    v_exp_f32 v34, v34
    v_add_f32 v25, v25, v33
    v_cvt_pk_bf16_f32 v32, v32, v33
    v_exp_f32 v35, v35
    v_add_f32 v25, v25, v34
    v_exp_f32 v36, v36
    v_add_f32 v25, v25, v35
    v_cvt_pk_bf16_f32 v33, v34, v35
    v_exp_f32 v37, v37
    v_add_f32 v25, v25, v36
    v_exp_f32 v38, v38
    v_add_f32 v25, v25, v37
    v_cvt_pk_bf16_f32 v34, v36, v37
    v_exp_f32 v39, v39
    v_add_f32 v25, v25, v38
    v_exp_f32 v40, v40
    v_add_f32 v25, v25, v39
    v_cvt_pk_bf16_f32 v35, v38, v39
    v_exp_f32 v41, v41
    v_add_f32 v25, v25, v40
    v_exp_f32 v42, v42
    v_add_f32 v25, v25, v41
    v_cvt_pk_bf16_f32 v40, v40, v41
    v_exp_f32 v43, v43
    v_add_f32 v25, v25, v42
    v_exp_f32 v44, v44
    v_add_f32 v25, v25, v43
    v_cvt_pk_bf16_f32 v41, v42, v43
    v_exp_f32 v45, v45
    v_add_f32 v25, v25, v44
    v_exp_f32 v46, v46
    v_add_f32 v25, v25, v45
    v_cvt_pk_bf16_f32 v42, v44, v45
    v_exp_f32 v47, v47
    v_add_f32 v25, v25, v46
    v_add_f32 v25, v25, v47
    v_cvt_pk_bf16_f32 v43, v46, v47
    v_mfma_f32_32x32x16_bf16 v[128:143], a[192:195], v[32:35], v[128:143]
    v_mfma_f32_32x32x16_bf16 v[144:159], a[196:199], v[32:35], v[144:159]
    v_mfma_f32_32x32x16_bf16 v[160:175], a[200:203], v[32:35], v[160:175]
    v_mfma_f32_32x32x16_bf16 v[176:191], a[204:207], v[32:35], v[176:191]
    v_mfma_f32_32x32x16_bf16 v[128:143], a[208:211], v[40:43], v[128:143]
    v_mfma_f32_32x32x16_bf16 v[144:159], a[212:215], v[40:43], v[144:159]
    v_mfma_f32_32x32x16_bf16 v[160:175], a[216:219], v[40:43], v[160:175]
    v_mfma_f32_32x32x16_bf16 v[176:191], a[220:223], v[40:43], v[176:191]
    v_mfma_f32_32x32x16_bf16 v[32:47], a[160:163], a[64:67], 0
    v_mfma_f32_32x32x16_bf16 v[32:47], a[164:167], a[68:71], v[32:47]
    v_mfma_f32_32x32x16_bf16 v[32:47], a[168:171], a[72:75], v[32:47]
    v_mfma_f32_32x32x16_bf16 v[32:47], a[172:175], a[76:79], v[32:47]
    v_mfma_f32_32x32x16_bf16 v[32:47], a[176:179], a[80:83], v[32:47]
    v_mfma_f32_32x32x16_bf16 v[32:47], a[180:183], a[84:87], v[32:47]
    v_mfma_f32_32x32x16_bf16 v[32:47], a[184:187], a[88:91], v[32:47]
    v_mfma_f32_32x32x16_bf16 v[32:47], a[188:191], a[92:95], v[32:47]
    s_nop 7
    s_nop 3
    v_sub_f32 v32, v32, v50
    v_sub_f32 v33, v33, v50
    v_sub_f32 v34, v34, v50
    v_sub_f32 v35, v35, v50
    v_sub_f32 v36, v36, v50
    v_sub_f32 v37, v37, v50
    v_sub_f32 v38, v38, v50
    v_sub_f32 v39, v39, v50
    v_sub_f32 v40, v40, v50
    v_sub_f32 v41, v41, v50
    v_sub_f32 v42, v42, v50
    v_sub_f32 v43, v43, v50
    v_sub_f32 v44, v44, v50
    v_sub_f32 v45, v45, v50
    v_sub_f32 v46, v46, v50
    v_sub_f32 v47, v47, v50
    v_exp_f32 v32, v32
    v_exp_f32 v33, v33
    v_add_f32 v26, v26, v32
    v_exp_f32 v34, v34
    v_add_f32 v26, v26, v33
    v_cvt_pk_bf16_f32 v32, v32, v33
    v_exp_f32 v35, v35
    v_add_f32 v26, v26, v34
    v_exp_f32 v36, v36
    v_add_f32 v26, v26, v35
    v_cvt_pk_bf16_f32 v33, v34, v35
    v_exp_f32 v37, v37
    v_add_f32 v26, v26, v36
    v_exp_f32 v38, v38
    v_add_f32 v26, v26, v37
    v_cvt_pk_bf16_f32 v34, v36, v37
    v_exp_f32 v39, v39
    v_add_f32 v26, v26, v38
    v_exp_f32 v40, v40
    v_add_f32 v26, v26, v39
    v_cvt_pk_bf16_f32 v35, v38, v39
    v_exp_f32 v41, v41
    v_add_f32 v26, v26, v40
    v_exp_f32 v42, v42
    v_add_f32 v26, v26, v41
    v_cvt_pk_bf16_f32 v40, v40, v41
    v_exp_f32 v43, v43
    v_add_f32 v26, v26, v42
    v_exp_f32 v44, v44
    v_add_f32 v26, v26, v43
    v_cvt_pk_bf16_f32 v41, v42, v43
    v_exp_f32 v45, v45
    v_add_f32 v26, v26, v44
    v_exp_f32 v46, v46
    v_add_f32 v26, v26, v45
    v_cvt_pk_bf16_f32 v42, v44, v45
    v_exp_f32 v47, v47
    v_add_f32 v26, v26, v46
    v_add_f32 v26, v26, v47
    v_cvt_pk_bf16_f32 v43, v46, v47
    v_mfma_f32_32x32x16_bf16 v[192:207], a[192:195], v[32:35], v[192:207]
    v_mfma_f32_32x32x16_bf16 v[208:223], a[196:199], v[32:35], v[208:223]
    v_mfma_f32_32x32x16_bf16 v[224:239], a[200:203], v[32:35], v[224:239]
    v_mfma_f32_32x32x16_bf16 v[240:255], a[204:207], v[32:35], v[240:255]
    v_mfma_f32_32x32x16_bf16 v[192:207], a[208:211], v[40:43], v[192:207]
    v_mfma_f32_32x32x16_bf16 v[208:223], a[212:215], v[40:43], v[208:223]
    v_mfma_f32_32x32x16_bf16 v[224:239], a[216:219], v[40:43], v[224:239]
    v_mfma_f32_32x32x16_bf16 v[240:255], a[220:223], v[40:43], v[240:255]
    s_add_u32 s75, s75, 8192
    s_cmp_lt_u32 s75, 0x20000
    s_cbranch_scc1 L_s2
    s_nop 7
    s_nop 7
    v_mov_b32 v1, v24
    v_mov_b32 v2, v25
    v_mov_b32 v3, v26
    v_permlane32_swap_b32 v1, v24
    v_permlane32_swap_b32 v2, v25
    v_permlane32_swap_b32 v3, v26
    v_add_f32 v24, v24, v1
    v_add_f32 v25, v25, v2
    v_add_f32 v26, v26, v3
    s_branch L_join
L_last:
    s_endpgm
.section .rodata,"a"
.p2align 6
.amdhsa_kernel concat_heads__gqa_block_cached__gqa_block_cached__near_ridge_kernel
  .amdhsa_next_free_vgpr 512
  .amdhsa_next_free_sgpr 102
  .amdhsa_accum_offset 256
  .amdhsa_group_segment_fixed_size 0
  .amdhsa_kernarg_size 104
  .amdhsa_user_sgpr_count 2
  .amdhsa_user_sgpr_kernarg_segment_ptr 1
  .amdhsa_system_sgpr_workgroup_id_x 1
  .amdhsa_float_denorm_mode_32 3
.end_amdhsa_kernel
```
